```python
import torch

def _softmax(x, axis=-1):
    return torch.softmax(x, dim=axis)
def _gelu(x):
    return torch.nn.functional.gelu(x, approximate="tanh")
def _silu(x):
    return torch.nn.functional.silu(x)
def _sigmoid(x):
    return torch.sigmoid(x)
def _layernorm(x, axis=-1, eps=1e-5):
    m = x.mean(dim=axis, keepdim=True)
    v = x.var(dim=axis, keepdim=True, unbiased=False)
    return (x - m) / torch.sqrt(v + eps)
def _scatter_add(tgt, idx, src, axis=0):
    return tgt.clone().index_add_(axis, idx, src)
def _segment_sum(src, seg, n):
    out = torch.zeros((n,) + src.shape[1:], dtype=src.dtype)
    return out.index_add_(0, seg, src)
def _pad(x, pw):
    flat = tuple(v for pair in reversed(pw) for v in pair)
    return torch.nn.functional.pad(x, flat)

kernel_name = 'standalone__mha_softmax__near_ridge'

def setup_inputs():

    _w = (lambda a: (lambda t: t.to(torch.bfloat16) if t.is_floating_point() else t)(torch.as_tensor(a)))
    B, H, Sq, Sk, D = 16, 32, 368, 1024, 128
    return {
        "q": _w((lambda *s: torch.randn(*s, dtype=torch.bfloat16) * 0.8)(B, H, Sq, D)),
        "k": _w((lambda *s: torch.randn(*s, dtype=torch.bfloat16) * 0.8)(B, H, Sk, D)),
        "v": _w((lambda *s: torch.randn(*s, dtype=torch.bfloat16) * 0.05)(B, H, Sk, D)),
    }

def reference(q, k, v):
    scale = q.shape[-1] ** -0.5
    scores = torch.einsum("bhqd,bhkd->bhqk", q, k) * scale
    p = _softmax(scores, axis=-1)
    return torch.einsum("bhqk,bhkd->bhqd", p, v)
```

```asm
; @launch grid=(256,1,1) block=(256,1,1) lds=161792
.amdgcn_target "amdgcn-amd-amdhsa--gfx950"
.text
.globl standalone__mha_softmax__near_ridge_kernel
.p2align 8
.type standalone__mha_softmax__near_ridge_kernel,@function
standalone__mha_softmax__near_ridge_kernel:
    s_cmp_ge_u32 s2, 256
    s_cbranch_scc1 L_END
    s_load_dwordx4 s[4:7], s[0:1], 0
    s_load_dwordx4 s[8:11], s[0:1], 16
    v_lshrrev_b32 v36, 6, v0
    v_and_b32 v0, 63, v0
    v_readfirstlane_b32 s28, v36
    v_lshlrev_b32 v10, 4, v0
    v_lshrrev_b32 v37, 4, v0
    v_and_b32 v38, 15, v0
    v_xor_b32 v39, v37, v38
    v_lshlrev_b32 v39, 4, v39
    v_lshl_add_u32 v11, v37, 8, v39
    v_xor_b32 v12, 64, v11
    v_xor_b32 v13, 0x80, v11
    v_xor_b32 v14, 0xc0, v11
    s_lshl_b32 s3, s2, 19
    s_mul_i32 s29, s2, 188416
    s_mov_b32 s14, 188416
    s_mov_b32 s15, 0x20000
    s_mov_b32 s18, 0x80000
    s_mov_b32 s19, 0x20000
    s_mov_b32 s22, 0x80000
    s_mov_b32 s23, 0x20000
    s_mov_b32 s26, 188416
    s_mov_b32 s27, 0x20000
    s_mul_i32 s31, s28, 2112
    s_lshl_b32 s32, s28, 11
    s_mul_i32 s34, s28, 24576
    s_mov_b32 m0, s31
    s_waitcnt lgkmcnt(0)
    s_add_u32 s16, s6, s3
    s_addc_u32 s17, s7, 0
    s_add_u32 s20, s8, s3
    s_addc_u32 s21, s9, 0
    buffer_load_dwordx4 v10, s[16:19], s32 offen nt lds
    s_add_u32 m0, s31, 32
    s_add_u32 s12, s4, s29
    s_addc_u32 s13, s5, 0
    buffer_load_dwordx4 v10, s[16:19], s32 offen offset:1024 nt lds
    s_mul_i32 s31, s28, 2080
    s_add_u32 m0, s31, 33792
    s_add_u32 s24, s10, s29
    s_addc_u32 s25, s11, 0
    buffer_load_dwordx4 v10, s[20:23], s32 offen nt lds
    s_add_u32 m0, s31, 33808
    s_mov_b32 s36, 0xffff0000
    buffer_load_dwordx4 v10, s[20:23], s32 offen offset:1024 nt lds
    s_add_u32 m0, s34, 67584
    s_add_u32 s37, s34, 0
    buffer_load_dwordx4 v11, s[12:15], s37 offen offset:0 nt lds
    buffer_load_dwordx4 v12, s[12:15], s37 offen offset:1024 nt lds
    buffer_load_dwordx4 v13, s[12:15], s37 offen offset:2048 nt lds
    buffer_load_dwordx4 v14, s[12:15], s37 offen offset:3072 nt lds
    s_add_u32 m0, s34, 71680
    s_add_u32 s37, s34, 4096
    buffer_load_dwordx4 v11, s[12:15], s37 offen offset:0 nt lds
    buffer_load_dwordx4 v12, s[12:15], s37 offen offset:1024 nt lds
    buffer_load_dwordx4 v13, s[12:15], s37 offen offset:2048 nt lds
    buffer_load_dwordx4 v14, s[12:15], s37 offen offset:3072 nt lds
    s_add_u32 m0, s34, 75776
    s_add_u32 s37, s34, 8192
    buffer_load_dwordx4 v11, s[12:15], s37 offen offset:0 nt lds
    buffer_load_dwordx4 v12, s[12:15], s37 offen offset:1024 nt lds
    buffer_load_dwordx4 v13, s[12:15], s37 offen offset:2048 nt lds
    buffer_load_dwordx4 v14, s[12:15], s37 offen offset:3072 nt lds
    s_mov_b32 s35, 0x3e0293ee
    s_mov_b32 s38, 0x33800000
    s_mov_b32 s37, 1056
    v_and_b32 v36, 7, v0
    v_mul_lo_u32 v1, v36, s37
    v_lshrrev_b32 v36, 3, v38
    v_lshl_add_u32 v1, v36, 8, v1
    v_lshl_add_u32 v1, v37, 4, v1
    v_bfe_u32 v36, v0, 2, 3
    v_mul_u32_u24 v2, 1040, v36
    v_lshrrev_b32 v36, 5, v0
    v_lshl_add_u32 v2, v36, 8, v2
    v_bfe_u32 v35, v0, 1, 1
    v_lshl_add_u32 v2, v35, 7, v2
    v_lshlrev_b32 v21, 9, v36
    v_lshl_add_u32 v21, v35, 7, v21
    v_and_b32 v35, 1, v0
    v_lshl_add_u32 v2, v35, 3, v2
    v_mul_u32_u24 v35, 0x140, v35
    v_add_u32 v21, v21, v35
    v_lshrrev_b32 v35, 2, v38
    v_lshl_add_u32 v21, v35, 4, v21
    v_and_b32 v35, 1, v37
    v_lshl_add_u32 v21, v35, 3, v21
    v_mov_b32 v3, v1
    v_mov_b32 v4, v2
    v_lshl_add_u32 v39, v38, 8, v39
    s_add_u32 s37, s34, 67584
    v_add_u32 v5, s37, v39
    v_xor_b32 v35, 64, v39
    v_add_u32 v6, s37, v35
    v_xor_b32 v35, 0x80, v39
    v_add_u32 v7, s37, v35
    v_xor_b32 v35, 0xc0, v39
    v_add_u32 v8, s37, v35
    s_mov_b32 s43, s37
    v_lshlrev_b32 v35, 4, v38
    v_lshl_add_u32 v35, v37, 10, v35
    v_add_u32 v23, s37, v35
    v_mov_b32 v35, 0x3f803f80
    v_lshlrev_b32 v20, 2, v0
    v_bfe_u32 v34, v0, 1, 1
    v_cmp_eq_u32 vcc, v34, v36
    v_and_b32 v34, 1, v0
    s_nop 0
    v_cndmask_b32 v35, 0, v35, vcc
    v_mul_u32_u24 v34, 0xaaaa, v34
    v_add_u32 v19, 0x4444, v34
    v_accvgpr_write_b32 a224, 0
    v_accvgpr_write_b32 a225, 0
    v_accvgpr_write_b32 a226, 0
    v_accvgpr_write_b32 a227, 0
    v_accvgpr_write_b32 a228, 0
    v_accvgpr_write_b32 a229, 0
    v_accvgpr_write_b32 a230, 0
    v_accvgpr_write_b32 a231, 0
    v_accvgpr_write_b32 a232, 0
    v_accvgpr_write_b32 a233, 0
    v_accvgpr_write_b32 a234, 0
    v_accvgpr_write_b32 a235, 0
    v_accvgpr_write_b32 a236, 0
    v_accvgpr_write_b32 a237, 0
    v_accvgpr_write_b32 a238, 0
    v_accvgpr_write_b32 a239, 0
    v_accvgpr_write_b32 a240, 0
    v_accvgpr_write_b32 a241, 0
    v_accvgpr_write_b32 a242, 0
    v_accvgpr_write_b32 a243, 0
    v_accvgpr_write_b32 a244, 0
    v_accvgpr_write_b32 a245, 0
    v_accvgpr_write_b32 a246, 0
    v_accvgpr_write_b32 a247, 0
    v_mov_b32 v236, 0
    v_mov_b32 v237, 0
    v_mov_b32 v238, 0
    v_mov_b32 v239, 0
    v_mov_b32 v15, 0
    v_mov_b32 v16, 0
    v_accvgpr_write_b32 a248, v35
    v_accvgpr_write_b32 a249, v35
    v_accvgpr_write_b32 a250, v35
    v_accvgpr_write_b32 a251, v35
    s_mov_b32 s29, 1
    s_mov_b32 s30, 0
    s_mov_b32 s45, 0xfffff000
    s_mov_b32 s40, 0xffffe400
    s_lshl_b32 s44, s28, 31
    s_and_b32 s44, s44, 0xffff
    s_sub_u32 s40, s40, s44
    s_mov_b32 s44, 24576
    s_cmp_eq_u32 s28, 3
    s_cselect_b32 s44, 20480, s44
    s_waitcnt vmcnt(8)
    s_barrier
    ds_read_b128 v[64:67], v5 offset:0
    ds_read_b128 v[68:71], v6 offset:0
    ds_read_b128 v[72:75], v7 offset:0
    ds_read_b128 v[76:79], v8 offset:0
    ds_read_b128 a[96:99], v3 offset:0
    ds_read_b128 a[100:103], v3 offset:64
    ds_read_b128 a[104:107], v3 offset:128
    ds_read_b128 a[108:111], v3 offset:192
    ds_read_b128 a[112:115], v3 offset:512
    ds_read_b128 a[116:119], v3 offset:576
    ds_read_b128 a[120:123], v3 offset:640
    ds_read_b128 a[124:127], v3 offset:704
    s_cmp_ge_u32 s2, 16
    s_cbranch_scc1 L_NOPF
    s_getpc_b64 s[4:5]
L_PC:
    s_and_b32 s6, s28, 1
    s_lshl_b32 s6, s6, 13
    s_cmp_ge_u32 s28, 2
    s_cselect_b32 s7, L_B1-L_A1, 0
    s_add_u32 s6, s6, s7
    s_add_u32 s6, s6, L_A1-L_PC
    v_lshl_add_u32 v40, v0, 7, s6
    v_min_u32 v40, L_FIX-L_PC, v40
    v_mov_b32 v41, 0
    v_lshl_add_u64 v[42:43], v[40:41], 0, s[4:5]
    global_load_dword v22, v[42:43], off
L_NOPF:
    s_waitcnt lgkmcnt(11)
    v_lshlrev_b32 v80, 16, v64
    v_lshlrev_b32 v81, 16, v65
    v_lshlrev_b32 v82, 16, v66
    v_lshlrev_b32 v83, 16, v67
    v_and_b32 v64, s36, v64
    v_and_b32 v65, s36, v65
    v_and_b32 v66, s36, v66
    v_and_b32 v67, s36, v67
    v_mul_f32 v80, s35, v80
    v_mul_f32 v81, s35, v81
    v_mul_f32 v82, s35, v82
    v_mul_f32 v83, s35, v83
    v_mul_f32 v64, s35, v64
    v_mul_f32 v65, s35, v65
    v_mul_f32 v66, s35, v66
    v_mul_f32 v67, s35, v67
    v_cvt_pk_bf16_f32 v64, v80, v64
    v_cvt_pk_bf16_f32 v65, v81, v65
    v_cvt_pk_bf16_f32 v66, v82, v66
    v_cvt_pk_bf16_f32 v67, v83, v67
    v_accvgpr_write_b32 a0, v64
    v_accvgpr_write_b32 a1, v65
    v_accvgpr_write_b32 a2, v66
    v_accvgpr_write_b32 a3, v67
    ds_read_b64_tr_b16 a[160:161], v4 offset:33792
    ds_read_b64_tr_b16 a[162:163], v4 offset:34304
    ds_read_b64_tr_b16 a[164:165], v4 offset:33808
    ds_read_b64_tr_b16 a[166:167], v4 offset:34320
    s_waitcnt lgkmcnt(14)
    v_lshlrev_b32 v80, 16, v68
    v_lshlrev_b32 v81, 16, v69
    v_lshlrev_b32 v82, 16, v70
    v_lshlrev_b32 v83, 16, v71
    v_and_b32 v68, s36, v68
    v_and_b32 v69, s36, v69
    v_and_b32 v70, s36, v70
    v_and_b32 v71, s36, v71
    v_mul_f32 v80, s35, v80
    v_mul_f32 v81, s35, v81
    v_mul_f32 v82, s35, v82
    v_mul_f32 v83, s35, v83
    v_mul_f32 v68, s35, v68
    v_mul_f32 v69, s35, v69
    v_mul_f32 v70, s35, v70
    v_mul_f32 v71, s35, v71
    v_cvt_pk_bf16_f32 v68, v80, v68
    v_cvt_pk_bf16_f32 v69, v81, v69
    v_cvt_pk_bf16_f32 v70, v82, v70
    v_cvt_pk_bf16_f32 v71, v83, v71
    v_accvgpr_write_b32 a4, v68
    v_accvgpr_write_b32 a5, v69
    v_accvgpr_write_b32 a6, v70
    v_accvgpr_write_b32 a7, v71
    ds_read_b64_tr_b16 a[168:169], v4 offset:33824
    ds_read_b64_tr_b16 a[170:171], v4 offset:34336
    ds_read_b64_tr_b16 a[172:173], v4 offset:33840
    ds_read_b64_tr_b16 a[174:175], v4 offset:34352
    s_waitcnt lgkmcnt(15)
    v_lshlrev_b32 v80, 16, v72
    v_lshlrev_b32 v81, 16, v73
    v_lshlrev_b32 v82, 16, v74
    v_lshlrev_b32 v83, 16, v75
    v_and_b32 v72, s36, v72
    v_and_b32 v73, s36, v73
    v_and_b32 v74, s36, v74
    v_and_b32 v75, s36, v75
    v_mul_f32 v80, s35, v80
    v_mul_f32 v81, s35, v81
    v_mul_f32 v82, s35, v82
    v_mul_f32 v83, s35, v83
    v_mul_f32 v72, s35, v72
    v_mul_f32 v73, s35, v73
    v_mul_f32 v74, s35, v74
    v_mul_f32 v75, s35, v75
    v_cvt_pk_bf16_f32 v72, v80, v72
    v_cvt_pk_bf16_f32 v73, v81, v73
    v_cvt_pk_bf16_f32 v74, v82, v74
    v_cvt_pk_bf16_f32 v75, v83, v75
    v_accvgpr_write_b32 a8, v72
    v_accvgpr_write_b32 a9, v73
    v_accvgpr_write_b32 a10, v74
    v_accvgpr_write_b32 a11, v75
    ds_read_b64_tr_b16 a[176:177], v4 offset:33856
    ds_read_b64_tr_b16 a[178:179], v4 offset:34368
    ds_read_b64_tr_b16 a[180:181], v4 offset:33872
    ds_read_b64_tr_b16 a[182:183], v4 offset:34384
    v_lshlrev_b32 v80, 16, v76
    v_lshlrev_b32 v81, 16, v77
    v_lshlrev_b32 v82, 16, v78
    v_lshlrev_b32 v83, 16, v79
    v_and_b32 v76, s36, v76
    v_and_b32 v77, s36, v77
    v_and_b32 v78, s36, v78
    v_and_b32 v79, s36, v79
    v_mul_f32 v80, s35, v80
    v_mul_f32 v81, s35, v81
    v_mul_f32 v82, s35, v82
    v_mul_f32 v83, s35, v83
    v_mul_f32 v76, s35, v76
    v_mul_f32 v77, s35, v77
    v_mul_f32 v78, s35, v78
    v_mul_f32 v79, s35, v79
    v_cvt_pk_bf16_f32 v76, v80, v76
    v_cvt_pk_bf16_f32 v77, v81, v77
    v_cvt_pk_bf16_f32 v78, v82, v78
    v_cvt_pk_bf16_f32 v79, v83, v79
    v_accvgpr_write_b32 a12, v76
    v_accvgpr_write_b32 a13, v77
    v_accvgpr_write_b32 a14, v78
    v_accvgpr_write_b32 a15, v79
    ds_read_b64_tr_b16 a[184:185], v4 offset:33888
    ds_read_b64_tr_b16 a[186:187], v4 offset:34400
    ds_read_b64_tr_b16 a[188:189], v4 offset:33904
    ds_read_b64_tr_b16 a[190:191], v4 offset:34416
    s_waitcnt lgkmcnt(0)
    s_cmp_eq_u32 s28, 3
    s_cbranch_scc1 L_ROLE_B
    v_mfma_f32_16x16x32_bf16 v[48:51], a[96:99], a[0:3], 0
    s_add_u32 m0, s43, 12288
    s_add_u32 s46, s43, 4294912000
    buffer_load_dwordx4 v11, s[12:15], s46 offen offset:0 nt lds
    v_mfma_f32_16x16x32_bf16 v[48:51], a[100:103], a[4:7], v[48:51]
    buffer_load_dwordx4 v12, s[12:15], s46 offen offset:1024 nt lds
    buffer_load_dwordx4 v13, s[12:15], s46 offen offset:2048 nt lds
    v_mfma_f32_16x16x32_bf16 v[48:51], a[104:107], a[8:11], v[48:51]
    buffer_load_dwordx4 v14, s[12:15], s46 offen offset:3072 nt lds
    v_mfma_f32_16x16x32_bf16 v[48:51], a[108:111], a[12:15], v[48:51]
    s_waitcnt vmcnt(8)
    ds_read_b128 v[24:27], v5 offset:4096
    v_mfma_f32_16x16x32_bf16 v[52:55], a[124:127], a[12:15], 0
    ds_read_b128 v[28:31], v6 offset:4096
    v_mfma_f32_16x16x32_bf16 v[52:55], a[120:123], a[8:11], v[52:55]
    s_waitcnt lgkmcnt(1)
    v_lshlrev_b32 v32, 16, v24
    v_and_b32 v24, s36, v24
    v_mul_f32 v32, s35, v32
    v_mul_f32 v24, s35, v24
    v_cvt_pk_bf16_f32 v24, v32, v24
    v_accvgpr_write_b32 a16, v24
    v_lshlrev_b32 v33, 16, v25
    v_and_b32 v25, s36, v25
    v_mul_f32 v33, s35, v33
    v_mul_f32 v25, s35, v25
    v_cvt_pk_bf16_f32 v25, v33, v25
    v_accvgpr_write_b32 a17, v25
    v_lshlrev_b32 v32, 16, v26
    v_and_b32 v26, s36, v26
    v_mul_f32 v32, s35, v32
    v_mul_f32 v26, s35, v26
    v_cvt_pk_bf16_f32 v26, v32, v26
    v_accvgpr_write_b32 a18, v26
    v_lshlrev_b32 v33, 16, v27
    v_and_b32 v27, s36, v27
    v_mul_f32 v33, s35, v33
    v_mul_f32 v27, s35, v27
    v_cvt_pk_bf16_f32 v27, v33, v27
    v_accvgpr_write_b32 a19, v27
    v_mfma_f32_16x16x32_bf16 v[52:55], a[116:119], a[4:7], v[52:55]
    s_waitcnt lgkmcnt(0)
    ds_read_b128 v[24:27], v7 offset:4096
    v_lshlrev_b32 v32, 16, v28
    v_and_b32 v28, s36, v28
    v_mul_f32 v32, s35, v32
    v_mul_f32 v28, s35, v28
    v_cvt_pk_bf16_f32 v28, v32, v28
    v_accvgpr_write_b32 a20, v28
    v_lshlrev_b32 v33, 16, v29
    v_and_b32 v29, s36, v29
    v_mul_f32 v33, s35, v33
    v_mul_f32 v29, s35, v29
    v_cvt_pk_bf16_f32 v29, v33, v29
    v_accvgpr_write_b32 a21, v29
    v_lshlrev_b32 v32, 16, v30
    v_and_b32 v30, s36, v30
    v_mul_f32 v32, s35, v32
    v_mul_f32 v30, s35, v30
    v_cvt_pk_bf16_f32 v30, v32, v30
    v_accvgpr_write_b32 a22, v30
    v_lshlrev_b32 v33, 16, v31
    v_and_b32 v31, s36, v31
    v_mul_f32 v33, s35, v33
    v_mul_f32 v31, s35, v31
    v_cvt_pk_bf16_f32 v31, v33, v31
    v_accvgpr_write_b32 a23, v31
    v_mfma_f32_16x16x32_bf16 v[52:55], a[112:115], a[0:3], v[52:55]
    ds_read_b128 v[28:31], v8 offset:4096
    v_exp_f32 v49, v49
    v_mfma_f32_16x16x32_bf16 v[56:59], a[96:99], a[16:19], 0
    s_waitcnt lgkmcnt(1)
    v_lshlrev_b32 v32, 16, v24
    v_and_b32 v24, s36, v24
    v_mul_f32 v32, s35, v32
    v_mul_f32 v24, s35, v24
    v_cvt_pk_bf16_f32 v24, v32, v24
    v_accvgpr_write_b32 a24, v24
    v_lshlrev_b32 v33, 16, v25
    v_and_b32 v25, s36, v25
    v_mul_f32 v33, s35, v33
    v_mul_f32 v25, s35, v25
    v_cvt_pk_bf16_f32 v25, v33, v25
    v_accvgpr_write_b32 a25, v25
    v_lshlrev_b32 v32, 16, v26
    v_and_b32 v26, s36, v26
    v_mul_f32 v32, s35, v32
    v_mul_f32 v26, s35, v26
    v_cvt_pk_bf16_f32 v26, v32, v26
    v_accvgpr_write_b32 a26, v26
    v_lshlrev_b32 v33, 16, v27
    v_and_b32 v27, s36, v27
    v_mul_f32 v33, s35, v33
    v_mul_f32 v27, s35, v27
    v_cvt_pk_bf16_f32 v27, v33, v27
    v_accvgpr_write_b32 a27, v27
    s_add_u32 m0, s43, 16384
    s_add_u32 s46, s43, 4294916096
    buffer_load_dwordx4 v11, s[12:15], s46 offen offset:0 nt lds
    v_exp_f32 v51, v51
    v_mfma_f32_16x16x32_bf16 v[56:59], a[100:103], a[20:23], v[56:59]
    s_waitcnt lgkmcnt(0)
    v_lshlrev_b32 v32, 16, v28
    v_and_b32 v28, s36, v28
    v_mul_f32 v32, s35, v32
    v_mul_f32 v28, s35, v28
    v_cvt_pk_bf16_f32 v28, v32, v28
    v_accvgpr_write_b32 a28, v28
    v_lshlrev_b32 v33, 16, v29
    v_and_b32 v29, s36, v29
    v_mul_f32 v33, s35, v33
    v_mul_f32 v29, s35, v29
    v_cvt_pk_bf16_f32 v29, v33, v29
    v_accvgpr_write_b32 a29, v29
    v_lshlrev_b32 v32, 16, v30
    v_and_b32 v30, s36, v30
    v_mul_f32 v32, s35, v32
    v_mul_f32 v30, s35, v30
    v_cvt_pk_bf16_f32 v30, v32, v30
    v_accvgpr_write_b32 a30, v30
    v_lshlrev_b32 v33, 16, v31
    v_and_b32 v31, s36, v31
    v_mul_f32 v33, s35, v33
    v_mul_f32 v31, s35, v31
    v_cvt_pk_bf16_f32 v31, v33, v31
    v_accvgpr_write_b32 a31, v31
    v_exp_f32 v50, v50
    v_exp_f32 v55, v55
    v_mfma_f32_16x16x32_bf16 v[56:59], a[104:107], a[24:27], v[56:59]
    v_exp_f32 v52, v52
    v_cvt_pk_bf16_f32 v41, v50, v51
    v_mfma_f32_16x16x32_bf16 v[56:59], a[108:111], a[28:31], v[56:59]
    v_exp_f32 v54, v54
    v_mfma_f32_16x16x32_bf16 v[60:63], a[124:127], a[28:31], 0
    buffer_load_dwordx4 v12, s[12:15], s46 offen offset:1024 nt lds
    buffer_load_dwordx4 v13, s[12:15], s46 offen offset:2048 nt lds
    v_exp_f32 v53, v53
    v_cvt_pk_bf16_f32 v43, v54, v55
    v_mfma_f32_16x16x32_bf16 v[60:63], a[120:123], a[24:27], v[60:63]
    buffer_load_dwordx4 v14, s[12:15], s46 offen offset:3072 nt lds
    v_exp_f32 v48, v48
    v_cvt_pk_bf16_f32 v42, v52, v53
    v_mfma_f32_16x16x32_bf16 v[60:63], a[116:119], a[20:23], v[60:63]
    v_cvt_pk_bf16_f32 v40, v48, v49
    v_exp_f32 v59, v59
    v_mfma_f32_16x16x32_bf16 v[60:63], a[112:115], a[16:19], v[60:63]
    v_exp_f32 v57, v57
    v_mfma_f32_16x16x32_bf16 v[64:67], v[40:43], a[160:163], 0
    s_waitcnt vmcnt(8)
    ds_read_b128 v[24:27], v5 offset:8192
    ds_read_b128 v[28:31], v6 offset:8192
    v_exp_f32 v56, v56
    v_mfma_f32_16x16x32_bf16 v[68:71], v[40:43], a[164:167], 0
    s_add_u32 m0, s43, 20480
    s_add_u32 s46, s43, 4294920192
    buffer_load_dwordx4 v11, s[12:15], s46 offen offset:0 nt lds
    v_mfma_f32_16x16x32_bf16 v[72:75], v[40:43], a[168:171], 0
    s_waitcnt lgkmcnt(1)
    v_lshlrev_b32 v32, 16, v24
    v_mul_f32 v32, s35, v32
    v_lshlrev_b32 v33, 16, v25
    v_and_b32 v25, s36, v25
    v_mul_f32 v25, s35, v25
    v_mfma_f32_16x16x32_bf16 v[76:79], v[40:43], a[172:175], 0
    v_and_b32 v24, s36, v24
    v_mul_f32 v24, s35, v24
    v_cvt_pk_bf16_f32 v24, v32, v24
    v_accvgpr_write_b32 a32, v24
    v_mul_f32 v33, s35, v33
    v_cvt_pk_bf16_f32 v25, v33, v25
    v_lshlrev_b32 v32, 16, v26
    v_lshlrev_b32 v33, 16, v27
    v_mul_f32 v33, s35, v33
    v_exp_f32 v61, v61
    v_mfma_f32_16x16x32_bf16 v[80:83], v[40:43], a[176:179], 0
    s_waitcnt lgkmcnt(0)
    v_and_b32 v26, s36, v26
    v_mul_f32 v32, s35, v32
    v_mul_f32 v26, s35, v26
    v_cvt_pk_bf16_f32 v26, v32, v26
    v_and_b32 v27, s36, v27
    v_mfma_f32_16x16x32_bf16 v[84:87], v[40:43], a[180:183], 0
    v_accvgpr_write_b32 a33, v25
    v_accvgpr_write_b32 a34, v26
    v_mul_f32 v27, s35, v27
    v_cvt_pk_bf16_f32 v27, v33, v27
    v_accvgpr_write_b32 a35, v27
    v_lshlrev_b32 v32, 16, v28
    v_and_b32 v28, s36, v28
    v_mul_f32 v32, s35, v32
    v_mul_f32 v28, s35, v28
    v_cvt_pk_bf16_f32 v28, v32, v28
    v_accvgpr_write_b32 a36, v28
    v_lshlrev_b32 v33, 16, v29
    v_and_b32 v29, s36, v29
    v_mul_f32 v33, s35, v33
    v_mul_f32 v29, s35, v29
    v_cvt_pk_bf16_f32 v29, v33, v29
    v_lshlrev_b32 v32, 16, v30
    v_and_b32 v30, s36, v30
    v_mul_f32 v32, s35, v32
    v_lshlrev_b32 v33, 16, v31
    v_and_b32 v31, s36, v31
    v_mul_f32 v33, s35, v33
    v_mul_f32 v31, s35, v31
    v_cvt_pk_bf16_f32 v31, v33, v31
    v_mfma_f32_16x16x32_bf16 v[88:91], v[40:43], a[184:187], 0
    ds_read_b128 v[24:27], v7 offset:8192
    v_accvgpr_write_b32 a37, v29
    v_mul_f32 v30, s35, v30
    v_cvt_pk_bf16_f32 v30, v32, v30
    v_accvgpr_write_b32 a38, v30
    v_accvgpr_write_b32 a39, v31
    v_mfma_f32_16x16x32_bf16 v[92:95], v[40:43], a[188:191], 0
    ds_read_b128 v[28:31], v8 offset:8192
    v_exp_f32 v58, v58
    v_exp_f32 v63, v63
    v_mfma_f32_16x16x32_bf16 v[48:51], a[96:99], a[32:35], 0
    s_waitcnt lgkmcnt(1)
    v_lshlrev_b32 v32, 16, v24
    v_and_b32 v24, s36, v24
    v_mul_f32 v32, s35, v32
    v_mul_f32 v24, s35, v24
    v_cvt_pk_bf16_f32 v24, v32, v24
    v_accvgpr_write_b32 a40, v24
    v_lshlrev_b32 v33, 16, v25
    v_and_b32 v25, s36, v25
    v_mul_f32 v33, s35, v33
    v_mul_f32 v25, s35, v25
    v_cvt_pk_bf16_f32 v25, v33, v25
    v_accvgpr_write_b32 a41, v25
    v_lshlrev_b32 v32, 16, v26
    v_and_b32 v26, s36, v26
    v_mul_f32 v32, s35, v32
    v_mul_f32 v26, s35, v26
    v_cvt_pk_bf16_f32 v26, v32, v26
    v_accvgpr_write_b32 a42, v26
    v_lshlrev_b32 v33, 16, v27
    v_and_b32 v27, s36, v27
    v_mul_f32 v33, s35, v33
    v_mul_f32 v27, s35, v27
    v_cvt_pk_bf16_f32 v27, v33, v27
    v_accvgpr_write_b32 a43, v27
    v_mfma_f32_16x16x32_bf16 v[48:51], a[100:103], a[36:39], v[48:51]
    s_waitcnt lgkmcnt(0)
    v_lshlrev_b32 v32, 16, v28
    v_and_b32 v28, s36, v28
    v_mul_f32 v32, s35, v32
    v_mul_f32 v28, s35, v28
    v_cvt_pk_bf16_f32 v28, v32, v28
    v_accvgpr_write_b32 a44, v28
    v_lshlrev_b32 v33, 16, v29
    v_and_b32 v29, s36, v29
    v_mul_f32 v33, s35, v33
    v_mul_f32 v29, s35, v29
    v_cvt_pk_bf16_f32 v29, v33, v29
    v_accvgpr_write_b32 a45, v29
    v_lshlrev_b32 v32, 16, v30
    v_and_b32 v30, s36, v30
    v_mul_f32 v32, s35, v32
    v_mul_f32 v30, s35, v30
    v_cvt_pk_bf16_f32 v30, v32, v30
    v_accvgpr_write_b32 a46, v30
    v_lshlrev_b32 v33, 16, v31
    v_and_b32 v31, s36, v31
    v_mul_f32 v33, s35, v33
    v_mul_f32 v31, s35, v31
    v_cvt_pk_bf16_f32 v31, v33, v31
    v_accvgpr_write_b32 a47, v31
    v_cvt_pk_bf16_f32 v44, v56, v57
    v_cvt_pk_bf16_f32 v45, v58, v59
    v_mfma_f32_16x16x32_bf16 v[48:51], a[104:107], a[40:43], v[48:51]
    buffer_load_dwordx4 v12, s[12:15], s46 offen offset:1024 nt lds
    v_mfma_f32_16x16x32_bf16 v[48:51], a[108:111], a[44:47], v[48:51]
    v_exp_f32 v62, v62
    v_mfma_f32_16x16x32_bf16 v[52:55], a[124:127], a[44:47], 0
    v_exp_f32 v60, v60
    v_mfma_f32_16x16x32_bf16 v[52:55], a[120:123], a[40:43], v[52:55]
    buffer_load_dwordx4 v13, s[12:15], s46 offen offset:2048 nt lds
    v_mfma_f32_16x16x32_bf16 v[52:55], a[116:119], a[36:39], v[52:55]
    v_cvt_pk_bf16_f32 v46, v60, v61
    v_cvt_pk_bf16_f32 v47, v62, v63
    v_mfma_f32_16x16x32_bf16 v[52:55], a[112:115], a[32:35], v[52:55]
    buffer_load_dwordx4 v14, s[12:15], s46 offen offset:3072 nt lds
    v_smfmac_f32_16x16x64_bf16 a[224:227], a[248:251], v[40:47], v19
    v_exp_f32 v49, v49
    v_mfma_f32_16x16x32_bf16 v[96:99], v[44:47], a[160:163], 0
    s_waitcnt vmcnt(8)
    ds_read_b128 v[24:27], v5 offset:12288
    ds_read_b128 v[28:31], v6 offset:12288
    v_exp_f32 v48, v48
    v_mfma_f32_16x16x32_bf16 v[100:103], v[44:47], a[164:167], 0
    v_exp_f32 v54, v54
    v_mfma_f32_16x16x32_bf16 v[104:107], v[44:47], a[168:171], 0
    s_waitcnt lgkmcnt(1)
    v_lshlrev_b32 v32, 16, v24
    v_and_b32 v24, s36, v24
    v_mul_f32 v24, s35, v24
    v_lshlrev_b32 v33, 16, v25
    v_and_b32 v25, s36, v25
    v_exp_f32 v51, v51
    v_mfma_f32_16x16x32_bf16 v[108:111], v[44:47], a[172:175], 0
    s_waitcnt lgkmcnt(0)
    v_mul_f32 v32, s35, v32
    v_cvt_pk_bf16_f32 v24, v32, v24
    v_mul_f32 v33, s35, v33
    v_mul_f32 v25, s35, v25
    v_cvt_pk_bf16_f32 v25, v33, v25
    v_lshlrev_b32 v32, 16, v26
    v_and_b32 v26, s36, v26
    v_mul_f32 v32, s35, v32
    v_mul_f32 v26, s35, v26
    v_cvt_pk_bf16_f32 v26, v32, v26
    v_lshlrev_b32 v33, 16, v27
    v_and_b32 v27, s36, v27
    v_mul_f32 v33, s35, v33
    v_mul_f32 v27, s35, v27
    v_cvt_pk_bf16_f32 v27, v33, v27
    v_lshlrev_b32 v32, 16, v28
    v_and_b32 v28, s36, v28
    v_mul_f32 v32, s35, v32
    v_mul_f32 v28, s35, v28
    v_mfma_f32_16x16x32_bf16 v[112:115], v[44:47], a[176:179], 0
    v_accvgpr_write_b32 a48, v24
    v_accvgpr_write_b32 a49, v25
    v_accvgpr_write_b32 a50, v26
    v_accvgpr_write_b32 a51, v27
    v_cvt_pk_bf16_f32 v28, v32, v28
    v_lshlrev_b32 v33, 16, v29
    v_and_b32 v29, s36, v29
    v_mul_f32 v33, s35, v33
    v_mul_f32 v29, s35, v29
    v_lshlrev_b32 v32, 16, v30
    v_mfma_f32_16x16x32_bf16 v[116:119], v[44:47], a[180:183], 0
    ds_read_b128 v[24:27], v7 offset:12288
    v_accvgpr_write_b32 a52, v28
    v_cvt_pk_bf16_f32 v29, v33, v29
    v_accvgpr_write_b32 a53, v29
    v_and_b32 v30, s36, v30
    v_mul_f32 v32, s35, v32
    v_mul_f32 v30, s35, v30
    v_cvt_pk_bf16_f32 v30, v32, v30
    v_accvgpr_write_b32 a54, v30
    v_lshlrev_b32 v33, 16, v31
    v_mfma_f32_16x16x32_bf16 v[120:123], v[44:47], a[184:187], 0
    v_and_b32 v31, s36, v31
    v_mul_f32 v33, s35, v33
    v_mul_f32 v31, s35, v31
    v_cvt_pk_bf16_f32 v31, v33, v31
    v_accvgpr_write_b32 a55, v31
    v_mfma_f32_16x16x32_bf16 v[124:127], v[44:47], a[188:191], 0
    s_waitcnt lgkmcnt(0)
    ds_read_b128 v[28:31], v8 offset:12288
    v_lshlrev_b32 v32, 16, v24
    v_and_b32 v24, s36, v24
    v_mul_f32 v32, s35, v32
    v_mul_f32 v24, s35, v24
    v_cvt_pk_bf16_f32 v24, v32, v24
    v_accvgpr_write_b32 a56, v24
    v_lshlrev_b32 v33, 16, v25
    v_and_b32 v25, s36, v25
    v_lshlrev_b32 v32, 16, v26
    v_mul_f32 v32, s35, v32
    v_cvt_pk_bf16_f32 v40, v48, v49
    v_mfma_f32_16x16x32_bf16 v[56:59], a[96:99], a[48:51], 0
    v_mul_f32 v33, s35, v33
    v_mul_f32 v25, s35, v25
    v_cvt_pk_bf16_f32 v25, v33, v25
    v_accvgpr_write_b32 a57, v25
    v_and_b32 v26, s36, v26
    v_mul_f32 v26, s35, v26
    v_cvt_pk_bf16_f32 v26, v32, v26
    v_accvgpr_write_b32 a58, v26
    v_lshlrev_b32 v33, 16, v27
    v_and_b32 v27, s36, v27
    v_mul_f32 v33, s35, v33
    v_mul_f32 v27, s35, v27
    v_cvt_pk_bf16_f32 v27, v33, v27
    v_accvgpr_write_b32 a59, v27
    v_mfma_f32_16x16x32_bf16 v[56:59], a[100:103], a[52:55], v[56:59]
    s_waitcnt lgkmcnt(0)
    v_lshlrev_b32 v32, 16, v28
    v_and_b32 v28, s36, v28
    v_mul_f32 v32, s35, v32
    v_mul_f32 v28, s35, v28
    v_cvt_pk_bf16_f32 v28, v32, v28
    v_accvgpr_write_b32 a60, v28
    v_lshlrev_b32 v33, 16, v29
    v_and_b32 v29, s36, v29
    v_mul_f32 v33, s35, v33
    v_mul_f32 v29, s35, v29
    v_cvt_pk_bf16_f32 v29, v33, v29
    v_accvgpr_write_b32 a61, v29
    v_lshlrev_b32 v32, 16, v30
    v_and_b32 v30, s36, v30
    v_mul_f32 v32, s35, v32
    v_mul_f32 v30, s35, v30
    v_cvt_pk_bf16_f32 v30, v32, v30
    v_accvgpr_write_b32 a62, v30
    v_lshlrev_b32 v33, 16, v31
    v_and_b32 v31, s36, v31
    v_mul_f32 v33, s35, v33
    v_mul_f32 v31, s35, v31
    v_cvt_pk_bf16_f32 v31, v33, v31
    v_accvgpr_write_b32 a63, v31
    v_mfma_f32_16x16x32_bf16 v[56:59], a[104:107], a[56:59], v[56:59]
    v_exp_f32 v50, v50
    v_exp_f32 v52, v52
    v_mfma_f32_16x16x32_bf16 v[56:59], a[108:111], a[60:63], v[56:59]
    v_exp_f32 v55, v55
    v_mfma_f32_16x16x32_bf16 v[60:63], a[124:127], a[60:63], 0
    v_exp_f32 v53, v53
    v_mfma_f32_16x16x32_bf16 v[60:63], a[120:123], a[56:59], v[60:63]
    v_cvt_pk_bf16_f32 v41, v50, v51
    v_cvt_pk_bf16_f32 v42, v52, v53
    v_cvt_pk_bf16_f32 v43, v54, v55
    v_mfma_f32_16x16x32_bf16 v[60:63], a[116:119], a[52:55], v[60:63]
    v_exp_f32 v59, v59
    v_mfma_f32_16x16x32_bf16 v[60:63], a[112:115], a[48:51], v[60:63]
    v_exp_f32 v56, v56
    v_mfma_f32_16x16x32_bf16 v[128:131], v[40:43], a[160:163], 0
    s_waitcnt vmcnt(4)
    ds_read_b128 v[24:27], v5 offset:16384
    v_exp_f32 v58, v58
    v_mfma_f32_16x16x32_bf16 v[132:135], v[40:43], a[164:167], 0
    ds_read_b128 v[28:31], v6 offset:16384
    v_exp_f32 v62, v62
    v_mfma_f32_16x16x32_bf16 v[136:139], v[40:43], a[168:171], 0
    s_waitcnt lgkmcnt(1)
    v_lshlrev_b32 v32, 16, v24
    v_and_b32 v24, s36, v24
    v_lshlrev_b32 v33, 16, v25
    v_and_b32 v25, s36, v25
    v_mul_f32 v33, s35, v33
    v_mfma_f32_16x16x32_bf16 v[140:143], v[40:43], a[172:175], 0
    v_mul_f32 v32, s35, v32
    v_mul_f32 v24, s35, v24
    v_cvt_pk_bf16_f32 v24, v32, v24
    v_accvgpr_write_b32 a64, v24
    v_mul_f32 v25, s35, v25
    v_mfma_f32_16x16x32_bf16 v[144:147], v[40:43], a[176:179], 0
    s_waitcnt lgkmcnt(0)
    v_cvt_pk_bf16_f32 v25, v33, v25
    v_accvgpr_write_b32 a65, v25
    v_lshlrev_b32 v32, 16, v26
    v_and_b32 v26, s36, v26
    v_mul_f32 v32, s35, v32
    v_mul_f32 v26, s35, v26
    v_cvt_pk_bf16_f32 v26, v32, v26
    v_accvgpr_write_b32 a66, v26
    v_lshlrev_b32 v33, 16, v27
    v_and_b32 v27, s36, v27
    v_mul_f32 v33, s35, v33
    v_mul_f32 v27, s35, v27
    v_cvt_pk_bf16_f32 v27, v33, v27
    v_accvgpr_write_b32 a67, v27
    v_lshlrev_b32 v32, 16, v28
    v_and_b32 v28, s36, v28
    v_mul_f32 v32, s35, v32
    v_lshlrev_b32 v33, 16, v29
    v_and_b32 v29, s36, v29
    v_exp_f32 v57, v57
    v_exp_f32 v61, v61
    v_mfma_f32_16x16x32_bf16 v[148:151], v[40:43], a[180:183], 0
    ds_read_b128 v[24:27], v7 offset:16384
    v_mul_f32 v28, s35, v28
    v_mul_f32 v29, s35, v29
    v_mfma_f32_16x16x32_bf16 v[152:155], v[40:43], a[184:187], 0
    v_cvt_pk_bf16_f32 v28, v32, v28
    v_accvgpr_write_b32 a68, v28
    v_mul_f32 v33, s35, v33
    v_cvt_pk_bf16_f32 v29, v33, v29
    v_accvgpr_write_b32 a69, v29
    v_lshlrev_b32 v32, 16, v30
    v_and_b32 v30, s36, v30
    v_mul_f32 v32, s35, v32
    v_mul_f32 v30, s35, v30
    v_cvt_pk_bf16_f32 v30, v32, v30
    v_accvgpr_write_b32 a70, v30
    v_lshlrev_b32 v33, 16, v31
    v_and_b32 v31, s36, v31
    v_mul_f32 v33, s35, v33
    v_mul_f32 v31, s35, v31
    v_cvt_pk_bf16_f32 v31, v33, v31
    v_accvgpr_write_b32 a71, v31
    v_mfma_f32_16x16x32_bf16 v[156:159], v[40:43], a[188:191], 0
    s_waitcnt lgkmcnt(0)
    ds_read_b128 v[28:31], v8 offset:16384
    v_lshlrev_b32 v32, 16, v24
    v_and_b32 v24, s36, v24
    v_mul_f32 v32, s35, v32
    v_mul_f32 v24, s35, v24
    v_cvt_pk_bf16_f32 v24, v32, v24
    v_lshlrev_b32 v33, 16, v25
    v_and_b32 v25, s36, v25
    v_mul_f32 v33, s35, v33
    v_mul_f32 v25, s35, v25
    v_lshlrev_b32 v32, 16, v26
    v_mul_f32 v32, s35, v32
    v_mfma_f32_16x16x32_bf16 v[48:51], a[96:99], a[64:67], 0
    v_accvgpr_write_b32 a72, v24
    v_cvt_pk_bf16_f32 v25, v33, v25
    v_accvgpr_write_b32 a73, v25
    v_and_b32 v26, s36, v26
    v_mul_f32 v26, s35, v26
    v_cvt_pk_bf16_f32 v26, v32, v26
    v_accvgpr_write_b32 a74, v26
    v_lshlrev_b32 v33, 16, v27
    v_and_b32 v27, s36, v27
    v_mul_f32 v33, s35, v33
    v_mul_f32 v27, s35, v27
    v_cvt_pk_bf16_f32 v27, v33, v27
    v_accvgpr_write_b32 a75, v27
    v_mfma_f32_16x16x32_bf16 v[48:51], a[100:103], a[68:71], v[48:51]
    s_waitcnt lgkmcnt(0)
    v_lshlrev_b32 v32, 16, v28
    v_and_b32 v28, s36, v28
    v_mul_f32 v32, s35, v32
    v_mul_f32 v28, s35, v28
    v_cvt_pk_bf16_f32 v28, v32, v28
    v_accvgpr_write_b32 a76, v28
    v_lshlrev_b32 v33, 16, v29
    v_and_b32 v29, s36, v29
    v_mul_f32 v33, s35, v33
    v_mul_f32 v29, s35, v29
    v_cvt_pk_bf16_f32 v29, v33, v29
    v_accvgpr_write_b32 a77, v29
    v_lshlrev_b32 v32, 16, v30
    v_and_b32 v30, s36, v30
    v_mul_f32 v32, s35, v32
    v_mul_f32 v30, s35, v30
    v_cvt_pk_bf16_f32 v30, v32, v30
    v_accvgpr_write_b32 a78, v30
    v_lshlrev_b32 v33, 16, v31
    v_and_b32 v31, s36, v31
    v_mul_f32 v33, s35, v33
    v_mul_f32 v31, s35, v31
    v_cvt_pk_bf16_f32 v31, v33, v31
    v_accvgpr_write_b32 a79, v31
    v_mfma_f32_16x16x32_bf16 v[48:51], a[104:107], a[72:75], v[48:51]
    v_exp_f32 v60, v60
    v_mfma_f32_16x16x32_bf16 v[48:51], a[108:111], a[76:79], v[48:51]
    v_cvt_pk_bf16_f32 v44, v56, v57
    v_cvt_pk_bf16_f32 v46, v60, v61
    v_mfma_f32_16x16x32_bf16 v[52:55], a[124:127], a[76:79], 0
    v_exp_f32 v63, v63
    v_mfma_f32_16x16x32_bf16 v[52:55], a[120:123], a[72:75], v[52:55]
    v_exp_f32 v50, v50
    v_mfma_f32_16x16x32_bf16 v[52:55], a[116:119], a[68:71], v[52:55]
    v_cvt_pk_bf16_f32 v45, v58, v59
    v_cvt_pk_bf16_f32 v47, v62, v63
    v_mfma_f32_16x16x32_bf16 v[52:55], a[112:115], a[64:67], v[52:55]
    v_exp_f32 v51, v51
    v_smfmac_f32_16x16x64_bf16 a[228:231], a[248:251], v[40:47], v19
    v_exp_f32 v48, v48
    v_mfma_f32_16x16x32_bf16 v[160:163], v[44:47], a[160:163], 0
    s_waitcnt vmcnt(0)
    ds_read_b128 v[24:27], v5 offset:20480
    ds_read_b128 v[28:31], v6 offset:20480
    v_exp_f32 v49, v49
    v_mfma_f32_16x16x32_bf16 v[164:167], v[44:47], a[164:167], 0
    v_exp_f32 v52, v52
    v_mfma_f32_16x16x32_bf16 v[168:171], v[44:47], a[168:171], 0
    s_waitcnt lgkmcnt(1)
    v_lshlrev_b32 v32, 16, v24
    v_and_b32 v24, s36, v24
    v_mul_f32 v32, s35, v32
    v_mul_f32 v24, s35, v24
    v_cvt_pk_bf16_f32 v24, v32, v24
    v_lshlrev_b32 v33, 16, v25
    v_and_b32 v25, s36, v25
    v_mul_f32 v33, s35, v33
    v_mul_f32 v25, s35, v25
    v_cvt_pk_bf16_f32 v25, v33, v25
    v_lshlrev_b32 v32, 16, v26
    v_lshlrev_b32 v33, 16, v27
    v_and_b32 v27, s36, v27
    v_cvt_pk_bf16_f32 v41, v50, v51
    v_mfma_f32_16x16x32_bf16 v[172:175], v[44:47], a[172:175], 0
    s_waitcnt lgkmcnt(0)
    v_and_b32 v26, s36, v26
    v_mul_f32 v32, s35, v32
    v_mul_f32 v26, s35, v26
    v_cvt_pk_bf16_f32 v26, v32, v26
    v_mul_f32 v33, s35, v33
    v_mfma_f32_16x16x32_bf16 v[176:179], v[44:47], a[176:179], 0
    v_accvgpr_write_b32 a80, v24
    v_accvgpr_write_b32 a81, v25
    v_accvgpr_write_b32 a82, v26
    v_mul_f32 v27, s35, v27
    v_cvt_pk_bf16_f32 v27, v33, v27
    v_accvgpr_write_b32 a83, v27
    v_lshlrev_b32 v32, 16, v28
    v_lshlrev_b32 v33, 16, v29
    v_and_b32 v29, s36, v29
    v_mul_f32 v33, s35, v33
    v_mfma_f32_16x16x32_bf16 v[180:183], v[44:47], a[180:183], 0
    ds_read_b128 v[24:27], v7 offset:20480
    v_mul_f32 v29, s35, v29
    v_cvt_pk_bf16_f32 v29, v33, v29
    v_lshlrev_b32 v33, 16, v31
    v_and_b32 v31, s36, v31
    v_mul_f32 v31, s35, v31
    v_mfma_f32_16x16x32_bf16 v[184:187], v[44:47], a[184:187], 0
    v_and_b32 v28, s36, v28
    v_mul_f32 v32, s35, v32
    v_mul_f32 v28, s35, v28
    v_cvt_pk_bf16_f32 v28, v32, v28
    v_accvgpr_write_b32 a84, v28
    v_accvgpr_write_b32 a85, v29
    v_lshlrev_b32 v32, 16, v30
    v_and_b32 v30, s36, v30
    v_mul_f32 v32, s35, v32
    v_mul_f32 v30, s35, v30
    v_cvt_pk_bf16_f32 v30, v32, v30
    v_accvgpr_write_b32 a86, v30
    v_mul_f32 v33, s35, v33
    v_cvt_pk_bf16_f32 v31, v33, v31
    v_accvgpr_write_b32 a87, v31
    v_mfma_f32_16x16x32_bf16 v[188:191], v[44:47], a[188:191], 0
    s_waitcnt lgkmcnt(0)
    ds_read_b128 v[28:31], v8 offset:20480
    v_lshlrev_b32 v32, 16, v24
    v_and_b32 v24, s36, v24
    v_mul_f32 v32, s35, v32
    v_mul_f32 v24, s35, v24
    v_cvt_pk_bf16_f32 v24, v32, v24
    v_accvgpr_write_b32 a88, v24
    v_lshlrev_b32 v33, 16, v25
    v_and_b32 v25, s36, v25
    v_mul_f32 v33, s35, v33
    v_mul_f32 v25, s35, v25
    v_cvt_pk_bf16_f32 v25, v33, v25
    v_accvgpr_write_b32 a89, v25
    v_lshlrev_b32 v32, 16, v26
    v_and_b32 v26, s36, v26
    v_mul_f32 v32, s35, v32
    v_mul_f32 v26, s35, v26
    v_cvt_pk_bf16_f32 v26, v32, v26
    v_lshlrev_b32 v33, 16, v27
    v_and_b32 v27, s36, v27
    v_mul_f32 v27, s35, v27
    v_mfma_f32_16x16x32_bf16 v[56:59], a[96:99], a[80:83], 0
    v_accvgpr_write_b32 a90, v26
    v_mul_f32 v33, s35, v33
    v_cvt_pk_bf16_f32 v27, v33, v27
    v_accvgpr_write_b32 a91, v27
    v_mfma_f32_16x16x32_bf16 v[56:59], a[100:103], a[84:87], v[56:59]
    s_waitcnt lgkmcnt(0)
    v_lshlrev_b32 v32, 16, v28
    v_and_b32 v28, s36, v28
    v_mul_f32 v32, s35, v32
    v_mul_f32 v28, s35, v28
    v_cvt_pk_bf16_f32 v28, v32, v28
    v_accvgpr_write_b32 a92, v28
    v_lshlrev_b32 v33, 16, v29
    v_and_b32 v29, s36, v29
    v_mul_f32 v33, s35, v33
    v_mul_f32 v29, s35, v29
    v_cvt_pk_bf16_f32 v29, v33, v29
    v_accvgpr_write_b32 a93, v29
    v_lshlrev_b32 v32, 16, v30
    v_and_b32 v30, s36, v30
    v_mul_f32 v32, s35, v32
    v_mul_f32 v30, s35, v30
    v_cvt_pk_bf16_f32 v30, v32, v30
    v_accvgpr_write_b32 a94, v30
    v_lshlrev_b32 v33, 16, v31
    v_and_b32 v31, s36, v31
    v_mul_f32 v33, s35, v33
    v_mul_f32 v31, s35, v31
    v_cvt_pk_bf16_f32 v31, v33, v31
    v_accvgpr_write_b32 a95, v31
    v_exp_f32 v54, v54
    v_mfma_f32_16x16x32_bf16 v[56:59], a[104:107], a[88:91], v[56:59]
    v_exp_f32 v55, v55
    v_mfma_f32_16x16x32_bf16 v[56:59], a[108:111], a[92:95], v[56:59]
    s_barrier
    ds_read_b128 a[152:155], v3 offset:9088
    v_cvt_pk_bf16_f32 v43, v54, v55
    v_mfma_f32_16x16x32_bf16 v[60:63], a[124:127], a[92:95], 0
    ds_read_b128 a[132:135], v3 offset:8512
    v_cvt_pk_bf16_f32 v40, v48, v49
    v_mfma_f32_16x16x32_bf16 v[60:63], a[120:123], a[88:91], v[60:63]
    v_exp_f32 v53, v53
    v_mfma_f32_16x16x32_bf16 v[60:63], a[116:119], a[84:87], v[60:63]
    ds_read_b128 a[140:143], v3 offset:8640
    v_cvt_pk_bf16_f32 v42, v52, v53
    v_mfma_f32_16x16x32_bf16 v[60:63], a[112:115], a[80:83], v[60:63]
    ds_read_b128 a[136:139], v3 offset:8576
    v_mfma_f32_16x16x32_bf16 v[192:195], v[40:43], a[160:163], 0
    ds_read_b128 a[156:159], v3 offset:9152
    v_mfma_f32_16x16x32_bf16 v[196:199], v[40:43], a[164:167], 0
    v_exp_f32 v63, v63
    v_mfma_f32_16x16x32_bf16 v[200:203], v[40:43], a[168:171], 0
    ds_read_b128 a[128:131], v3 offset:8448
    v_mfma_f32_16x16x32_bf16 v[204:207], v[40:43], a[172:175], 0
    v_exp_f32 v62, v62
    v_mfma_f32_16x16x32_bf16 v[208:211], v[40:43], a[176:179], 0
    ds_read_b64_tr_b16 a[198:199], v4 offset:42768
    v_mfma_f32_16x16x32_bf16 v[212:215], v[40:43], a[180:183], 0
    v_exp_f32 v58, v58
    v_mfma_f32_16x16x32_bf16 v[216:219], v[40:43], a[184:187], 0
    v_exp_f32 v56, v56
    v_mfma_f32_16x16x32_bf16 v[220:223], v[40:43], a[188:191], 0
    s_waitcnt lgkmcnt(1)
    v_exp_f32 v60, v60
    v_mfma_f32_16x16x32_bf16 v[48:51], a[128:131], a[0:3], 0
    v_exp_f32 v61, v61
    v_mfma_f32_16x16x32_bf16 v[48:51], a[132:135], a[4:7], v[48:51]
    ds_read_b128 a[148:151], v3 offset:9024
    v_cvt_pk_bf16_f32 v46, v60, v61
    v_mfma_f32_16x16x32_bf16 v[48:51], a[136:139], a[8:11], v[48:51]
    ds_read_b128 a[144:147], v3 offset:8960
    v_cvt_pk_bf16_f32 v47, v62, v63
    v_mfma_f32_16x16x32_bf16 v[48:51], a[140:143], a[12:15], v[48:51]
    v_exp_f32 v57, v57
    v_mfma_f32_16x16x32_bf16 v[52:55], a[156:159], a[12:15], 0
    v_exp_f32 v59, v59
    v_mfma_f32_16x16x32_bf16 v[52:55], a[152:155], a[8:11], v[52:55]
    s_waitcnt lgkmcnt(1)
    ds_read_b64_tr_b16 a[192:193], v4 offset:42240
    v_cvt_pk_bf16_f32 v44, v56, v57
    v_mfma_f32_16x16x32_bf16 v[52:55], a[148:151], a[4:7], v[52:55]
    s_waitcnt lgkmcnt(1)
    ds_read_b64_tr_b16 a[210:211], v4 offset:42816
    v_cvt_pk_bf16_f32 v45, v58, v59
    v_mfma_f32_16x16x32_bf16 v[52:55], a[144:147], a[0:3], v[52:55]
    ds_read_b64_tr_b16 a[202:203], v4 offset:42784
    v_smfmac_f32_16x16x64_bf16 a[232:235], a[248:251], v[40:47], v19
    ds_read_b64_tr_b16 a[206:207], v4 offset:42800
    v_mfma_f32_16x16x32_bf16 v[224:227], v[44:47], a[160:163], 0
    ds_read_b64_tr_b16 a[194:195], v4 offset:42752
    v_mfma_f32_16x16x32_bf16 v[228:231], v[44:47], a[164:167], 0
    v_exp_f32 v55, v55
    v_mfma_f32_16x16x32_bf16 v[232:235], v[44:47], a[168:171], 0
    v_exp_f32 v48, v48
    v_mfma_f32_16x16x32_bf16 v[236:239], v[44:47], a[172:175], 0
    v_exp_f32 v54, v54
    v_mfma_f32_16x16x32_bf16 v[240:243], v[44:47], a[176:179], 0
    v_exp_f32 v51, v51
    v_mfma_f32_16x16x32_bf16 v[244:247], v[44:47], a[180:183], 0
    v_exp_f32 v53, v53
    v_mfma_f32_16x16x32_bf16 v[248:251], v[44:47], a[184:187], 0
    v_exp_f32 v52, v52
    v_mfma_f32_16x16x32_bf16 v[252:255], v[44:47], a[188:191], 0
    ds_read_b64_tr_b16 a[196:197], v4 offset:42256
    v_cvt_pk_bf16_f32 v42, v52, v53
    v_mfma_f32_16x16x32_bf16 v[56:59], a[128:131], a[16:19], 0
    ds_read_b64_tr_b16 a[218:219], v4 offset:42848
    v_cvt_pk_bf16_f32 v43, v54, v55
    v_mfma_f32_16x16x32_bf16 v[56:59], a[132:135], a[20:23], v[56:59]
    v_exp_f32 v50, v50
    v_mfma_f32_16x16x32_bf16 v[56:59], a[136:139], a[24:27], v[56:59]
    ds_read_b64_tr_b16 a[200:201], v4 offset:42272
    v_mfma_f32_16x16x32_bf16 v[56:59], a[140:143], a[28:31], v[56:59]
    ds_read_b64_tr_b16 a[212:213], v4 offset:42320
    v_mfma_f32_16x16x32_bf16 v[60:63], a[156:159], a[28:31], 0
    v_exp_f32 v49, v49
    v_mfma_f32_16x16x32_bf16 v[60:63], a[152:155], a[24:27], v[60:63]
    ds_read_b64_tr_b16 a[204:205], v4 offset:42288
    v_cvt_pk_bf16_f32 v40, v48, v49
    v_mfma_f32_16x16x32_bf16 v[60:63], a[148:151], a[20:23], v[60:63]
    ds_read_b64_tr_b16 a[220:221], v4 offset:42352
    v_cvt_pk_bf16_f32 v41, v50, v51
    v_mfma_f32_16x16x32_bf16 v[60:63], a[144:147], a[16:19], v[60:63]
    s_waitcnt lgkmcnt(6)
    ds_read_b64_tr_b16 a[208:209], v4 offset:42304
    v_mfma_f32_16x16x32_bf16 v[64:67], v[40:43], a[192:195], v[64:67]
    s_waitcnt lgkmcnt(6)
    ds_read_b64_tr_b16 a[214:215], v4 offset:42832
    v_mfma_f32_16x16x32_bf16 v[68:71], v[40:43], a[196:199], v[68:71]
    s_waitcnt lgkmcnt(5)
    ds_read_b64_tr_b16 a[216:217], v4 offset:42336
    v_mfma_f32_16x16x32_bf16 v[72:75], v[40:43], a[200:203], v[72:75]
    s_waitcnt lgkmcnt(4)
    ds_read_b64_tr_b16 a[222:223], v4 offset:42864
    v_mfma_f32_16x16x32_bf16 v[76:79], v[40:43], a[204:207], v[76:79]
    s_waitcnt lgkmcnt(3)
    v_exp_f32 v61, v61
    v_mfma_f32_16x16x32_bf16 v[80:83], v[40:43], a[208:211], v[80:83]
    s_waitcnt lgkmcnt(2)
    v_exp_f32 v59, v59
    v_mfma_f32_16x16x32_bf16 v[84:87], v[40:43], a[212:215], v[84:87]
    s_waitcnt lgkmcnt(1)
    v_exp_f32 v58, v58
    v_mfma_f32_16x16x32_bf16 v[88:91], v[40:43], a[216:219], v[88:91]
    s_waitcnt lgkmcnt(0)
    v_exp_f32 v63, v63
    v_mfma_f32_16x16x32_bf16 v[92:95], v[40:43], a[220:223], v[92:95]
    v_exp_f32 v60, v60
    v_mfma_f32_16x16x32_bf16 v[48:51], a[128:131], a[32:35], 0
    v_exp_f32 v62, v62
    v_mfma_f32_16x16x32_bf16 v[48:51], a[132:135], a[36:39], v[48:51]
    v_exp_f32 v56, v56
    v_mfma_f32_16x16x32_bf16 v[48:51], a[136:139], a[40:43], v[48:51]
    v_cvt_pk_bf16_f32 v47, v62, v63
    v_mfma_f32_16x16x32_bf16 v[48:51], a[140:143], a[44:47], v[48:51]
    v_cvt_pk_bf16_f32 v45, v58, v59
    v_mfma_f32_16x16x32_bf16 v[52:55], a[156:159], a[44:47], 0
    v_exp_f32 v57, v57
    v_mfma_f32_16x16x32_bf16 v[52:55], a[152:155], a[40:43], v[52:55]
    v_cvt_pk_bf16_f32 v46, v60, v61
    v_mfma_f32_16x16x32_bf16 v[52:55], a[148:151], a[36:39], v[52:55]
    v_cvt_pk_bf16_f32 v44, v56, v57
    v_mfma_f32_16x16x32_bf16 v[52:55], a[144:147], a[32:35], v[52:55]
.p2align 5
L_A1:
    v_smfmac_f32_16x16x64_bf16 a[224:227], a[248:251], v[40:47], v19
    s_xor_b32 s30, s30, 16896
    s_add_u32 s40, s40, 1024
    v_add_u32 v3, s30, v1
    v_mfma_f32_16x16x32_bf16 v[96:99], v[44:47], a[192:195], v[96:99]
    s_add_u32 s29, s29, 2
    v_exp_f32 v48, v48
    v_mfma_f32_16x16x32_bf16 v[100:103], v[44:47], a[196:199], v[100:103]
    v_exp_f32 v49, v49
    v_mfma_f32_16x16x32_bf16 v[104:107], v[44:47], a[200:203], v[104:107]
    v_exp_f32 v50, v50
    v_mfma_f32_16x16x32_bf16 v[108:111], v[44:47], a[204:207], v[108:111]
    v_exp_f32 v51, v51
    v_mfma_f32_16x16x32_bf16 v[112:115], v[44:47], a[208:211], v[112:115]
    v_exp_f32 v52, v52
    v_mfma_f32_16x16x32_bf16 v[116:119], v[44:47], a[212:215], v[116:119]
    v_exp_f32 v53, v53
    v_mfma_f32_16x16x32_bf16 v[120:123], v[44:47], a[216:219], v[120:123]
    v_exp_f32 v54, v54
    v_mfma_f32_16x16x32_bf16 v[124:127], v[44:47], a[220:223], v[124:127]
    v_exp_f32 v55, v55
    v_mfma_f32_16x16x32_bf16 v[56:59], a[128:131], a[48:51], 0
    v_cvt_pk_bf16_f32 v40, v48, v49
    v_cvt_pk_bf16_f32 v41, v50, v51
    v_mfma_f32_16x16x32_bf16 v[56:59], a[132:135], a[52:55], v[56:59]
    v_cvt_pk_bf16_f32 v42, v52, v53
    v_cvt_pk_bf16_f32 v43, v54, v55
    v_mfma_f32_16x16x32_bf16 v[56:59], a[136:139], a[56:59], v[56:59]
    s_cmp_lt_u32 s40, s44
    s_cselect_b32 s41, s40, 94208
    v_add_u32 v4, s30, v2
    v_mfma_f32_16x16x32_bf16 v[56:59], a[140:143], a[60:63], v[56:59]
    s_add_u32 s41, s41, s43
    v_add_u32 v9, s41, v20
    v_mfma_f32_16x16x32_bf16 v[60:63], a[156:159], a[60:63], 0
    ds_read2st64_b32 v[24:25], v9 offset0:0 offset1:1
    v_mfma_f32_16x16x32_bf16 v[60:63], a[152:155], a[56:59], v[60:63]
    v_exp_f32 v56, v56
    v_mfma_f32_16x16x32_bf16 v[60:63], a[148:151], a[52:55], v[60:63]
    v_exp_f32 v57, v57
    v_mfma_f32_16x16x32_bf16 v[60:63], a[144:147], a[48:51], v[60:63]
    v_exp_f32 v58, v58
    v_mfma_f32_16x16x32_bf16 v[128:131], v[40:43], a[192:195], v[128:131]
    v_exp_f32 v59, v59
    v_mfma_f32_16x16x32_bf16 v[132:135], v[40:43], a[196:199], v[132:135]
    s_waitcnt lgkmcnt(0)
    v_exp_f32 v60, v60
    v_mfma_f32_16x16x32_bf16 v[136:139], v[40:43], a[200:203], v[136:139]
    v_exp_f32 v61, v61
    v_mfma_f32_16x16x32_bf16 v[140:143], v[40:43], a[204:207], v[140:143]
    v_exp_f32 v62, v62
    v_mfma_f32_16x16x32_bf16 v[144:147], v[40:43], a[208:211], v[144:147]
    v_exp_f32 v63, v63
    v_mfma_f32_16x16x32_bf16 v[148:151], v[40:43], a[212:215], v[148:151]
    v_cvt_pk_bf16_f32 v44, v56, v57
    v_cvt_pk_bf16_f32 v45, v58, v59
    v_mfma_f32_16x16x32_bf16 v[152:155], v[40:43], a[216:219], v[152:155]
    v_cvt_pk_bf16_f32 v46, v60, v61
    v_cvt_pk_bf16_f32 v47, v62, v63
    v_mfma_f32_16x16x32_bf16 v[156:159], v[40:43], a[220:223], v[156:159]
    ds_read2st64_b32 v[26:27], v9 offset0:2 offset1:3
    v_lshlrev_b32 v28, 16, v24
    v_mfma_f32_16x16x32_bf16 v[48:51], a[128:131], a[64:67], 0
    v_and_b32 v24, s36, v24
    v_mul_f32 v28, s35, v28
    v_mfma_f32_16x16x32_bf16 v[48:51], a[132:135], a[68:71], v[48:51]
    v_mul_f32 v24, s35, v24
    v_cvt_pk_bf16_f32 v24, v28, v24
    v_mfma_f32_16x16x32_bf16 v[48:51], a[136:139], a[72:75], v[48:51]
    v_lshlrev_b32 v29, 16, v25
    v_and_b32 v25, s36, v25
    v_mfma_f32_16x16x32_bf16 v[48:51], a[140:143], a[76:79], v[48:51]
    v_mul_f32 v29, s35, v29
    v_mul_f32 v25, s35, v25
    v_mfma_f32_16x16x32_bf16 v[52:55], a[156:159], a[76:79], 0
    s_waitcnt lgkmcnt(0)
    v_cvt_pk_bf16_f32 v25, v29, v25
    v_lshlrev_b32 v30, 16, v26
    v_mfma_f32_16x16x32_bf16 v[52:55], a[152:155], a[72:75], v[52:55]
    v_exp_f32 v48, v48
    v_mfma_f32_16x16x32_bf16 v[52:55], a[148:151], a[68:71], v[52:55]
    v_exp_f32 v49, v49
    v_mfma_f32_16x16x32_bf16 v[52:55], a[144:147], a[64:67], v[52:55]
    v_exp_f32 v50, v50
    v_smfmac_f32_16x16x64_bf16 a[228:231], a[248:251], v[40:47], v19
    s_barrier
    v_mfma_f32_16x16x32_bf16 v[160:163], v[44:47], a[192:195], v[160:163]
    ds_read_b128 a[96:99], v3 offset:0
    v_cvt_pk_bf16_f32 v40, v48, v49
    v_mfma_f32_16x16x32_bf16 v[164:167], v[44:47], a[196:199], v[164:167]
    v_exp_f32 v51, v51
    v_mfma_f32_16x16x32_bf16 v[168:171], v[44:47], a[200:203], v[168:171]
    ds_read_b128 a[100:103], v3 offset:64
    v_cvt_pk_bf16_f32 v41, v50, v51
    v_mfma_f32_16x16x32_bf16 v[172:175], v[44:47], a[204:207], v[172:175]
    v_exp_f32 v52, v52
    v_mfma_f32_16x16x32_bf16 v[176:179], v[44:47], a[208:211], v[176:179]
    ds_read_b128 a[104:107], v3 offset:128
    v_and_b32 v26, s36, v26
    v_mfma_f32_16x16x32_bf16 v[180:183], v[44:47], a[212:215], v[180:183]
    v_exp_f32 v53, v53
    v_mfma_f32_16x16x32_bf16 v[184:187], v[44:47], a[216:219], v[184:187]
    ds_read_b128 a[108:111], v3 offset:192
    v_cvt_pk_bf16_f32 v42, v52, v53
    v_mfma_f32_16x16x32_bf16 v[188:191], v[44:47], a[220:223], v[188:191]
    v_exp_f32 v54, v54
    v_mfma_f32_16x16x32_bf16 v[56:59], a[128:131], a[80:83], 0
    v_exp_f32 v55, v55
    v_mfma_f32_16x16x32_bf16 v[56:59], a[132:135], a[84:87], v[56:59]
    ds_read_b128 a[124:127], v3 offset:704
    v_cvt_pk_bf16_f32 v43, v54, v55
    v_mfma_f32_16x16x32_bf16 v[56:59], a[136:139], a[88:91], v[56:59]
    v_mul_f32 v30, s35, v30
    v_mul_f32 v26, s35, v26
    v_mfma_f32_16x16x32_bf16 v[56:59], a[140:143], a[92:95], v[56:59]
    ds_read_b128 a[120:123], v3 offset:640
    v_cvt_pk_bf16_f32 v26, v30, v26
    v_mfma_f32_16x16x32_bf16 v[60:63], a[156:159], a[92:95], 0
    v_lshlrev_b32 v31, 16, v27
    v_and_b32 v27, s36, v27
    v_mfma_f32_16x16x32_bf16 v[60:63], a[152:155], a[88:91], v[60:63]
    ds_read_b128 a[116:119], v3 offset:576
    v_mul_f32 v31, s35, v31
    v_mfma_f32_16x16x32_bf16 v[60:63], a[148:151], a[84:87], v[60:63]
    v_exp_f32 v56, v56
    v_mfma_f32_16x16x32_bf16 v[60:63], a[144:147], a[80:83], v[60:63]
    ds_read_b128 a[112:115], v3 offset:512
    v_mul_f32 v27, s35, v27
    v_mfma_f32_16x16x32_bf16 v[192:195], v[40:43], a[192:195], v[192:195]
    v_exp_f32 v57, v57
    v_mfma_f32_16x16x32_bf16 v[196:199], v[40:43], a[196:199], v[196:199]
    ds_read_b64_tr_b16 a[160:161], v4 offset:33792
    v_cvt_pk_bf16_f32 v44, v56, v57
    v_mfma_f32_16x16x32_bf16 v[200:203], v[40:43], a[200:203], v[200:203]
    v_exp_f32 v58, v58
    v_mfma_f32_16x16x32_bf16 v[204:207], v[40:43], a[204:207], v[204:207]
    ds_read_b64_tr_b16 a[162:163], v4 offset:34304
    v_cvt_pk_bf16_f32 v27, v31, v27
    v_mfma_f32_16x16x32_bf16 v[208:211], v[40:43], a[208:211], v[208:211]
    v_exp_f32 v59, v59
    v_mfma_f32_16x16x32_bf16 v[212:215], v[40:43], a[212:215], v[212:215]
    ds_read_b64_tr_b16 a[164:165], v4 offset:33808
    v_cvt_pk_bf16_f32 v45, v58, v59
    v_mfma_f32_16x16x32_bf16 v[216:219], v[40:43], a[216:219], v[216:219]
    v_exp_f32 v60, v60
    v_mfma_f32_16x16x32_bf16 v[220:223], v[40:43], a[220:223], v[220:223]
    s_waitcnt lgkmcnt(10)
    ds_read_b64_tr_b16 a[166:167], v4 offset:34320
    v_mfma_f32_16x16x32_bf16 v[48:51], a[96:99], a[0:3], 0
    s_waitcnt lgkmcnt(10)
    v_exp_f32 v61, v61
    v_mfma_f32_16x16x32_bf16 v[48:51], a[100:103], a[4:7], v[48:51]
    s_waitcnt lgkmcnt(9)
    ds_read_b64_tr_b16 a[168:169], v4 offset:33824
    v_cvt_pk_bf16_f32 v46, v60, v61
    v_mfma_f32_16x16x32_bf16 v[48:51], a[104:107], a[8:11], v[48:51]
    s_waitcnt lgkmcnt(9)
    v_exp_f32 v62, v62
    v_mfma_f32_16x16x32_bf16 v[48:51], a[108:111], a[12:15], v[48:51]
    s_waitcnt lgkmcnt(8)
    v_exp_f32 v63, v63
    v_mfma_f32_16x16x32_bf16 v[52:55], a[124:127], a[12:15], 0
    s_waitcnt lgkmcnt(7)
    ds_read_b64_tr_b16 a[170:171], v4 offset:34336
    v_cvt_pk_bf16_f32 v47, v62, v63
    v_mfma_f32_16x16x32_bf16 v[52:55], a[120:123], a[8:11], v[52:55]
    s_waitcnt lgkmcnt(7)
    v_exp_f32 v48, v48
    v_mfma_f32_16x16x32_bf16 v[52:55], a[116:119], a[4:7], v[52:55]
    s_waitcnt lgkmcnt(6)
    ds_read_b64_tr_b16 a[172:173], v4 offset:33840
    v_mfma_f32_16x16x32_bf16 v[52:55], a[112:115], a[0:3], v[52:55]
    v_exp_f32 v49, v49
    v_smfmac_f32_16x16x64_bf16 a[232:235], a[248:251], v[40:47], v19
    ds_read_b64_tr_b16 a[174:175], v4 offset:34352
    v_mfma_f32_16x16x32_bf16 v[224:227], v[44:47], a[192:195], v[224:227]
    v_exp_f32 v50, v50
    v_mfma_f32_16x16x32_bf16 v[228:231], v[44:47], a[196:199], v[228:231]
    ds_read_b64_tr_b16 a[176:177], v4 offset:33856
    v_cvt_pk_bf16_f32 v40, v48, v49
    v_mfma_f32_16x16x32_bf16 v[232:235], v[44:47], a[200:203], v[232:235]
    v_exp_f32 v51, v51
    v_mfma_f32_16x16x32_bf16 v[236:239], v[44:47], a[204:207], v[236:239]
    ds_read_b64_tr_b16 a[178:179], v4 offset:34368
    v_cvt_pk_bf16_f32 v41, v50, v51
    v_mfma_f32_16x16x32_bf16 v[240:243], v[44:47], a[208:211], v[240:243]
    v_exp_f32 v52, v52
    v_mfma_f32_16x16x32_bf16 v[244:247], v[44:47], a[212:215], v[244:247]
    ds_read_b64_tr_b16 a[180:181], v4 offset:33872
    v_mfma_f32_16x16x32_bf16 v[248:251], v[44:47], a[216:219], v[248:251]
    v_exp_f32 v53, v53
    v_mfma_f32_16x16x32_bf16 v[252:255], v[44:47], a[220:223], v[252:255]
    ds_read_b64_tr_b16 a[182:183], v4 offset:34384
    v_cvt_pk_bf16_f32 v42, v52, v53
    v_mfma_f32_16x16x32_bf16 v[56:59], a[96:99], a[16:19], 0
    v_exp_f32 v54, v54
    v_mfma_f32_16x16x32_bf16 v[56:59], a[100:103], a[20:23], v[56:59]
    ds_read_b64_tr_b16 a[184:185], v4 offset:33888
    v_mfma_f32_16x16x32_bf16 v[56:59], a[104:107], a[24:27], v[56:59]
    v_exp_f32 v55, v55
    v_mfma_f32_16x16x32_bf16 v[56:59], a[108:111], a[28:31], v[56:59]
    ds_read_b64_tr_b16 a[186:187], v4 offset:34400
    v_cvt_pk_bf16_f32 v43, v54, v55
    v_mfma_f32_16x16x32_bf16 v[60:63], a[124:127], a[28:31], 0
    ds_write_b32 v9, v24 offset:0
    v_mfma_f32_16x16x32_bf16 v[60:63], a[120:123], a[24:27], v[60:63]
    ds_read_b64_tr_b16 a[188:189], v4 offset:33904
    v_mfma_f32_16x16x32_bf16 v[60:63], a[116:119], a[20:23], v[60:63]
    v_exp_f32 v56, v56
    v_mfma_f32_16x16x32_bf16 v[60:63], a[112:115], a[16:19], v[60:63]
    s_waitcnt lgkmcnt(14)
    ds_read_b64_tr_b16 a[190:191], v4 offset:34416
    v_mfma_f32_16x16x32_bf16 v[64:67], v[40:43], a[160:163], v[64:67]
    s_waitcnt lgkmcnt(13)
    v_exp_f32 v57, v57
    v_mfma_f32_16x16x32_bf16 v[68:71], v[40:43], a[164:167], v[68:71]
    s_waitcnt lgkmcnt(11)
    v_exp_f32 v58, v58
    v_mfma_f32_16x16x32_bf16 v[72:75], v[40:43], a[168:171], v[72:75]
    s_waitcnt lgkmcnt(9)
    v_exp_f32 v59, v59
    v_mfma_f32_16x16x32_bf16 v[76:79], v[40:43], a[172:175], v[76:79]
    s_waitcnt lgkmcnt(7)
    v_exp_f32 v60, v60
    v_mfma_f32_16x16x32_bf16 v[80:83], v[40:43], a[176:179], v[80:83]
    s_waitcnt lgkmcnt(5)
    v_exp_f32 v61, v61
    v_mfma_f32_16x16x32_bf16 v[84:87], v[40:43], a[180:183], v[84:87]
    s_waitcnt lgkmcnt(3)
    v_exp_f32 v62, v62
    v_mfma_f32_16x16x32_bf16 v[88:91], v[40:43], a[184:187], v[88:91]
    s_waitcnt lgkmcnt(0)
    v_exp_f32 v63, v63
    v_mfma_f32_16x16x32_bf16 v[92:95], v[40:43], a[188:191], v[92:95]
    v_cvt_pk_bf16_f32 v44, v56, v57
    v_cvt_pk_bf16_f32 v45, v58, v59
    v_mfma_f32_16x16x32_bf16 v[48:51], a[96:99], a[32:35], 0
    v_cvt_pk_bf16_f32 v46, v60, v61
    v_cvt_pk_bf16_f32 v47, v62, v63
    v_mfma_f32_16x16x32_bf16 v[48:51], a[100:103], a[36:39], v[48:51]
    ds_write_b32 v9, v25 offset:256
    v_mfma_f32_16x16x32_bf16 v[48:51], a[104:107], a[40:43], v[48:51]
    ds_write_b32 v9, v26 offset:512
    v_mfma_f32_16x16x32_bf16 v[48:51], a[108:111], a[44:47], v[48:51]
    ds_write_b32 v9, v27 offset:768
    v_mfma_f32_16x16x32_bf16 v[52:55], a[124:127], a[44:47], 0
    v_mfma_f32_16x16x32_bf16 v[52:55], a[120:123], a[40:43], v[52:55]
    v_exp_f32 v48, v48
    v_mfma_f32_16x16x32_bf16 v[52:55], a[116:119], a[36:39], v[52:55]
    v_exp_f32 v49, v49
    v_mfma_f32_16x16x32_bf16 v[52:55], a[112:115], a[32:35], v[52:55]
    v_exp_f32 v50, v50
    v_smfmac_f32_16x16x64_bf16 a[224:227], a[248:251], v[40:47], v19
    s_add_u32 s40, s40, 1024
    s_cmp_lt_u32 s40, s44
    s_cselect_b32 s41, s40, 94208
    v_mfma_f32_16x16x32_bf16 v[96:99], v[44:47], a[160:163], v[96:99]
    s_add_u32 s41, s41, s43
    v_exp_f32 v51, v51
    v_mfma_f32_16x16x32_bf16 v[100:103], v[44:47], a[164:167], v[100:103]
    v_exp_f32 v52, v52
    v_mfma_f32_16x16x32_bf16 v[104:107], v[44:47], a[168:171], v[104:107]
    v_exp_f32 v53, v53
    v_mfma_f32_16x16x32_bf16 v[108:111], v[44:47], a[172:175], v[108:111]
    v_exp_f32 v54, v54
    v_mfma_f32_16x16x32_bf16 v[112:115], v[44:47], a[176:179], v[112:115]
    v_exp_f32 v55, v55
    v_mfma_f32_16x16x32_bf16 v[116:119], v[44:47], a[180:183], v[116:119]
    v_cvt_pk_bf16_f32 v40, v48, v49
    v_cvt_pk_bf16_f32 v41, v50, v51
    v_mfma_f32_16x16x32_bf16 v[120:123], v[44:47], a[184:187], v[120:123]
    v_cvt_pk_bf16_f32 v42, v52, v53
    v_cvt_pk_bf16_f32 v43, v54, v55
    v_mfma_f32_16x16x32_bf16 v[124:127], v[44:47], a[188:191], v[124:127]
    v_add_u32 v9, s41, v20
    v_mfma_f32_16x16x32_bf16 v[56:59], a[96:99], a[48:51], 0
    ds_read2st64_b32 v[24:25], v9 offset0:0 offset1:1
    v_mfma_f32_16x16x32_bf16 v[56:59], a[100:103], a[52:55], v[56:59]
    ds_read2st64_b32 v[26:27], v9 offset0:2 offset1:3
    v_mfma_f32_16x16x32_bf16 v[56:59], a[104:107], a[56:59], v[56:59]
    v_mfma_f32_16x16x32_bf16 v[56:59], a[108:111], a[60:63], v[56:59]
    v_mfma_f32_16x16x32_bf16 v[60:63], a[124:127], a[60:63], 0
    v_mfma_f32_16x16x32_bf16 v[60:63], a[120:123], a[56:59], v[60:63]
    s_waitcnt lgkmcnt(1)
    v_exp_f32 v56, v56
    v_mfma_f32_16x16x32_bf16 v[60:63], a[116:119], a[52:55], v[60:63]
    s_waitcnt lgkmcnt(0)
    v_exp_f32 v57, v57
    v_mfma_f32_16x16x32_bf16 v[60:63], a[112:115], a[48:51], v[60:63]
    v_exp_f32 v58, v58
    v_mfma_f32_16x16x32_bf16 v[128:131], v[40:43], a[160:163], v[128:131]
    v_exp_f32 v59, v59
    v_mfma_f32_16x16x32_bf16 v[132:135], v[40:43], a[164:167], v[132:135]
    v_exp_f32 v60, v60
    v_mfma_f32_16x16x32_bf16 v[136:139], v[40:43], a[168:171], v[136:139]
    v_exp_f32 v61, v61
    v_mfma_f32_16x16x32_bf16 v[140:143], v[40:43], a[172:175], v[140:143]
    v_exp_f32 v62, v62
    v_mfma_f32_16x16x32_bf16 v[144:147], v[40:43], a[176:179], v[144:147]
    v_exp_f32 v63, v63
    v_mfma_f32_16x16x32_bf16 v[148:151], v[40:43], a[180:183], v[148:151]
    v_cvt_pk_bf16_f32 v44, v56, v57
    v_cvt_pk_bf16_f32 v45, v58, v59
    v_mfma_f32_16x16x32_bf16 v[152:155], v[40:43], a[184:187], v[152:155]
    v_cvt_pk_bf16_f32 v46, v60, v61
    v_cvt_pk_bf16_f32 v47, v62, v63
    v_mfma_f32_16x16x32_bf16 v[156:159], v[40:43], a[188:191], v[156:159]
    v_lshlrev_b32 v28, 16, v24
    v_and_b32 v24, s36, v24
    v_mfma_f32_16x16x32_bf16 v[48:51], a[96:99], a[64:67], 0
    v_mul_f32 v28, s35, v28
    v_mul_f32 v24, s35, v24
    v_mfma_f32_16x16x32_bf16 v[48:51], a[100:103], a[68:71], v[48:51]
    v_cvt_pk_bf16_f32 v24, v28, v24
    v_lshlrev_b32 v29, 16, v25
    v_mfma_f32_16x16x32_bf16 v[48:51], a[104:107], a[72:75], v[48:51]
    v_and_b32 v25, s36, v25
    v_mul_f32 v29, s35, v29
    v_mfma_f32_16x16x32_bf16 v[48:51], a[108:111], a[76:79], v[48:51]
    v_mul_f32 v25, s35, v25
    v_cvt_pk_bf16_f32 v25, v29, v25
    v_mfma_f32_16x16x32_bf16 v[52:55], a[124:127], a[76:79], 0
    v_lshlrev_b32 v30, 16, v26
    v_and_b32 v26, s36, v26
    v_mfma_f32_16x16x32_bf16 v[52:55], a[120:123], a[72:75], v[52:55]
    v_exp_f32 v48, v48
    v_mfma_f32_16x16x32_bf16 v[52:55], a[116:119], a[68:71], v[52:55]
    v_exp_f32 v49, v49
    v_mfma_f32_16x16x32_bf16 v[52:55], a[112:115], a[64:67], v[52:55]
    v_exp_f32 v50, v50
    v_smfmac_f32_16x16x64_bf16 a[228:231], a[248:251], v[40:47], v19
    s_barrier
    v_mfma_f32_16x16x32_bf16 v[160:163], v[44:47], a[160:163], v[160:163]
    ds_read_b128 a[128:131], v3 offset:8448
    v_cvt_pk_bf16_f32 v40, v48, v49
    v_mfma_f32_16x16x32_bf16 v[164:167], v[44:47], a[164:167], v[164:167]
    v_exp_f32 v51, v51
    v_mfma_f32_16x16x32_bf16 v[168:171], v[44:47], a[168:171], v[168:171]
    ds_read_b128 a[132:135], v3 offset:8512
    v_cvt_pk_bf16_f32 v41, v50, v51
    v_mfma_f32_16x16x32_bf16 v[172:175], v[44:47], a[172:175], v[172:175]
    v_exp_f32 v52, v52
    v_mfma_f32_16x16x32_bf16 v[176:179], v[44:47], a[176:179], v[176:179]
    ds_read_b128 a[136:139], v3 offset:8576
    v_mul_f32 v30, s35, v30
    v_mfma_f32_16x16x32_bf16 v[180:183], v[44:47], a[180:183], v[180:183]
    v_exp_f32 v53, v53
    v_mfma_f32_16x16x32_bf16 v[184:187], v[44:47], a[184:187], v[184:187]
    ds_read_b128 a[140:143], v3 offset:8640
    v_cvt_pk_bf16_f32 v42, v52, v53
    v_mfma_f32_16x16x32_bf16 v[188:191], v[44:47], a[188:191], v[188:191]
    v_exp_f32 v54, v54
    v_mfma_f32_16x16x32_bf16 v[56:59], a[96:99], a[80:83], 0
    v_exp_f32 v55, v55
    v_mfma_f32_16x16x32_bf16 v[56:59], a[100:103], a[84:87], v[56:59]
    ds_read_b128 a[156:159], v3 offset:9152
    v_cvt_pk_bf16_f32 v43, v54, v55
    v_mfma_f32_16x16x32_bf16 v[56:59], a[104:107], a[88:91], v[56:59]
    v_mul_f32 v26, s35, v26
    v_cvt_pk_bf16_f32 v26, v30, v26
    v_mfma_f32_16x16x32_bf16 v[56:59], a[108:111], a[92:95], v[56:59]
    ds_read_b128 a[152:155], v3 offset:9088
    v_lshlrev_b32 v31, 16, v27
    v_mfma_f32_16x16x32_bf16 v[60:63], a[124:127], a[92:95], 0
    v_and_b32 v27, s36, v27
    v_mul_f32 v31, s35, v31
    v_mfma_f32_16x16x32_bf16 v[60:63], a[120:123], a[88:91], v[60:63]
    ds_read_b128 a[148:151], v3 offset:9024
    v_mul_f32 v27, s35, v27
    v_mfma_f32_16x16x32_bf16 v[60:63], a[116:119], a[84:87], v[60:63]
    v_exp_f32 v56, v56
    v_mfma_f32_16x16x32_bf16 v[60:63], a[112:115], a[80:83], v[60:63]
    ds_read_b128 a[144:147], v3 offset:8960
    v_cvt_pk_bf16_f32 v27, v31, v27
    v_mfma_f32_16x16x32_bf16 v[192:195], v[40:43], a[160:163], v[192:195]
    v_exp_f32 v57, v57
    v_mfma_f32_16x16x32_bf16 v[196:199], v[40:43], a[164:167], v[196:199]
    ds_read_b64_tr_b16 a[192:193], v4 offset:42240
    v_cvt_pk_bf16_f32 v44, v56, v57
    v_mfma_f32_16x16x32_bf16 v[200:203], v[40:43], a[168:171], v[200:203]
    v_exp_f32 v58, v58
    v_mfma_f32_16x16x32_bf16 v[204:207], v[40:43], a[172:175], v[204:207]
    ds_read_b64_tr_b16 a[194:195], v4 offset:42752
    v_mfma_f32_16x16x32_bf16 v[208:211], v[40:43], a[176:179], v[208:211]
    v_exp_f32 v59, v59
    v_mfma_f32_16x16x32_bf16 v[212:215], v[40:43], a[180:183], v[212:215]
    ds_read_b64_tr_b16 a[196:197], v4 offset:42256
    v_cvt_pk_bf16_f32 v45, v58, v59
    v_mfma_f32_16x16x32_bf16 v[216:219], v[40:43], a[184:187], v[216:219]
    v_exp_f32 v60, v60
    v_mfma_f32_16x16x32_bf16 v[220:223], v[40:43], a[188:191], v[220:223]
    s_waitcnt lgkmcnt(10)
    ds_read_b64_tr_b16 a[198:199], v4 offset:42768
    v_mfma_f32_16x16x32_bf16 v[48:51], a[128:131], a[0:3], 0
    s_waitcnt lgkmcnt(10)
    v_exp_f32 v61, v61
    v_mfma_f32_16x16x32_bf16 v[48:51], a[132:135], a[4:7], v[48:51]
    s_waitcnt lgkmcnt(9)
    ds_read_b64_tr_b16 a[200:201], v4 offset:42272
    v_cvt_pk_bf16_f32 v46, v60, v61
    v_mfma_f32_16x16x32_bf16 v[48:51], a[136:139], a[8:11], v[48:51]
    s_waitcnt lgkmcnt(9)
    v_exp_f32 v62, v62
    v_mfma_f32_16x16x32_bf16 v[48:51], a[140:143], a[12:15], v[48:51]
    s_waitcnt lgkmcnt(8)
    v_exp_f32 v63, v63
    v_mfma_f32_16x16x32_bf16 v[52:55], a[156:159], a[12:15], 0
    s_waitcnt lgkmcnt(7)
    ds_read_b64_tr_b16 a[202:203], v4 offset:42784
    v_cvt_pk_bf16_f32 v47, v62, v63
    v_mfma_f32_16x16x32_bf16 v[52:55], a[152:155], a[8:11], v[52:55]
    s_waitcnt lgkmcnt(7)
    v_exp_f32 v48, v48
    v_mfma_f32_16x16x32_bf16 v[52:55], a[148:151], a[4:7], v[52:55]
    s_waitcnt lgkmcnt(6)
    ds_read_b64_tr_b16 a[204:205], v4 offset:42288
    v_mfma_f32_16x16x32_bf16 v[52:55], a[144:147], a[0:3], v[52:55]
    v_exp_f32 v49, v49
    v_smfmac_f32_16x16x64_bf16 a[232:235], a[248:251], v[40:47], v19
    ds_read_b64_tr_b16 a[206:207], v4 offset:42800
    v_mfma_f32_16x16x32_bf16 v[224:227], v[44:47], a[160:163], v[224:227]
    v_exp_f32 v50, v50
    v_mfma_f32_16x16x32_bf16 v[228:231], v[44:47], a[164:167], v[228:231]
    ds_read_b64_tr_b16 a[208:209], v4 offset:42304
    v_cvt_pk_bf16_f32 v40, v48, v49
    v_mfma_f32_16x16x32_bf16 v[232:235], v[44:47], a[168:171], v[232:235]
    v_exp_f32 v51, v51
    v_mfma_f32_16x16x32_bf16 v[236:239], v[44:47], a[172:175], v[236:239]
    ds_read_b64_tr_b16 a[210:211], v4 offset:42816
    v_cvt_pk_bf16_f32 v41, v50, v51
    v_mfma_f32_16x16x32_bf16 v[240:243], v[44:47], a[176:179], v[240:243]
    v_exp_f32 v52, v52
    v_mfma_f32_16x16x32_bf16 v[244:247], v[44:47], a[180:183], v[244:247]
    ds_read_b64_tr_b16 a[212:213], v4 offset:42320
    v_mfma_f32_16x16x32_bf16 v[248:251], v[44:47], a[184:187], v[248:251]
    v_exp_f32 v53, v53
    v_mfma_f32_16x16x32_bf16 v[252:255], v[44:47], a[188:191], v[252:255]
    ds_read_b64_tr_b16 a[214:215], v4 offset:42832
    v_cvt_pk_bf16_f32 v42, v52, v53
    v_mfma_f32_16x16x32_bf16 v[56:59], a[128:131], a[16:19], 0
    v_exp_f32 v54, v54
    v_mfma_f32_16x16x32_bf16 v[56:59], a[132:135], a[20:23], v[56:59]
    ds_read_b64_tr_b16 a[216:217], v4 offset:42336
    v_mfma_f32_16x16x32_bf16 v[56:59], a[136:139], a[24:27], v[56:59]
    v_exp_f32 v55, v55
    v_mfma_f32_16x16x32_bf16 v[56:59], a[140:143], a[28:31], v[56:59]
    ds_read_b64_tr_b16 a[218:219], v4 offset:42848
    v_cvt_pk_bf16_f32 v43, v54, v55
    v_mfma_f32_16x16x32_bf16 v[60:63], a[156:159], a[28:31], 0
    ds_write_b32 v9, v24 offset:0
    v_mfma_f32_16x16x32_bf16 v[60:63], a[152:155], a[24:27], v[60:63]
    ds_read_b64_tr_b16 a[220:221], v4 offset:42352
    v_mfma_f32_16x16x32_bf16 v[60:63], a[148:151], a[20:23], v[60:63]
    v_exp_f32 v56, v56
    v_mfma_f32_16x16x32_bf16 v[60:63], a[144:147], a[16:19], v[60:63]
    s_waitcnt lgkmcnt(14)
    ds_read_b64_tr_b16 a[222:223], v4 offset:42864
    v_mfma_f32_16x16x32_bf16 v[64:67], v[40:43], a[192:195], v[64:67]
    s_waitcnt lgkmcnt(13)
    v_exp_f32 v57, v57
    v_mfma_f32_16x16x32_bf16 v[68:71], v[40:43], a[196:199], v[68:71]
    s_waitcnt lgkmcnt(11)
    v_exp_f32 v58, v58
    v_mfma_f32_16x16x32_bf16 v[72:75], v[40:43], a[200:203], v[72:75]
    s_waitcnt lgkmcnt(9)
    v_exp_f32 v59, v59
    v_mfma_f32_16x16x32_bf16 v[76:79], v[40:43], a[204:207], v[76:79]
    s_waitcnt lgkmcnt(7)
    v_exp_f32 v60, v60
    v_mfma_f32_16x16x32_bf16 v[80:83], v[40:43], a[208:211], v[80:83]
    s_waitcnt lgkmcnt(5)
    v_exp_f32 v61, v61
    v_mfma_f32_16x16x32_bf16 v[84:87], v[40:43], a[212:215], v[84:87]
    s_waitcnt lgkmcnt(3)
    v_exp_f32 v62, v62
    v_mfma_f32_16x16x32_bf16 v[88:91], v[40:43], a[216:219], v[88:91]
    s_waitcnt lgkmcnt(0)
    v_exp_f32 v63, v63
    v_mfma_f32_16x16x32_bf16 v[92:95], v[40:43], a[220:223], v[92:95]
    ds_write_b32 v9, v25 offset:256
    v_mfma_f32_16x16x32_bf16 v[48:51], a[128:131], a[32:35], 0
    ds_write_b32 v9, v26 offset:512
    v_mfma_f32_16x16x32_bf16 v[48:51], a[132:135], a[36:39], v[48:51]
    ds_write_b32 v9, v27 offset:768
    v_mfma_f32_16x16x32_bf16 v[48:51], a[136:139], a[40:43], v[48:51]
    v_cvt_pk_bf16_f32 v44, v56, v57
    v_cvt_pk_bf16_f32 v45, v58, v59
    v_mfma_f32_16x16x32_bf16 v[48:51], a[140:143], a[44:47], v[48:51]
    v_cvt_pk_bf16_f32 v46, v60, v61
    v_cvt_pk_bf16_f32 v47, v62, v63
    v_mfma_f32_16x16x32_bf16 v[52:55], a[156:159], a[44:47], 0
    v_mfma_f32_16x16x32_bf16 v[52:55], a[152:155], a[40:43], v[52:55]
    s_cmp_lg_u32 s29, 31
    v_mfma_f32_16x16x32_bf16 v[52:55], a[148:151], a[36:39], v[52:55]
    v_mfma_f32_16x16x32_bf16 v[52:55], a[144:147], a[32:35], v[52:55]
    s_cbranch_scc1 L_A1
    v_smfmac_f32_16x16x64_bf16 a[224:227], a[248:251], v[40:47], v19
    ds_read_b128 a[20:23], v6 offset:4096
    v_exp_f32 v50, v50
    v_mfma_f32_16x16x32_bf16 v[96:99], v[44:47], a[192:195], v[96:99]
    ds_read_b128 a[16:19], v5 offset:4096
    ds_read_b128 a[36:39], v6 offset:8192
    v_exp_f32 v54, v54
    v_mfma_f32_16x16x32_bf16 v[100:103], v[44:47], a[196:199], v[100:103]
    v_exp_f32 v51, v51
    v_mfma_f32_16x16x32_bf16 v[104:107], v[44:47], a[200:203], v[104:107]
    s_xor_b32 s30, s30, 16896
    ds_read_b128 a[40:43], v7 offset:8192
    v_accvgpr_read_b32 v38, a225
    v_mfma_f32_16x16x32_bf16 v[108:111], v[44:47], a[204:207], v[108:111]
    ds_read_b128 a[4:7], v6 offset:0
    v_accvgpr_read_b32 v34, a224
    v_add_f32 v34, v34, v38
    v_mfma_f32_16x16x32_bf16 v[112:115], v[44:47], a[208:211], v[112:115]
    ds_read_b128 a[24:27], v7 offset:4096
    ds_read_b128 a[32:35], v5 offset:8192
    v_subrev_u32 v38, s38, v34
    v_exp_f32 v52, v52
    v_accvgpr_read_b32 v39, a227
    v_mfma_f32_16x16x32_bf16 v[116:119], v[44:47], a[212:215], v[116:119]
    v_exp_f32 v48, v48
    v_mfma_f32_16x16x32_bf16 v[120:123], v[44:47], a[216:219], v[120:123]
    v_rcp_f32 v34, v34
    v_mfma_f32_16x16x32_bf16 v[124:127], v[44:47], a[220:223], v[124:127]
    v_exp_f32 v53, v53
    v_mfma_f32_16x16x32_bf16 v[56:59], a[128:131], a[48:51], 0
    v_exp_f32 v49, v49
    v_mfma_f32_16x16x32_bf16 v[56:59], a[132:135], a[52:55], v[56:59]
    ds_read_b128 a[12:15], v8 offset:0
    v_accvgpr_read_b32 v36, a226
    v_add_f32 v36, v36, v39
    v_add_u32 v4, s30, v2
    v_mfma_f32_16x16x32_bf16 v[56:59], a[136:139], a[56:59], v[56:59]
    v_mov_b32_dpp v34, v34 row_ror:12 row_mask:0xa bank_mask:0xf
    v_cvt_pk_bf16_f32 v40, v48, v49
    v_mfma_f32_16x16x32_bf16 v[56:59], a[140:143], a[60:63], v[56:59]
    v_cvt_pk_bf16_f32 v41, v50, v51
    v_subrev_u32 v39, s38, v36
    v_mfma_f32_16x16x32_bf16 v[60:63], a[156:159], a[60:63], 0
    v_mov_b32_dpp v34, v34 row_ror:8 row_mask:0xc bank_mask:0xf
    v_cvt_pk_bf16_f32 v42, v52, v53
    v_mfma_f32_16x16x32_bf16 v[60:63], a[152:155], a[56:59], v[60:63]
    ds_read_b128 a[0:3], v5 offset:0
    ds_read_b128 a[56:59], v7 offset:12288
    v_exp_f32 v55, v55
    v_mfma_f32_16x16x32_bf16 v[60:63], a[148:151], a[52:55], v[60:63]
    v_mul_f32_dpp v67, v34, v67 row_newbcast:3 row_mask:0xf bank_mask:0xf
    v_cvt_pk_bf16_f32 v43, v54, v55
    v_exp_f32 v58, v58
    v_mfma_f32_16x16x32_bf16 v[60:63], a[144:147], a[48:51], v[60:63]
    v_mul_f32_dpp v65, v34, v65 row_newbcast:1 row_mask:0xf bank_mask:0xf
    v_rcp_f32 v36, v36
    v_mfma_f32_16x16x32_bf16 v[128:131], v[40:43], a[192:195], v[128:131]
    ds_read_b128 a[28:31], v8 offset:4096
    v_exp_f32 v57, v57
    v_mfma_f32_16x16x32_bf16 v[132:135], v[40:43], a[196:199], v[132:135]
    ds_read_b128 a[8:11], v7 offset:0
    v_mul_f32_dpp v71, v34, v71 row_newbcast:3 row_mask:0xf bank_mask:0xf
    v_mul_f32_dpp v75, v34, v75 row_newbcast:3 row_mask:0xf bank_mask:0xf
    v_exp_f32 v62, v62
    v_exp_f32 v63, v63
    v_mfma_f32_16x16x32_bf16 v[136:139], v[40:43], a[200:203], v[136:139]
    v_mul_f32_dpp v69, v34, v69 row_newbcast:1 row_mask:0xf bank_mask:0xf
    v_mov_b32_dpp v36, v36 row_ror:12 row_mask:0xa bank_mask:0xf
    v_mfma_f32_16x16x32_bf16 v[140:143], v[40:43], a[204:207], v[140:143]
    v_exp_f32 v59, v59
    v_mfma_f32_16x16x32_bf16 v[144:147], v[40:43], a[208:211], v[144:147]
    ds_read_b128 a[44:47], v8 offset:8192
    v_mov_b32_dpp v36, v36 row_ror:8 row_mask:0xc bank_mask:0xf
    v_mfma_f32_16x16x32_bf16 v[148:151], v[40:43], a[212:215], v[148:151]
    v_max_u32 v15, v15, v38
    v_mul_f32_dpp v99, v36, v99 row_newbcast:3 row_mask:0xf bank_mask:0xf
    v_mfma_f32_16x16x32_bf16 v[152:155], v[40:43], a[216:219], v[152:155]
    v_mul_f32_dpp v79, v34, v79 row_newbcast:3 row_mask:0xf bank_mask:0xf
    v_mul_f32_dpp v103, v36, v103 row_newbcast:3 row_mask:0xf bank_mask:0xf
    v_mul_f32_dpp v107, v36, v107 row_newbcast:3 row_mask:0xf bank_mask:0xf
    v_mul_f32_dpp v111, v36, v111 row_newbcast:3 row_mask:0xf bank_mask:0xf
    v_mfma_f32_16x16x32_bf16 v[156:159], v[40:43], a[220:223], v[156:159]
    ds_read_b128 a[52:55], v6 offset:12288
    v_mul_f32_dpp v64, v34, v64 row_newbcast:0 row_mask:0xf bank_mask:0xf
    v_mul_f32_dpp v83, v34, v83 row_newbcast:3 row_mask:0xf bank_mask:0xf
    v_mfma_f32_16x16x32_bf16 v[48:51], a[128:131], a[64:67], 0
    v_mul_f32_dpp v86, v34, v86 row_newbcast:2 row_mask:0xf bank_mask:0xf
    v_cvt_pk_bf16_f32 v45, v58, v59
    v_mfma_f32_16x16x32_bf16 v[48:51], a[132:135], a[68:71], v[48:51]
    v_exp_f32 v61, v61
    v_mfma_f32_16x16x32_bf16 v[48:51], a[136:139], a[72:75], v[48:51]
    ds_read_b128 a[48:51], v5 offset:12288
    v_mul_f32_dpp v68, v34, v68 row_newbcast:0 row_mask:0xf bank_mask:0xf
    v_mul_f32_dpp v104, v36, v104 row_newbcast:0 row_mask:0xf bank_mask:0xf
    v_mfma_f32_16x16x32_bf16 v[48:51], a[140:143], a[76:79], v[48:51]
    v_exp_f32 v56, v56
    v_exp_f32 v60, v60
    v_cvt_pk_bf16_f32 v47, v62, v63
    v_mfma_f32_16x16x32_bf16 v[52:55], a[156:159], a[76:79], 0
    v_mul_f32_dpp v87, v34, v87 row_newbcast:3 row_mask:0xf bank_mask:0xf
    v_cvt_pk_bf16_f32 v44, v56, v57
    v_mfma_f32_16x16x32_bf16 v[52:55], a[152:155], a[72:75], v[52:55]
    v_mul_f32_dpp v70, v34, v70 row_newbcast:2 row_mask:0xf bank_mask:0xf
    v_mul_f32_dpp v78, v34, v78 row_newbcast:2 row_mask:0xf bank_mask:0xf
    v_mul_f32_dpp v80, v34, v80 row_newbcast:0 row_mask:0xf bank_mask:0xf
    v_mul_f32_dpp v97, v36, v97 row_newbcast:1 row_mask:0xf bank_mask:0xf
    v_cvt_pk_bf16_f32 v46, v60, v61
    v_mfma_f32_16x16x32_bf16 v[52:55], a[148:151], a[68:71], v[52:55]
    v_mul_f32_dpp v85, v34, v85 row_newbcast:1 row_mask:0xf bank_mask:0xf
    v_add_u32 v3, s30, v1
    v_mfma_f32_16x16x32_bf16 v[52:55], a[144:147], a[64:67], v[52:55]
    ds_read_b128 a[68:71], v6 offset:16384
    v_mul_f32_dpp v105, v36, v105 row_newbcast:1 row_mask:0xf bank_mask:0xf
    v_smfmac_f32_16x16x64_bf16 a[228:231], a[248:251], v[40:47], v19
    s_barrier
    ds_read_b128 a[120:123], v3 offset:640
    ds_read_b64_tr_b16 a[190:191], v4 offset:34416
    v_mul_f32_dpp v115, v36, v115 row_newbcast:3 row_mask:0xf bank_mask:0xf
    v_mul_f32_dpp v119, v36, v119 row_newbcast:3 row_mask:0xf bank_mask:0xf
    v_exp_f32 v50, v50
    v_mfma_f32_16x16x32_bf16 v[160:163], v[44:47], a[192:195], v[160:163]
    ds_read_b128 a[108:111], v3 offset:192
    ds_read_b64_tr_b16 a[184:185], v4 offset:33888
    v_exp_f32 v48, v48
    v_exp_f32 v49, v49
    v_mfma_f32_16x16x32_bf16 v[164:167], v[44:47], a[196:199], v[164:167]
    ds_read_b64_tr_b16 a[172:173], v4 offset:33840
    v_mul_f32_dpp v66, v34, v66 row_newbcast:2 row_mask:0xf bank_mask:0xf
    v_exp_f32 v53, v53
    v_mfma_f32_16x16x32_bf16 v[168:171], v[44:47], a[200:203], v[168:171]
    ds_read_b128 a[116:119], v3 offset:576
    v_mul_f32_dpp v72, v34, v72 row_newbcast:0 row_mask:0xf bank_mask:0xf
    v_mul_f32_dpp v81, v34, v81 row_newbcast:1 row_mask:0xf bank_mask:0xf
    v_mul_f32_dpp v88, v34, v88 row_newbcast:0 row_mask:0xf bank_mask:0xf
    v_mul_f32_dpp v109, v36, v109 row_newbcast:1 row_mask:0xf bank_mask:0xf
    v_mfma_f32_16x16x32_bf16 v[172:175], v[44:47], a[204:207], v[172:175]
    ds_read_b128 a[100:103], v3 offset:64
    ds_read_b64_tr_b16 a[162:163], v4 offset:34304
    v_mul_f32_dpp v74, v34, v74 row_newbcast:2 row_mask:0xf bank_mask:0xf
    v_mfma_f32_16x16x32_bf16 v[176:179], v[44:47], a[208:211], v[176:179]
    v_cvt_pk_bf16_f32 v64, v64, v68
    v_mul_f32_dpp v118, v36, v118 row_newbcast:2 row_mask:0xf bank_mask:0xf
    v_exp_f32 v51, v51
    v_mfma_f32_16x16x32_bf16 v[180:183], v[44:47], a[212:215], v[180:183]
    ds_read_b128 a[104:107], v3 offset:128
    v_mul_f32_dpp v91, v34, v91 row_newbcast:3 row_mask:0xf bank_mask:0xf
    v_mfma_f32_16x16x32_bf16 v[184:187], v[44:47], a[216:219], v[184:187]
    ds_read_b128 a[64:67], v5 offset:16384
    ds_read_b64_tr_b16 a[170:171], v4 offset:34336
    v_mul_f32_dpp v73, v34, v73 row_newbcast:1 row_mask:0xf bank_mask:0xf
    v_mul_f32_dpp v100, v36, v100 row_newbcast:0 row_mask:0xf bank_mask:0xf
    v_mfma_f32_16x16x32_bf16 v[188:191], v[44:47], a[220:223], v[188:191]
    ds_read_b64_tr_b16 a[178:179], v4 offset:34368
    v_cvt_pk_bf16_f32 v68, v66, v70
    v_exp_f32 v52, v52
    v_mfma_f32_16x16x32_bf16 v[56:59], a[128:131], a[80:83], 0
    v_cvt_pk_bf16_f32 v66, v65, v69
    v_mul_f32_dpp v116, v36, v116 row_newbcast:0 row_mask:0xf bank_mask:0xf
    v_mfma_f32_16x16x32_bf16 v[56:59], a[132:135], a[84:87], v[56:59]
    v_exp_f32 v55, v55
    v_mfma_f32_16x16x32_bf16 v[56:59], a[136:139], a[88:91], v[56:59]
    ds_read_b64_tr_b16 a[166:167], v4 offset:34320
    v_mul_f32_dpp v77, v34, v77 row_newbcast:1 row_mask:0xf bank_mask:0xf
    v_mul_f32_dpp v106, v36, v106 row_newbcast:2 row_mask:0xf bank_mask:0xf
    v_mul_f32_dpp v123, v36, v123 row_newbcast:3 row_mask:0xf bank_mask:0xf
    v_cvt_pk_bf16_f32 v41, v50, v51
    v_cvt_pk_bf16_f32 v42, v52, v53
    v_mfma_f32_16x16x32_bf16 v[56:59], a[140:143], a[92:95], v[56:59]
    ds_read_b128 a[76:79], v8 offset:16384
    v_mul_f32_dpp v84, v34, v84 row_newbcast:0 row_mask:0xf bank_mask:0xf
    v_exp_f32 v54, v54
    v_mfma_f32_16x16x32_bf16 v[60:63], a[156:159], a[92:95], 0
    v_xor_b32 v24, 0x140, v23
    v_mul_f32_dpp v76, v34, v76 row_newbcast:0 row_mask:0xf bank_mask:0xf
    v_mul_f32_dpp v93, v34, v93 row_newbcast:1 row_mask:0xf bank_mask:0xf
    v_accvgpr_read_b32 v38, a229
    v_cvt_pk_bf16_f32 v40, v48, v49
    v_mfma_f32_16x16x32_bf16 v[60:63], a[152:155], a[88:91], v[60:63]
    ds_read_b128 a[60:63], v8 offset:12288
    ds_read_b128 a[124:127], v3 offset:704
    v_mul_f32_dpp v101, v36, v101 row_newbcast:1 row_mask:0xf bank_mask:0xf
    v_mfma_f32_16x16x32_bf16 v[60:63], a[148:151], a[84:87], v[60:63]
    ds_read_b64_tr_b16 a[180:181], v4 offset:33872
    v_mul_f32_dpp v96, v36, v96 row_newbcast:0 row_mask:0xf bank_mask:0xf
    v_cvt_pk_bf16_f32 v43, v54, v55
    v_mfma_f32_16x16x32_bf16 v[60:63], a[144:147], a[80:83], v[60:63]
    v_mul_f32_dpp v82, v34, v82 row_newbcast:2 row_mask:0xf bank_mask:0xf
    v_cvt_pk_bf16_f32 v96, v96, v100
    v_exp_f32 v59, v59
    v_mfma_f32_16x16x32_bf16 v[192:195], v[40:43], a[192:195], v[192:195]
    ds_read_b64_tr_b16 a[164:165], v4 offset:33808
    v_mul_f32_dpp v114, v36, v114 row_newbcast:2 row_mask:0xf bank_mask:0xf
    v_mfma_f32_16x16x32_bf16 v[196:199], v[40:43], a[196:199], v[196:199]
    ds_read_b128 a[96:99], v3 offset:0
    ds_read_b128 a[112:115], v3 offset:512
    v_cvt_pk_bf16_f32 v70, v67, v71
    v_mfma_f32_16x16x32_bf16 v[200:203], v[40:43], a[200:203], v[200:203]
    v_exp_f32 v56, v56
    v_exp_f32 v62, v62
    v_mfma_f32_16x16x32_bf16 v[204:207], v[40:43], a[204:207], v[204:207]
    ds_read_b128 a[84:87], v6 offset:20480
    ds_read_b128 a[88:91], v7 offset:20480
    v_cvt_pk_bf16_f32 v80, v80, v84
    v_exp_f32 v61, v61
    v_exp_f32 v63, v63
    v_mfma_f32_16x16x32_bf16 v[208:211], v[40:43], a[208:211], v[208:211]
    v_exp_f32 v60, v60
    v_mfma_f32_16x16x32_bf16 v[212:215], v[40:43], a[212:215], v[212:215]
    v_cvt_pk_bf16_f32 v84, v82, v86
    v_cvt_pk_bf16_f32 v86, v83, v87
    v_max_u32 v15, v15, v39
    v_mfma_f32_16x16x32_bf16 v[216:219], v[40:43], a[216:219], v[216:219]
    v_mul_f32_dpp v90, v34, v90 row_newbcast:2 row_mask:0xf bank_mask:0xf
    v_mul_f32_dpp v102, v36, v102 row_newbcast:2 row_mask:0xf bank_mask:0xf
    v_exp_f32 v57, v57
    v_mfma_f32_16x16x32_bf16 v[220:223], v[40:43], a[220:223], v[220:223]
    s_waitcnt lgkmcnt(15)
    s_waitcnt lgkmcnt(3)
    ds_read_b64_tr_b16 a[176:177], v4 offset:33856
    v_cvt_pk_bf16_f32 v69, v74, v78
    v_mul_f32_dpp v110, v36, v110 row_newbcast:2 row_mask:0xf bank_mask:0xf
    v_mul_f32_dpp v112, v36, v112 row_newbcast:0 row_mask:0xf bank_mask:0xf
    v_mul_f32_dpp v124, v36, v124 row_newbcast:0 row_mask:0xf bank_mask:0xf
    v_exp_f32 v58, v58
    v_mfma_f32_16x16x32_bf16 v[48:51], a[96:99], a[0:3], 0
    ds_read_b64_tr_b16 a[186:187], v4 offset:34400
    ds_read_b64_tr_b16 a[188:189], v4 offset:33904
    v_mul_f32_dpp v95, v34, v95 row_newbcast:3 row_mask:0xf bank_mask:0xf
    v_mul_f32_dpp v113, v36, v113 row_newbcast:1 row_mask:0xf bank_mask:0xf
    v_cvt_pk_bf16_f32 v112, v112, v116
    v_mfma_f32_16x16x32_bf16 v[48:51], a[100:103], a[4:7], v[48:51]
    ds_read_b64_tr_b16 a[160:161], v4 offset:33792
    ds_read_b128 a[80:83], v5 offset:20480
    v_mul_f32_dpp v89, v34, v89 row_newbcast:1 row_mask:0xf bank_mask:0xf
    v_mul_f32_dpp v92, v34, v92 row_newbcast:0 row_mask:0xf bank_mask:0xf
    v_mul_f32_dpp v98, v36, v98 row_newbcast:2 row_mask:0xf bank_mask:0xf
    v_cvt_pk_bf16_f32 v45, v58, v59
    v_mfma_f32_16x16x32_bf16 v[48:51], a[104:107], a[8:11], v[48:51]
    v_cvt_pk_bf16_f32 v82, v81, v85
    v_cvt_pk_bf16_f32 v46, v60, v61
    v_mfma_f32_16x16x32_bf16 v[48:51], a[108:111], a[12:15], v[48:51]
    v_cvt_pk_bf16_f32 v100, v98, v102
    v_cvt_pk_bf16_f32 v47, v62, v63
    v_mfma_f32_16x16x32_bf16 v[52:55], a[124:127], a[12:15], 0
    ds_read_b128 a[92:95], v8 offset:20480
    v_mul_f32_dpp v94, v34, v94 row_newbcast:2 row_mask:0xf bank_mask:0xf
    v_mul_f32_dpp v122, v36, v122 row_newbcast:2 row_mask:0xf bank_mask:0xf
    v_accvgpr_read_b32 v34, a228
    v_mfma_f32_16x16x32_bf16 v[52:55], a[120:123], a[8:11], v[52:55]
    ds_read_b64_tr_b16 a[174:175], v4 offset:34352
    v_cvt_pk_bf16_f32 v44, v56, v57
    v_mfma_f32_16x16x32_bf16 v[52:55], a[116:119], a[4:7], v[52:55]
    s_waitcnt lgkmcnt(9)
    v_cvt_pk_bf16_f32 v67, v73, v77
    v_mul_f32_dpp v108, v36, v108 row_newbcast:0 row_mask:0xf bank_mask:0xf
    v_mfma_f32_16x16x32_bf16 v[52:55], a[112:115], a[0:3], v[52:55]
    v_cvt_pk_bf16_f32 v83, v89, v93
    v_mul_f32_dpp v126, v36, v126 row_newbcast:2 row_mask:0xf bank_mask:0xf
    v_add_f32 v34, v34, v38
    v_smfmac_f32_16x16x64_bf16 a[232:235], a[248:251], v[40:47], v19
    ds_read_b64_tr_b16 a[168:169], v4 offset:33824
    v_exp_f32 v48, v48
    v_mfma_f32_16x16x32_bf16 v[224:227], v[44:47], a[192:195], v[224:227]
    v_exp_f32 v51, v51
    v_exp_f32 v53, v53
    v_mfma_f32_16x16x32_bf16 v[228:231], v[44:47], a[196:199], v[228:231]
    v_cvt_pk_bf16_f32 v65, v72, v76
    v_cvt_pk_bf16_f32 v85, v90, v94
    v_cvt_pk_bf16_f32 v87, v91, v95
    v_cvt_pk_bf16_f32 v102, v99, v103
    v_mul_f32_dpp v127, v36, v127 row_newbcast:3 row_mask:0xf bank_mask:0xf
    v_mfma_f32_16x16x32_bf16 v[232:235], v[44:47], a[200:203], v[232:235]
    ds_read_b64_tr_b16 a[182:183], v4 offset:34384
    v_cvt_pk_bf16_f32 v116, v114, v118
    v_exp_f32 v54, v54
    v_mfma_f32_16x16x32_bf16 v[236:239], v[44:47], a[204:207], v[236:239]
    ds_write_b128 v24, v[84:87] offset:512
    ds_read_b128 a[72:75], v7 offset:16384
    v_subrev_u32 v38, s38, v34
    v_mfma_f32_16x16x32_bf16 v[240:243], v[44:47], a[208:211], v[240:243]
    v_rcp_f32 v34, v34
    v_mfma_f32_16x16x32_bf16 v[244:247], v[44:47], a[212:215], v[244:247]
    v_cvt_pk_bf16_f32 v71, v75, v79
    v_mul_f32_dpp v117, v36, v117 row_newbcast:1 row_mask:0xf bank_mask:0xf
    v_exp_f32 v50, v50
    v_exp_f32 v52, v52
    v_mfma_f32_16x16x32_bf16 v[248:251], v[44:47], a[216:219], v[248:251]
    v_cvt_pk_bf16_f32 v81, v88, v92
    v_exp_f32 v55, v55
    v_mfma_f32_16x16x32_bf16 v[252:255], v[44:47], a[220:223], v[252:255]
    v_mul_f32_dpp v121, v36, v121 row_newbcast:1 row_mask:0xf bank_mask:0xf
    v_mov_b32_dpp v34, v34 row_ror:12 row_mask:0xa bank_mask:0xf
    v_exp_f32 v49, v49
    v_mfma_f32_16x16x32_bf16 v[56:59], a[96:99], a[16:19], 0
    v_mov_b32_dpp v34, v34 row_ror:8 row_mask:0xc bank_mask:0xf
    v_cvt_pk_bf16_f32 v43, v54, v55
    v_mfma_f32_16x16x32_bf16 v[56:59], a[100:103], a[20:23], v[56:59]
    v_cvt_pk_bf16_f32 v118, v115, v119
    v_mul_f32_dpp v129, v34, v129 row_newbcast:1 row_mask:0xf bank_mask:0xf
    v_accvgpr_read_b32 v39, a231
    v_mfma_f32_16x16x32_bf16 v[56:59], a[104:107], a[24:27], v[56:59]
    ds_write_b128 v23, v[68:71] offset:512
    v_mul_f32_dpp v131, v34, v131 row_newbcast:3 row_mask:0xf bank_mask:0xf
    v_mfma_f32_16x16x32_bf16 v[56:59], a[108:111], a[28:31], v[56:59]
    v_mul_f32_dpp v120, v36, v120 row_newbcast:0 row_mask:0xf bank_mask:0xf
    v_mul_f32_dpp v125, v36, v125 row_newbcast:1 row_mask:0xf bank_mask:0xf
    v_max_u32 v15, v15, v38
    v_cvt_pk_bf16_f32 v42, v52, v53
    v_mfma_f32_16x16x32_bf16 v[60:63], a[124:127], a[28:31], 0
    v_mul_f32_dpp v135, v34, v135 row_newbcast:3 row_mask:0xf bank_mask:0xf
    v_mul_f32_dpp v139, v34, v139 row_newbcast:3 row_mask:0xf bank_mask:0xf
    v_mul_f32_dpp v143, v34, v143 row_newbcast:3 row_mask:0xf bank_mask:0xf
    v_cvt_pk_bf16_f32 v41, v50, v51
    v_mfma_f32_16x16x32_bf16 v[60:63], a[120:123], a[24:27], v[60:63]
    v_mul_f32_dpp v141, v34, v141 row_newbcast:1 row_mask:0xf bank_mask:0xf
    v_exp_f32 v57, v57
    v_exp_f32 v58, v58
    v_exp_f32 v59, v59
    v_mfma_f32_16x16x32_bf16 v[60:63], a[116:119], a[20:23], v[60:63]
    ds_write_b128 v23, v[64:67] offset:0
    v_cvt_pk_bf16_f32 v114, v113, v117
    v_mul_f32_dpp v128, v34, v128 row_newbcast:0 row_mask:0xf bank_mask:0xf
    v_mul_f32_dpp v144, v34, v144 row_newbcast:0 row_mask:0xf bank_mask:0xf
    v_cvt_pk_bf16_f32 v40, v48, v49
    v_mfma_f32_16x16x32_bf16 v[60:63], a[112:115], a[16:19], v[60:63]
    s_waitcnt lgkmcnt(9)
    v_cvt_pk_bf16_f32 v117, v122, v126
    v_mul_f32_dpp v142, v34, v142 row_newbcast:2 row_mask:0xf bank_mask:0xf
    v_mfma_f32_16x16x32_bf16 v[64:67], v[40:43], a[160:163], 0
    v_mul_f32_dpp v132, v34, v132 row_newbcast:0 row_mask:0xf bank_mask:0xf
    v_mul_f32_dpp v147, v34, v147 row_newbcast:3 row_mask:0xf bank_mask:0xf
    v_accvgpr_read_b32 v36, a230
    v_mfma_f32_16x16x32_bf16 v[68:71], v[40:43], a[164:167], 0
    s_waitcnt lgkmcnt(5)
    v_exp_f32 v63, v63
    v_mfma_f32_16x16x32_bf16 v[72:75], v[40:43], a[168:171], 0
    v_mul_f32_dpp v134, v34, v134 row_newbcast:2 row_mask:0xf bank_mask:0xf
    v_mul_f32_dpp v145, v34, v145 row_newbcast:1 row_mask:0xf bank_mask:0xf
    v_mul_f32_dpp v148, v34, v148 row_newbcast:0 row_mask:0xf bank_mask:0xf
    v_mul_f32_dpp v149, v34, v149 row_newbcast:1 row_mask:0xf bank_mask:0xf
    v_mul_f32_dpp v151, v34, v151 row_newbcast:3 row_mask:0xf bank_mask:0xf
    v_mul_f32_dpp v152, v34, v152 row_newbcast:0 row_mask:0xf bank_mask:0xf
    v_add_f32 v36, v36, v39
    v_mfma_f32_16x16x32_bf16 v[76:79], v[40:43], a[172:175], 0
    ds_write_b128 v24, v[80:83] offset:0
    v_mul_f32_dpp v154, v34, v154 row_newbcast:2 row_mask:0xf bank_mask:0xf
    v_mfma_f32_16x16x32_bf16 v[80:83], v[40:43], a[176:179], 0
    s_waitcnt lgkmcnt(5)
    v_exp_f32 v56, v56
    v_mfma_f32_16x16x32_bf16 v[84:87], v[40:43], a[180:183], 0
    v_cvt_pk_bf16_f32 v99, v105, v109
    v_mul_f32_dpp v130, v34, v130 row_newbcast:2 row_mask:0xf bank_mask:0xf
    v_mul_f32_dpp v155, v34, v155 row_newbcast:3 row_mask:0xf bank_mask:0xf
    v_subrev_u32 v39, s38, v36
    v_exp_f32 v60, v60
    v_exp_f32 v62, v62
    v_mfma_f32_16x16x32_bf16 v[88:91], v[40:43], a[184:187], 0
    v_cvt_pk_bf16_f32 v98, v97, v101
    v_exp_f32 v61, v61
    v_cvt_pk_bf16_f32 v45, v58, v59
    v_mfma_f32_16x16x32_bf16 v[92:95], v[40:43], a[188:191], 0
    v_mul_f32_dpp v138, v34, v138 row_newbcast:2 row_mask:0xf bank_mask:0xf
    v_mul_f32_dpp v159, v34, v159 row_newbcast:3 row_mask:0xf bank_mask:0xf
    v_max_u32 v15, v15, v39
    v_mfma_f32_16x16x32_bf16 v[48:51], a[96:99], a[32:35], 0
    v_cvt_pk_bf16_f32 v103, v107, v111
    v_mul_f32_dpp v150, v34, v150 row_newbcast:2 row_mask:0xf bank_mask:0xf
    v_rcp_f32 v36, v36
    v_mfma_f32_16x16x32_bf16 v[48:51], a[100:103], a[36:39], v[48:51]
    v_cvt_pk_bf16_f32 v113, v120, v124
    v_cvt_pk_bf16_f32 v115, v121, v125
    v_cvt_pk_bf16_f32 v119, v123, v127
    v_mfma_f32_16x16x32_bf16 v[48:51], a[104:107], a[40:43], v[48:51]
    ds_write_b128 v24, v[112:115] offset:4096
    v_mul_f32_dpp v146, v34, v146 row_newbcast:2 row_mask:0xf bank_mask:0xf
    v_mfma_f32_16x16x32_bf16 v[48:51], a[108:111], a[44:47], v[48:51]
    v_cvt_pk_bf16_f32 v97, v104, v108
    v_cvt_pk_bf16_f32 v144, v144, v148
    v_cvt_pk_bf16_f32 v44, v56, v57
    v_cvt_pk_bf16_f32 v47, v62, v63
    v_mfma_f32_16x16x32_bf16 v[52:55], a[124:127], a[44:47], 0
    ds_write_b128 v23, v[96:99] offset:4096
    v_cvt_pk_bf16_f32 v101, v106, v110
    v_mul_f32_dpp v133, v34, v133 row_newbcast:1 row_mask:0xf bank_mask:0xf
    v_mfma_f32_16x16x32_bf16 v[52:55], a[120:123], a[40:43], v[52:55]
    v_cvt_pk_bf16_f32 v128, v128, v132
    v_cvt_pk_bf16_f32 v46, v60, v61
    v_mfma_f32_16x16x32_bf16 v[52:55], a[116:119], a[36:39], v[52:55]
    ds_write_b128 v24, v[116:119] offset:4608
    v_mul_f32_dpp v153, v34, v153 row_newbcast:1 row_mask:0xf bank_mask:0xf
    v_mov_b32_dpp v36, v36 row_ror:12 row_mask:0xa bank_mask:0xf
    v_mfma_f32_16x16x32_bf16 v[52:55], a[112:115], a[32:35], v[52:55]
    v_mul_f32_dpp v140, v34, v140 row_newbcast:0 row_mask:0xf bank_mask:0xf
    v_mul_f32_dpp v156, v34, v156 row_newbcast:0 row_mask:0xf bank_mask:0xf
    v_mov_b32_dpp v36, v36 row_ror:8 row_mask:0xc bank_mask:0xf
    v_smfmac_f32_16x16x64_bf16 a[236:239], a[248:251], v[40:47], v19
    ds_write_b128 v23, v[100:103] offset:4608
    v_mul_f32_dpp v163, v36, v163 row_newbcast:3 row_mask:0xf bank_mask:0xf
    v_mul_f32_dpp v164, v36, v164 row_newbcast:0 row_mask:0xf bank_mask:0xf
    v_mul_f32_dpp v167, v36, v167 row_newbcast:3 row_mask:0xf bank_mask:0xf
    v_mul_f32_dpp v171, v36, v171 row_newbcast:3 row_mask:0xf bank_mask:0xf
    v_mfma_f32_16x16x32_bf16 v[96:99], v[44:47], a[160:163], 0
    v_mul_f32_dpp v136, v34, v136 row_newbcast:0 row_mask:0xf bank_mask:0xf
    v_mul_f32_dpp v175, v36, v175 row_newbcast:3 row_mask:0xf bank_mask:0xf
    v_exp_f32 v48, v48
    v_mfma_f32_16x16x32_bf16 v[100:103], v[44:47], a[164:167], 0
    v_cvt_pk_bf16_f32 v132, v130, v134
    v_mul_f32_dpp v162, v36, v162 row_newbcast:2 row_mask:0xf bank_mask:0xf
    v_accvgpr_read_b32 v39, a235
    v_exp_f32 v54, v54
    v_mfma_f32_16x16x32_bf16 v[104:107], v[44:47], a[168:171], 0
    v_mul_f32_dpp v160, v36, v160 row_newbcast:0 row_mask:0xf bank_mask:0xf
    v_accvgpr_read_b32 v38, a233
    v_exp_f32 v51, v51
    v_exp_f32 v55, v55
    v_mfma_f32_16x16x32_bf16 v[108:111], v[44:47], a[172:175], 0
    v_mul_f32_dpp v166, v36, v166 row_newbcast:2 row_mask:0xf bank_mask:0xf
    v_mul_f32_dpp v174, v36, v174 row_newbcast:2 row_mask:0xf bank_mask:0xf
    v_mul_f32_dpp v176, v36, v176 row_newbcast:0 row_mask:0xf bank_mask:0xf
    v_mfma_f32_16x16x32_bf16 v[112:115], v[44:47], a[176:179], 0
    v_cvt_pk_bf16_f32 v134, v131, v135
    v_cvt_pk_bf16_f32 v160, v160, v164
    v_cvt_pk_bf16_f32 v164, v162, v166
    v_exp_f32 v49, v49
    v_mfma_f32_16x16x32_bf16 v[116:119], v[44:47], a[180:183], 0
    v_cvt_pk_bf16_f32 v130, v129, v133
    v_cvt_pk_bf16_f32 v135, v139, v143
    v_exp_f32 v50, v50
    v_mfma_f32_16x16x32_bf16 v[120:123], v[44:47], a[184:187], 0
    v_mul_f32_dpp v178, v36, v178 row_newbcast:2 row_mask:0xf bank_mask:0xf
    v_exp_f32 v52, v52
    v_mfma_f32_16x16x32_bf16 v[124:127], v[44:47], a[188:191], 0
    v_mul_f32_dpp v137, v34, v137 row_newbcast:1 row_mask:0xf bank_mask:0xf
    v_mul_f32_dpp v157, v34, v157 row_newbcast:1 row_mask:0xf bank_mask:0xf
    v_mul_f32_dpp v161, v36, v161 row_newbcast:1 row_mask:0xf bank_mask:0xf
    v_mfma_f32_16x16x32_bf16 v[56:59], a[96:99], a[48:51], 0
    v_cvt_pk_bf16_f32 v131, v137, v141
    v_cvt_pk_bf16_f32 v148, v146, v150
    v_mfma_f32_16x16x32_bf16 v[56:59], a[100:103], a[52:55], v[56:59]
    v_cvt_pk_bf16_f32 v150, v147, v151
    v_cvt_pk_bf16_f32 v41, v50, v51
    v_mfma_f32_16x16x32_bf16 v[56:59], a[104:107], a[56:59], v[56:59]
    v_cvt_pk_bf16_f32 v133, v138, v142
    v_cvt_pk_bf16_f32 v151, v155, v159
    v_cvt_pk_bf16_f32 v43, v54, v55
    v_mfma_f32_16x16x32_bf16 v[56:59], a[108:111], a[60:63], v[56:59]
    v_mul_f32_dpp v179, v36, v179 row_newbcast:3 row_mask:0xf bank_mask:0xf
    v_exp_f32 v53, v53
    v_cvt_pk_bf16_f32 v40, v48, v49
    v_mfma_f32_16x16x32_bf16 v[60:63], a[124:127], a[60:63], 0
    v_cvt_pk_bf16_f32 v129, v136, v140
    v_mul_f32_dpp v165, v36, v165 row_newbcast:1 row_mask:0xf bank_mask:0xf
    v_mul_f32_dpp v182, v36, v182 row_newbcast:2 row_mask:0xf bank_mask:0xf
    v_mul_f32_dpp v183, v36, v183 row_newbcast:3 row_mask:0xf bank_mask:0xf
    v_cvt_pk_bf16_f32 v42, v52, v53
    v_mfma_f32_16x16x32_bf16 v[60:63], a[120:123], a[56:59], v[60:63]
    ds_write_b128 v23, v[128:131] offset:8192
    v_mul_f32_dpp v158, v34, v158 row_newbcast:2 row_mask:0xf bank_mask:0xf
    v_mul_f32_dpp v180, v36, v180 row_newbcast:0 row_mask:0xf bank_mask:0xf
    v_mul_f32_dpp v187, v36, v187 row_newbcast:3 row_mask:0xf bank_mask:0xf
    v_cvt_pk_bf16_f32 v176, v176, v180
    v_exp_f32 v57, v57
    v_exp_f32 v58, v58
    v_mfma_f32_16x16x32_bf16 v[60:63], a[116:119], a[52:55], v[60:63]
    v_cvt_pk_bf16_f32 v146, v145, v149
    v_cvt_pk_bf16_f32 v149, v154, v158
    v_mul_f32_dpp v169, v36, v169 row_newbcast:1 row_mask:0xf bank_mask:0xf
    v_mul_f32_dpp v190, v36, v190 row_newbcast:2 row_mask:0xf bank_mask:0xf
    v_mfma_f32_16x16x32_bf16 v[60:63], a[112:115], a[48:51], v[60:63]
    v_cvt_pk_bf16_f32 v147, v153, v157
    v_accvgpr_read_b32 v34, a232
    v_mfma_f32_16x16x32_bf16 v[128:131], v[40:43], a[160:163], 0
    ds_write_b128 v23, v[132:135] offset:8704
    v_mul_f32_dpp v170, v36, v170 row_newbcast:2 row_mask:0xf bank_mask:0xf
    v_cvt_pk_bf16_f32 v166, v163, v167
    v_add_f32 v34, v34, v38
    v_subrev_u32 v38, s38, v34
    v_mfma_f32_16x16x32_bf16 v[132:135], v[40:43], a[164:167], 0
    v_cvt_pk_bf16_f32 v145, v152, v156
    v_mul_f32_dpp v173, v36, v173 row_newbcast:1 row_mask:0xf bank_mask:0xf
    v_cvt_pk_bf16_f32 v163, v169, v173
    v_mul_f32_dpp v177, v36, v177 row_newbcast:1 row_mask:0xf bank_mask:0xf
    v_cvt_pk_bf16_f32 v180, v178, v182
    v_mfma_f32_16x16x32_bf16 v[136:139], v[40:43], a[168:171], 0
    ds_write_b128 v24, v[144:147] offset:8192
    v_mul_f32_dpp v181, v36, v181 row_newbcast:1 row_mask:0xf bank_mask:0xf
    v_exp_f32 v56, v56
    v_mfma_f32_16x16x32_bf16 v[140:143], v[40:43], a[172:175], 0
    v_rcp_f32 v34, v34
    v_mfma_f32_16x16x32_bf16 v[144:147], v[40:43], a[176:179], 0
    ds_write_b128 v24, v[148:151] offset:8704
    v_mul_f32_dpp v168, v36, v168 row_newbcast:0 row_mask:0xf bank_mask:0xf
    v_cvt_pk_bf16_f32 v167, v171, v175
    v_exp_f32 v62, v62
    v_mfma_f32_16x16x32_bf16 v[148:151], v[40:43], a[180:183], 0
    v_mul_f32_dpp v172, v36, v172 row_newbcast:0 row_mask:0xf bank_mask:0xf
    v_cvt_pk_bf16_f32 v162, v161, v165
    v_mul_f32_dpp v184, v36, v184 row_newbcast:0 row_mask:0xf bank_mask:0xf
    v_mfma_f32_16x16x32_bf16 v[152:155], v[40:43], a[184:187], 0
    v_mul_f32_dpp v189, v36, v189 row_newbcast:1 row_mask:0xf bank_mask:0xf
    v_cvt_pk_bf16_f32 v182, v179, v183
    v_mfma_f32_16x16x32_bf16 v[156:159], v[40:43], a[188:191], 0
    v_exp_f32 v59, v59
    v_exp_f32 v63, v63
    v_mfma_f32_16x16x32_bf16 v[48:51], a[96:99], a[64:67], 0
    v_cvt_pk_bf16_f32 v161, v168, v172
    v_exp_f32 v60, v60
    v_cvt_pk_bf16_f32 v44, v56, v57
    v_mfma_f32_16x16x32_bf16 v[48:51], a[100:103], a[68:71], v[48:51]
    s_waitcnt lgkmcnt(11)
    v_cvt_pk_bf16_f32 v165, v170, v174
    v_mov_b32_dpp v34, v34 row_ror:12 row_mask:0xa bank_mask:0xf
    v_mfma_f32_16x16x32_bf16 v[48:51], a[104:107], a[72:75], v[48:51]
    v_mul_f32_dpp v191, v36, v191 row_newbcast:3 row_mask:0xf bank_mask:0xf
    v_cvt_pk_bf16_f32 v178, v177, v181
    v_mov_b32_dpp v34, v34 row_ror:8 row_mask:0xc bank_mask:0xf
    v_cvt_pk_bf16_f32 v45, v58, v59
    v_cvt_pk_bf16_f32 v47, v62, v63
    v_mfma_f32_16x16x32_bf16 v[48:51], a[108:111], a[76:79], v[48:51]
    v_mul_f32_dpp v186, v36, v186 row_newbcast:2 row_mask:0xf bank_mask:0xf
    v_cvt_pk_bf16_f32 v183, v187, v191
    v_mfma_f32_16x16x32_bf16 v[52:55], a[124:127], a[76:79], 0
    ds_write_b128 v23, v[160:163] offset:12288
    v_exp_f32 v61, v61
    v_mfma_f32_16x16x32_bf16 v[52:55], a[120:123], a[72:75], v[52:55]
    v_mul_f32_dpp v185, v36, v185 row_newbcast:1 row_mask:0xf bank_mask:0xf
    v_mul_f32_dpp v195, v34, v195 row_newbcast:3 row_mask:0xf bank_mask:0xf
    v_mul_f32_dpp v199, v34, v199 row_newbcast:3 row_mask:0xf bank_mask:0xf
    v_mul_f32_dpp v203, v34, v203 row_newbcast:3 row_mask:0xf bank_mask:0xf
    v_cvt_pk_bf16_f32 v46, v60, v61
    v_mfma_f32_16x16x32_bf16 v[52:55], a[116:119], a[68:71], v[52:55]
    ds_write_b128 v23, v[164:167] offset:12800
    v_mul_f32_dpp v188, v36, v188 row_newbcast:0 row_mask:0xf bank_mask:0xf
    v_cvt_pk_bf16_f32 v181, v186, v190
    v_mul_f32_dpp v201, v34, v201 row_newbcast:1 row_mask:0xf bank_mask:0xf
    v_mul_f32_dpp v204, v34, v204 row_newbcast:0 row_mask:0xf bank_mask:0xf
    v_mfma_f32_16x16x32_bf16 v[52:55], a[112:115], a[64:67], v[52:55]
    ds_write_b128 v24, v[180:183] offset:12800
    v_exp_f32 v51, v51
    v_smfmac_f32_16x16x64_bf16 a[240:243], a[248:251], v[40:47], v19
    s_barrier
    ds_read_b128 a[156:159], v3 offset:9152
    ds_read_b64_tr_b16 a[218:219], v4 offset:42848
    v_cvt_pk_bf16_f32 v179, v185, v189
    v_mul_f32_dpp v205, v34, v205 row_newbcast:1 row_mask:0xf bank_mask:0xf
    v_accvgpr_read_b32 v36, a234
    v_add_f32 v36, v36, v39
    v_mfma_f32_16x16x32_bf16 v[160:163], v[44:47], a[160:163], 0
    ds_read_b64_tr_b16 a[198:199], v4 offset:42768
    v_subrev_u32 v39, s38, v36
    v_mfma_f32_16x16x32_bf16 v[164:167], v[44:47], a[164:167], 0
    ds_read_b128 a[128:131], v3 offset:8448
    ds_read_b64_tr_b16 a[214:215], v4 offset:42832
    v_mul_f32_dpp v207, v34, v207 row_newbcast:3 row_mask:0xf bank_mask:0xf
    v_mul_f32_dpp v211, v34, v211 row_newbcast:3 row_mask:0xf bank_mask:0xf
    v_mul_f32_dpp v215, v34, v215 row_newbcast:3 row_mask:0xf bank_mask:0xf
    v_mul_f32_dpp v217, v34, v217 row_newbcast:1 row_mask:0xf bank_mask:0xf
    v_mul_f32_dpp v219, v34, v219 row_newbcast:3 row_mask:0xf bank_mask:0xf
    v_mul_f32_dpp v222, v34, v222 row_newbcast:2 row_mask:0xf bank_mask:0xf
    v_mul_f32_dpp v223, v34, v223 row_newbcast:3 row_mask:0xf bank_mask:0xf
    v_exp_f32 v52, v52
    v_mfma_f32_16x16x32_bf16 v[168:171], v[44:47], a[168:171], 0
    ds_read_b128 a[148:151], v3 offset:9024
    v_cvt_pk_bf16_f32 v177, v184, v188
    v_mul_f32_dpp v216, v34, v216 row_newbcast:0 row_mask:0xf bank_mask:0xf
    v_exp_f32 v53, v53
    v_exp_f32 v54, v54
    v_mfma_f32_16x16x32_bf16 v[172:175], v[44:47], a[172:175], 0
    ds_write_b128 v24, v[176:179] offset:12288
    v_mul_f32_dpp v192, v34, v192 row_newbcast:0 row_mask:0xf bank_mask:0xf
    v_mul_f32_dpp v209, v34, v209 row_newbcast:1 row_mask:0xf bank_mask:0xf
    v_rcp_f32 v36, v36
    v_mfma_f32_16x16x32_bf16 v[176:179], v[44:47], a[176:179], 0
    ds_read_b128 a[136:139], v3 offset:8576
    v_mul_f32_dpp v193, v34, v193 row_newbcast:1 row_mask:0xf bank_mask:0xf
    v_mul_f32_dpp v194, v34, v194 row_newbcast:2 row_mask:0xf bank_mask:0xf
    v_mul_f32_dpp v196, v34, v196 row_newbcast:0 row_mask:0xf bank_mask:0xf
    v_mul_f32_dpp v213, v34, v213 row_newbcast:1 row_mask:0xf bank_mask:0xf
    v_mul_f32_dpp v214, v34, v214 row_newbcast:2 row_mask:0xf bank_mask:0xf
    v_mfma_f32_16x16x32_bf16 v[180:183], v[44:47], a[180:183], 0
    v_mul_f32_dpp v198, v34, v198 row_newbcast:2 row_mask:0xf bank_mask:0xf
    v_mul_f32_dpp v208, v34, v208 row_newbcast:0 row_mask:0xf bank_mask:0xf
    v_mul_f32_dpp v210, v34, v210 row_newbcast:2 row_mask:0xf bank_mask:0xf
    v_mul_f32_dpp v212, v34, v212 row_newbcast:0 row_mask:0xf bank_mask:0xf
    v_mfma_f32_16x16x32_bf16 v[184:187], v[44:47], a[184:187], 0
    ds_read_b128 a[132:135], v3 offset:8512
    ds_read_b128 a[152:155], v3 offset:9088
    v_cvt_pk_bf16_f32 v192, v192, v196
    v_mfma_f32_16x16x32_bf16 v[188:191], v[44:47], a[188:191], 0
    v_mul_f32_dpp v200, v34, v200 row_newbcast:0 row_mask:0xf bank_mask:0xf
    v_mul_f32_dpp v206, v34, v206 row_newbcast:2 row_mask:0xf bank_mask:0xf
    v_cvt_pk_bf16_f32 v196, v194, v198
    v_mul_f32_dpp v218, v34, v218 row_newbcast:2 row_mask:0xf bank_mask:0xf
    v_mfma_f32_16x16x32_bf16 v[56:59], a[96:99], a[80:83], 0
    ds_read_b64_tr_b16 a[200:201], v4 offset:42272
    ds_read_b64_tr_b16 a[204:205], v4 offset:42288
    v_mul_f32_dpp v220, v34, v220 row_newbcast:0 row_mask:0xf bank_mask:0xf
    v_cvt_pk_bf16_f32 v208, v208, v212
    v_mov_b32_dpp v36, v36 row_ror:12 row_mask:0xa bank_mask:0xf
    v_mfma_f32_16x16x32_bf16 v[56:59], a[100:103], a[84:87], v[56:59]
    ds_read_b128 a[144:147], v3 offset:8960
    v_cvt_pk_bf16_f32 v198, v195, v199
    v_mov_b32_dpp v36, v36 row_ror:8 row_mask:0xc bank_mask:0xf
    v_exp_f32 v49, v49
    v_mfma_f32_16x16x32_bf16 v[56:59], a[104:107], a[88:91], v[56:59]
    v_cvt_pk_bf16_f32 v199, v203, v207
    v_cvt_pk_bf16_f32 v212, v210, v214
    v_mul_f32_dpp v225, v36, v225 row_newbcast:1 row_mask:0xf bank_mask:0xf
    v_exp_f32 v48, v48
    v_mfma_f32_16x16x32_bf16 v[56:59], a[108:111], a[92:95], v[56:59]
    ds_read_b64_tr_b16 a[222:223], v4 offset:42864
    v_mul_f32_dpp v221, v34, v221 row_newbcast:1 row_mask:0xf bank_mask:0xf
    v_cvt_pk_bf16_f32 v214, v211, v215
    v_mul_f32_dpp v224, v36, v224 row_newbcast:0 row_mask:0xf bank_mask:0xf
    v_mul_f32_dpp v227, v36, v227 row_newbcast:3 row_mask:0xf bank_mask:0xf
    v_exp_f32 v55, v55
    v_cvt_pk_bf16_f32 v42, v52, v53
    v_mfma_f32_16x16x32_bf16 v[60:63], a[124:127], a[92:95], 0
    v_mul_f32_dpp v197, v34, v197 row_newbcast:1 row_mask:0xf bank_mask:0xf
    v_cvt_pk_bf16_f32 v194, v193, v197
    v_cvt_pk_bf16_f32 v193, v200, v204
    v_cvt_pk_bf16_f32 v195, v201, v205
    v_mul_f32_dpp v229, v36, v229 row_newbcast:1 row_mask:0xf bank_mask:0xf
    v_mfma_f32_16x16x32_bf16 v[60:63], a[120:123], a[88:91], v[60:63]
    ds_read_b64_tr_b16 a[216:217], v4 offset:42336
    v_mul_f32_dpp v202, v34, v202 row_newbcast:2 row_mask:0xf bank_mask:0xf
    v_mul_f32_dpp v231, v36, v231 row_newbcast:3 row_mask:0xf bank_mask:0xf
    v_exp_f32 v50, v50
    v_cvt_pk_bf16_f32 v43, v54, v55
    v_exp_f32 v59, v59
    v_mfma_f32_16x16x32_bf16 v[60:63], a[116:119], a[84:87], v[60:63]
    ds_write_b128 v23, v[192:195] offset:16384
    ds_read_b64_tr_b16 a[196:197], v4 offset:42256
    v_cvt_pk_bf16_f32 v197, v202, v206
    v_cvt_pk_bf16_f32 v210, v209, v213
    v_mul_f32_dpp v232, v36, v232 row_newbcast:0 row_mask:0xf bank_mask:0xf
    v_cvt_pk_bf16_f32 v40, v48, v49
    v_cvt_pk_bf16_f32 v41, v50, v51
    v_mfma_f32_16x16x32_bf16 v[60:63], a[112:115], a[80:83], v[60:63]
    ds_write_b128 v23, v[196:199] offset:16896
    v_cvt_pk_bf16_f32 v211, v217, v221
    v_mfma_f32_16x16x32_bf16 v[192:195], v[40:43], a[160:163], 0
    v_cvt_pk_bf16_f32 v215, v219, v223
    v_mul_f32_dpp v228, v36, v228 row_newbcast:0 row_mask:0xf bank_mask:0xf
    v_exp_f32 v56, v56
    v_exp_f32 v57, v57
    v_mfma_f32_16x16x32_bf16 v[196:199], v[40:43], a[164:167], 0
    v_cvt_pk_bf16_f32 v209, v216, v220
    v_mul_f32_dpp v235, v36, v235 row_newbcast:3 row_mask:0xf bank_mask:0xf
    v_mul_f32_dpp v239, v36, v239 row_newbcast:3 row_mask:0xf bank_mask:0xf
    v_mfma_f32_16x16x32_bf16 v[200:203], v[40:43], a[168:171], 0
    v_cvt_pk_bf16_f32 v213, v218, v222
    v_mul_f32_dpp v233, v36, v233 row_newbcast:1 row_mask:0xf bank_mask:0xf
    v_mfma_f32_16x16x32_bf16 v[204:207], v[40:43], a[172:175], 0
    ds_write_b128 v24, v[208:211] offset:16384
    ds_read_b128 a[140:143], v3 offset:8640
    ds_read_b64_tr_b16 a[202:203], v4 offset:42784
    v_cvt_pk_bf16_f32 v224, v224, v228
    v_mul_f32_dpp v243, v36, v243 row_newbcast:3 row_mask:0xf bank_mask:0xf
    v_mul_f32_dpp v247, v36, v247 row_newbcast:3 row_mask:0xf bank_mask:0xf
    v_mul_f32_dpp v251, v36, v251 row_newbcast:3 row_mask:0xf bank_mask:0xf
    v_exp_f32 v63, v63
    v_mfma_f32_16x16x32_bf16 v[208:211], v[40:43], a[176:179], 0
    ds_write_b128 v24, v[212:215] offset:16896
    v_mul_f32_dpp v230, v36, v230 row_newbcast:2 row_mask:0xf bank_mask:0xf
    v_mul_f32_dpp v250, v36, v250 row_newbcast:2 row_mask:0xf bank_mask:0xf
    v_exp_f32 v58, v58
    v_exp_f32 v62, v62
    v_mfma_f32_16x16x32_bf16 v[212:215], v[40:43], a[180:183], 0
    v_mul_f32_dpp v226, v36, v226 row_newbcast:2 row_mask:0xf bank_mask:0xf
    v_mul_f32_dpp v237, v36, v237 row_newbcast:1 row_mask:0xf bank_mask:0xf
    v_cvt_pk_bf16_f32 v228, v226, v230
    v_mfma_f32_16x16x32_bf16 v[216:219], v[40:43], a[184:187], 0
    ds_read_b64_tr_b16 a[206:207], v4 offset:42800
    v_mul_f32_dpp v234, v36, v234 row_newbcast:2 row_mask:0xf bank_mask:0xf
    v_mul_f32_dpp v236, v36, v236 row_newbcast:0 row_mask:0xf bank_mask:0xf
    v_mfma_f32_16x16x32_bf16 v[220:223], v[40:43], a[188:191], 0
    s_waitcnt lgkmcnt(15)
    ds_read_b64_tr_b16 a[194:195], v4 offset:42752
    v_cvt_pk_bf16_f32 v230, v227, v231
    v_cvt_pk_bf16_f32 v227, v233, v237
    v_mfma_f32_16x16x32_bf16 v[48:51], a[128:131], a[0:3], 0
    s_waitcnt lgkmcnt(15)
    v_cvt_pk_bf16_f32 v226, v225, v229
    v_cvt_pk_bf16_f32 v225, v232, v236
    v_mul_f32_dpp v240, v36, v240 row_newbcast:0 row_mask:0xf bank_mask:0xf
    v_mfma_f32_16x16x32_bf16 v[48:51], a[132:135], a[4:7], v[48:51]
    ds_write_b128 v23, v[224:227] offset:20480
    v_mul_f32_dpp v252, v36, v252 row_newbcast:0 row_mask:0xf bank_mask:0xf
    v_cvt_pk_bf16_f32 v44, v56, v57
    v_mfma_f32_16x16x32_bf16 v[48:51], a[136:139], a[8:11], v[48:51]
    s_waitcnt lgkmcnt(5)
    v_mul_f32_dpp v238, v36, v238 row_newbcast:2 row_mask:0xf bank_mask:0xf
    v_mul_f32_dpp v244, v36, v244 row_newbcast:0 row_mask:0xf bank_mask:0xf
    v_exp_f32 v61, v61
    v_cvt_pk_bf16_f32 v47, v62, v63
    v_mfma_f32_16x16x32_bf16 v[48:51], a[140:143], a[12:15], v[48:51]
    v_mul_f32_dpp v253, v36, v253 row_newbcast:1 row_mask:0xf bank_mask:0xf
    v_exp_f32 v60, v60
    v_mfma_f32_16x16x32_bf16 v[52:55], a[156:159], a[12:15], 0
    v_cvt_pk_bf16_f32 v45, v58, v59
    v_cvt_pk_bf16_f32 v46, v60, v61
    v_mfma_f32_16x16x32_bf16 v[52:55], a[152:155], a[8:11], v[52:55]
    ds_read_b64_tr_b16 a[192:193], v4 offset:42240
    v_cvt_pk_bf16_f32 v229, v234, v238
    v_mul_f32_dpp v248, v36, v248 row_newbcast:0 row_mask:0xf bank_mask:0xf
    v_mfma_f32_16x16x32_bf16 v[52:55], a[148:151], a[4:7], v[52:55]
    v_mul_f32_dpp v242, v36, v242 row_newbcast:2 row_mask:0xf bank_mask:0xf
    v_mul_f32_dpp v245, v36, v245 row_newbcast:1 row_mask:0xf bank_mask:0xf
    v_mfma_f32_16x16x32_bf16 v[52:55], a[144:147], a[0:3], v[52:55]
    v_cvt_pk_bf16_f32 v231, v235, v239
    v_mul_f32_dpp v246, v36, v246 row_newbcast:2 row_mask:0xf bank_mask:0xf
    v_mul_f32_dpp v255, v36, v255 row_newbcast:3 row_mask:0xf bank_mask:0xf
    v_smfmac_f32_16x16x64_bf16 a[244:247], a[248:251], v[40:47], v19
    ds_write_b128 v23, v[228:231] offset:20992
    v_mul_f32_dpp v241, v36, v241 row_newbcast:1 row_mask:0xf bank_mask:0xf
    v_mfma_f32_16x16x32_bf16 v[224:227], v[44:47], a[160:163], 0
    v_mul_f32_dpp v249, v36, v249 row_newbcast:1 row_mask:0xf bank_mask:0xf
    v_mul_f32_dpp v254, v36, v254 row_newbcast:2 row_mask:0xf bank_mask:0xf
    v_cvt_pk_bf16_f32 v240, v240, v244
    v_cvt_pk_bf16_f32 v244, v242, v246
    v_cvt_pk_bf16_f32 v246, v243, v247
    v_mfma_f32_16x16x32_bf16 v[228:231], v[44:47], a[164:167], 0
    v_cvt_pk_bf16_f32 v242, v241, v245
    v_cvt_pk_bf16_f32 v241, v248, v252
    v_cvt_pk_bf16_f32 v243, v249, v253
    v_exp_f32 v51, v51
    v_mfma_f32_16x16x32_bf16 v[232:235], v[44:47], a[168:171], 0
    v_cvt_pk_bf16_f32 v245, v250, v254
    v_cvt_pk_bf16_f32 v247, v251, v255
    v_mfma_f32_16x16x32_bf16 v[236:239], v[44:47], a[172:175], 0
    ds_write_b128 v24, v[240:243] offset:20480
    v_mfma_f32_16x16x32_bf16 v[240:243], v[44:47], a[176:179], 0
    ds_write_b128 v24, v[244:247] offset:20992
    v_mfma_f32_16x16x32_bf16 v[244:247], v[44:47], a[180:183], 0
    v_exp_f32 v54, v54
    v_mfma_f32_16x16x32_bf16 v[248:251], v[44:47], a[184:187], 0
    v_exp_f32 v55, v55
    v_mfma_f32_16x16x32_bf16 v[252:255], v[44:47], a[188:191], 0
    v_exp_f32 v50, v50
    v_mfma_f32_16x16x32_bf16 v[56:59], a[128:131], a[16:19], 0
    v_exp_f32 v49, v49
    v_mfma_f32_16x16x32_bf16 v[56:59], a[132:135], a[20:23], v[56:59]
    v_exp_f32 v53, v53
    v_mfma_f32_16x16x32_bf16 v[56:59], a[136:139], a[24:27], v[56:59]
    v_exp_f32 v48, v48
    v_mfma_f32_16x16x32_bf16 v[56:59], a[140:143], a[28:31], v[56:59]
    v_exp_f32 v52, v52
    v_mfma_f32_16x16x32_bf16 v[60:63], a[156:159], a[28:31], 0
    v_cvt_pk_bf16_f32 v42, v52, v53
    v_cvt_pk_bf16_f32 v43, v54, v55
    v_mfma_f32_16x16x32_bf16 v[60:63], a[152:155], a[24:27], v[60:63]
    ds_read_b64_tr_b16 a[210:211], v4 offset:42816
    v_cvt_pk_bf16_f32 v41, v50, v51
    v_mfma_f32_16x16x32_bf16 v[60:63], a[148:151], a[20:23], v[60:63]
    ds_read_b64_tr_b16 a[212:213], v4 offset:42320
    v_cvt_pk_bf16_f32 v40, v48, v49
    v_mfma_f32_16x16x32_bf16 v[60:63], a[144:147], a[16:19], v[60:63]
    s_waitcnt lgkmcnt(5)
    ds_read_b64_tr_b16 a[208:209], v4 offset:42304
    v_mfma_f32_16x16x32_bf16 v[64:67], v[40:43], a[192:195], v[64:67]
    v_exp_f32 v59, v59
    v_mfma_f32_16x16x32_bf16 v[68:71], v[40:43], a[196:199], v[68:71]
    v_max_u32 v15, v15, v38
    v_mfma_f32_16x16x32_bf16 v[72:75], v[40:43], a[200:203], v[72:75]
    ds_read_b64_tr_b16 a[220:221], v4 offset:42352
    v_mfma_f32_16x16x32_bf16 v[76:79], v[40:43], a[204:207], v[76:79]
    s_waitcnt lgkmcnt(1)
    v_exp_f32 v62, v62
    v_mfma_f32_16x16x32_bf16 v[80:83], v[40:43], a[208:211], v[80:83]
    v_exp_f32 v56, v56
    v_mfma_f32_16x16x32_bf16 v[84:87], v[40:43], a[212:215], v[84:87]
    v_exp_f32 v57, v57
    v_mfma_f32_16x16x32_bf16 v[88:91], v[40:43], a[216:219], v[88:91]
    s_waitcnt lgkmcnt(0)
    v_exp_f32 v61, v61
    v_mfma_f32_16x16x32_bf16 v[92:95], v[40:43], a[220:223], v[92:95]
    v_mfma_f32_16x16x32_bf16 v[48:51], a[128:131], a[32:35], 0
    v_exp_f32 v58, v58
    v_mfma_f32_16x16x32_bf16 v[48:51], a[132:135], a[36:39], v[48:51]
    v_exp_f32 v60, v60
    v_mfma_f32_16x16x32_bf16 v[48:51], a[136:139], a[40:43], v[48:51]
    v_exp_f32 v63, v63
    v_mfma_f32_16x16x32_bf16 v[48:51], a[140:143], a[44:47], v[48:51]
    v_cvt_pk_bf16_f32 v45, v58, v59
    v_mfma_f32_16x16x32_bf16 v[52:55], a[156:159], a[44:47], 0
    v_cvt_pk_bf16_f32 v44, v56, v57
    v_cvt_pk_bf16_f32 v46, v60, v61
    v_mfma_f32_16x16x32_bf16 v[52:55], a[152:155], a[40:43], v[52:55]
    v_mfma_f32_16x16x32_bf16 v[52:55], a[148:151], a[36:39], v[52:55]
    v_cvt_pk_bf16_f32 v47, v62, v63
    v_mfma_f32_16x16x32_bf16 v[52:55], a[144:147], a[32:35], v[52:55]
    v_max_u32 v15, v15, v39
    s_waitcnt lgkmcnt(0)
.p2align 5
L_A2:
    v_smfmac_f32_16x16x64_bf16 a[236:239], a[248:251], v[40:47], v19
    s_add_u32 s29, s29, 2
    s_xor_b32 s30, s30, 16896
    v_add_u32 v3, s30, v1
    v_mfma_f32_16x16x32_bf16 v[96:99], v[44:47], a[192:195], v[96:99]
    v_exp_f32 v48, v48
    v_mfma_f32_16x16x32_bf16 v[100:103], v[44:47], a[196:199], v[100:103]
    v_exp_f32 v49, v49
    v_mfma_f32_16x16x32_bf16 v[104:107], v[44:47], a[200:203], v[104:107]
    v_exp_f32 v50, v50
    v_mfma_f32_16x16x32_bf16 v[108:111], v[44:47], a[204:207], v[108:111]
    v_exp_f32 v51, v51
    v_mfma_f32_16x16x32_bf16 v[112:115], v[44:47], a[208:211], v[112:115]
    v_exp_f32 v52, v52
    v_mfma_f32_16x16x32_bf16 v[116:119], v[44:47], a[212:215], v[116:119]
    v_exp_f32 v53, v53
    v_mfma_f32_16x16x32_bf16 v[120:123], v[44:47], a[216:219], v[120:123]
    v_exp_f32 v54, v54
    v_mfma_f32_16x16x32_bf16 v[124:127], v[44:47], a[220:223], v[124:127]
    v_exp_f32 v55, v55
    v_mfma_f32_16x16x32_bf16 v[56:59], a[128:131], a[48:51], 0
    v_cvt_pk_bf16_f32 v40, v48, v49
    v_cvt_pk_bf16_f32 v41, v50, v51
    v_mfma_f32_16x16x32_bf16 v[56:59], a[132:135], a[52:55], v[56:59]
    v_cvt_pk_bf16_f32 v42, v52, v53
    v_cvt_pk_bf16_f32 v43, v54, v55
    v_mfma_f32_16x16x32_bf16 v[56:59], a[136:139], a[56:59], v[56:59]
    v_add_u32 v4, s30, v2
    v_mfma_f32_16x16x32_bf16 v[56:59], a[140:143], a[60:63], v[56:59]
    v_mfma_f32_16x16x32_bf16 v[60:63], a[156:159], a[60:63], 0
    v_mfma_f32_16x16x32_bf16 v[60:63], a[152:155], a[56:59], v[60:63]
    v_exp_f32 v56, v56
    v_mfma_f32_16x16x32_bf16 v[60:63], a[148:151], a[52:55], v[60:63]
    v_exp_f32 v57, v57
    v_mfma_f32_16x16x32_bf16 v[60:63], a[144:147], a[48:51], v[60:63]
    v_exp_f32 v58, v58
    v_mfma_f32_16x16x32_bf16 v[128:131], v[40:43], a[192:195], v[128:131]
    v_exp_f32 v59, v59
    v_mfma_f32_16x16x32_bf16 v[132:135], v[40:43], a[196:199], v[132:135]
    v_exp_f32 v60, v60
    v_mfma_f32_16x16x32_bf16 v[136:139], v[40:43], a[200:203], v[136:139]
    v_exp_f32 v61, v61
    v_mfma_f32_16x16x32_bf16 v[140:143], v[40:43], a[204:207], v[140:143]
    v_exp_f32 v62, v62
    v_mfma_f32_16x16x32_bf16 v[144:147], v[40:43], a[208:211], v[144:147]
    v_exp_f32 v63, v63
    v_mfma_f32_16x16x32_bf16 v[148:151], v[40:43], a[212:215], v[148:151]
    v_cvt_pk_bf16_f32 v44, v56, v57
    v_cvt_pk_bf16_f32 v45, v58, v59
    v_mfma_f32_16x16x32_bf16 v[152:155], v[40:43], a[216:219], v[152:155]
    v_cvt_pk_bf16_f32 v46, v60, v61
    v_cvt_pk_bf16_f32 v47, v62, v63
    v_mfma_f32_16x16x32_bf16 v[156:159], v[40:43], a[220:223], v[156:159]
    v_mfma_f32_16x16x32_bf16 v[48:51], a[128:131], a[64:67], 0
    v_mfma_f32_16x16x32_bf16 v[48:51], a[132:135], a[68:71], v[48:51]
    v_mfma_f32_16x16x32_bf16 v[48:51], a[136:139], a[72:75], v[48:51]
    v_mfma_f32_16x16x32_bf16 v[48:51], a[140:143], a[76:79], v[48:51]
    v_mfma_f32_16x16x32_bf16 v[52:55], a[156:159], a[76:79], 0
    v_mfma_f32_16x16x32_bf16 v[52:55], a[152:155], a[72:75], v[52:55]
    v_exp_f32 v48, v48
    v_mfma_f32_16x16x32_bf16 v[52:55], a[148:151], a[68:71], v[52:55]
    v_exp_f32 v49, v49
    v_mfma_f32_16x16x32_bf16 v[52:55], a[144:147], a[64:67], v[52:55]
    v_exp_f32 v50, v50
    v_smfmac_f32_16x16x64_bf16 a[240:243], a[248:251], v[40:47], v19
    s_barrier
    v_mfma_f32_16x16x32_bf16 v[160:163], v[44:47], a[192:195], v[160:163]
    ds_read_b128 a[96:99], v3 offset:0
    v_cvt_pk_bf16_f32 v40, v48, v49
    v_mfma_f32_16x16x32_bf16 v[164:167], v[44:47], a[196:199], v[164:167]
    v_exp_f32 v51, v51
    v_mfma_f32_16x16x32_bf16 v[168:171], v[44:47], a[200:203], v[168:171]
    ds_read_b128 a[100:103], v3 offset:64
    v_cvt_pk_bf16_f32 v41, v50, v51
    v_mfma_f32_16x16x32_bf16 v[172:175], v[44:47], a[204:207], v[172:175]
    v_exp_f32 v52, v52
    v_mfma_f32_16x16x32_bf16 v[176:179], v[44:47], a[208:211], v[176:179]
    ds_read_b128 a[104:107], v3 offset:128
    v_mfma_f32_16x16x32_bf16 v[180:183], v[44:47], a[212:215], v[180:183]
    v_exp_f32 v53, v53
    v_mfma_f32_16x16x32_bf16 v[184:187], v[44:47], a[216:219], v[184:187]
    ds_read_b128 a[108:111], v3 offset:192
    v_cvt_pk_bf16_f32 v42, v52, v53
    v_mfma_f32_16x16x32_bf16 v[188:191], v[44:47], a[220:223], v[188:191]
    v_exp_f32 v54, v54
    v_mfma_f32_16x16x32_bf16 v[56:59], a[128:131], a[80:83], 0
    v_exp_f32 v55, v55
    v_mfma_f32_16x16x32_bf16 v[56:59], a[132:135], a[84:87], v[56:59]
    ds_read_b128 a[124:127], v3 offset:704
    v_cvt_pk_bf16_f32 v43, v54, v55
    v_mfma_f32_16x16x32_bf16 v[56:59], a[136:139], a[88:91], v[56:59]
    v_mfma_f32_16x16x32_bf16 v[56:59], a[140:143], a[92:95], v[56:59]
    ds_read_b128 a[120:123], v3 offset:640
    v_mfma_f32_16x16x32_bf16 v[60:63], a[156:159], a[92:95], 0
    v_mfma_f32_16x16x32_bf16 v[60:63], a[152:155], a[88:91], v[60:63]
    ds_read_b128 a[116:119], v3 offset:576
    v_mfma_f32_16x16x32_bf16 v[60:63], a[148:151], a[84:87], v[60:63]
    v_exp_f32 v56, v56
    v_mfma_f32_16x16x32_bf16 v[60:63], a[144:147], a[80:83], v[60:63]
    ds_read_b128 a[112:115], v3 offset:512
    v_mfma_f32_16x16x32_bf16 v[192:195], v[40:43], a[192:195], v[192:195]
    v_exp_f32 v57, v57
    v_mfma_f32_16x16x32_bf16 v[196:199], v[40:43], a[196:199], v[196:199]
    ds_read_b64_tr_b16 a[160:161], v4 offset:33792
    v_cvt_pk_bf16_f32 v44, v56, v57
    v_mfma_f32_16x16x32_bf16 v[200:203], v[40:43], a[200:203], v[200:203]
    v_exp_f32 v58, v58
    v_mfma_f32_16x16x32_bf16 v[204:207], v[40:43], a[204:207], v[204:207]
    ds_read_b64_tr_b16 a[162:163], v4 offset:34304
    v_mfma_f32_16x16x32_bf16 v[208:211], v[40:43], a[208:211], v[208:211]
    v_exp_f32 v59, v59
    v_mfma_f32_16x16x32_bf16 v[212:215], v[40:43], a[212:215], v[212:215]
    ds_read_b64_tr_b16 a[164:165], v4 offset:33808
    v_cvt_pk_bf16_f32 v45, v58, v59
    v_mfma_f32_16x16x32_bf16 v[216:219], v[40:43], a[216:219], v[216:219]
    v_exp_f32 v60, v60
    v_mfma_f32_16x16x32_bf16 v[220:223], v[40:43], a[220:223], v[220:223]
    s_waitcnt lgkmcnt(10)
    ds_read_b64_tr_b16 a[166:167], v4 offset:34320
    v_mfma_f32_16x16x32_bf16 v[48:51], a[96:99], a[0:3], 0
    s_waitcnt lgkmcnt(10)
    v_exp_f32 v61, v61
    v_mfma_f32_16x16x32_bf16 v[48:51], a[100:103], a[4:7], v[48:51]
    s_waitcnt lgkmcnt(9)
    ds_read_b64_tr_b16 a[168:169], v4 offset:33824
    v_cvt_pk_bf16_f32 v46, v60, v61
    v_mfma_f32_16x16x32_bf16 v[48:51], a[104:107], a[8:11], v[48:51]
    s_waitcnt lgkmcnt(9)
    v_exp_f32 v62, v62
    v_mfma_f32_16x16x32_bf16 v[48:51], a[108:111], a[12:15], v[48:51]
    s_waitcnt lgkmcnt(8)
    v_exp_f32 v63, v63
    v_mfma_f32_16x16x32_bf16 v[52:55], a[124:127], a[12:15], 0
    s_waitcnt lgkmcnt(7)
    ds_read_b64_tr_b16 a[170:171], v4 offset:34336
    v_cvt_pk_bf16_f32 v47, v62, v63
    v_mfma_f32_16x16x32_bf16 v[52:55], a[120:123], a[8:11], v[52:55]
    s_waitcnt lgkmcnt(7)
    v_exp_f32 v48, v48
    v_mfma_f32_16x16x32_bf16 v[52:55], a[116:119], a[4:7], v[52:55]
    s_waitcnt lgkmcnt(6)
    ds_read_b64_tr_b16 a[172:173], v4 offset:33840
    v_mfma_f32_16x16x32_bf16 v[52:55], a[112:115], a[0:3], v[52:55]
    v_exp_f32 v49, v49
    v_smfmac_f32_16x16x64_bf16 a[244:247], a[248:251], v[40:47], v19
    ds_read_b64_tr_b16 a[174:175], v4 offset:34352
    v_mfma_f32_16x16x32_bf16 v[224:227], v[44:47], a[192:195], v[224:227]
    v_exp_f32 v50, v50
    v_mfma_f32_16x16x32_bf16 v[228:231], v[44:47], a[196:199], v[228:231]
    ds_read_b64_tr_b16 a[176:177], v4 offset:33856
    v_cvt_pk_bf16_f32 v40, v48, v49
    v_mfma_f32_16x16x32_bf16 v[232:235], v[44:47], a[200:203], v[232:235]
    v_exp_f32 v51, v51
    v_mfma_f32_16x16x32_bf16 v[236:239], v[44:47], a[204:207], v[236:239]
    ds_read_b64_tr_b16 a[178:179], v4 offset:34368
    v_cvt_pk_bf16_f32 v41, v50, v51
    v_mfma_f32_16x16x32_bf16 v[240:243], v[44:47], a[208:211], v[240:243]
    v_exp_f32 v52, v52
    v_mfma_f32_16x16x32_bf16 v[244:247], v[44:47], a[212:215], v[244:247]
    ds_read_b64_tr_b16 a[180:181], v4 offset:33872
    v_mfma_f32_16x16x32_bf16 v[248:251], v[44:47], a[216:219], v[248:251]
    v_exp_f32 v53, v53
    v_mfma_f32_16x16x32_bf16 v[252:255], v[44:47], a[220:223], v[252:255]
    ds_read_b64_tr_b16 a[182:183], v4 offset:34384
    v_cvt_pk_bf16_f32 v42, v52, v53
    v_mfma_f32_16x16x32_bf16 v[56:59], a[96:99], a[16:19], 0
    v_exp_f32 v54, v54
    v_mfma_f32_16x16x32_bf16 v[56:59], a[100:103], a[20:23], v[56:59]
    ds_read_b64_tr_b16 a[184:185], v4 offset:33888
    v_mfma_f32_16x16x32_bf16 v[56:59], a[104:107], a[24:27], v[56:59]
    v_exp_f32 v55, v55
    v_mfma_f32_16x16x32_bf16 v[56:59], a[108:111], a[28:31], v[56:59]
    ds_read_b64_tr_b16 a[186:187], v4 offset:34400
    v_cvt_pk_bf16_f32 v43, v54, v55
    v_mfma_f32_16x16x32_bf16 v[60:63], a[124:127], a[28:31], 0
    v_mfma_f32_16x16x32_bf16 v[60:63], a[120:123], a[24:27], v[60:63]
    ds_read_b64_tr_b16 a[188:189], v4 offset:33904
    v_mfma_f32_16x16x32_bf16 v[60:63], a[116:119], a[20:23], v[60:63]
    v_exp_f32 v56, v56
    v_mfma_f32_16x16x32_bf16 v[60:63], a[112:115], a[16:19], v[60:63]
    s_waitcnt lgkmcnt(13)
    ds_read_b64_tr_b16 a[190:191], v4 offset:34416
    v_mfma_f32_16x16x32_bf16 v[64:67], v[40:43], a[160:163], v[64:67]
    s_waitcnt lgkmcnt(12)
    v_exp_f32 v57, v57
    v_mfma_f32_16x16x32_bf16 v[68:71], v[40:43], a[164:167], v[68:71]
    s_waitcnt lgkmcnt(10)
    v_exp_f32 v58, v58
    v_mfma_f32_16x16x32_bf16 v[72:75], v[40:43], a[168:171], v[72:75]
    s_waitcnt lgkmcnt(8)
    v_exp_f32 v59, v59
    v_mfma_f32_16x16x32_bf16 v[76:79], v[40:43], a[172:175], v[76:79]
    s_waitcnt lgkmcnt(6)
    v_exp_f32 v60, v60
    v_mfma_f32_16x16x32_bf16 v[80:83], v[40:43], a[176:179], v[80:83]
    s_waitcnt lgkmcnt(4)
    v_exp_f32 v61, v61
    v_mfma_f32_16x16x32_bf16 v[84:87], v[40:43], a[180:183], v[84:87]
    s_waitcnt lgkmcnt(2)
    v_exp_f32 v62, v62
    v_mfma_f32_16x16x32_bf16 v[88:91], v[40:43], a[184:187], v[88:91]
    s_waitcnt lgkmcnt(0)
    v_exp_f32 v63, v63
    v_mfma_f32_16x16x32_bf16 v[92:95], v[40:43], a[188:191], v[92:95]
    v_cvt_pk_bf16_f32 v44, v56, v57
    v_cvt_pk_bf16_f32 v45, v58, v59
    v_mfma_f32_16x16x32_bf16 v[48:51], a[96:99], a[32:35], 0
    v_cvt_pk_bf16_f32 v46, v60, v61
    v_cvt_pk_bf16_f32 v47, v62, v63
    v_mfma_f32_16x16x32_bf16 v[48:51], a[100:103], a[36:39], v[48:51]
    v_mfma_f32_16x16x32_bf16 v[48:51], a[104:107], a[40:43], v[48:51]
    v_mfma_f32_16x16x32_bf16 v[48:51], a[108:111], a[44:47], v[48:51]
    v_mfma_f32_16x16x32_bf16 v[52:55], a[124:127], a[44:47], 0
    v_mfma_f32_16x16x32_bf16 v[52:55], a[120:123], a[40:43], v[52:55]
    v_exp_f32 v48, v48
    v_mfma_f32_16x16x32_bf16 v[52:55], a[116:119], a[36:39], v[52:55]
    v_exp_f32 v49, v49
    v_mfma_f32_16x16x32_bf16 v[52:55], a[112:115], a[32:35], v[52:55]
    v_exp_f32 v50, v50
    v_smfmac_f32_16x16x64_bf16 a[236:239], a[248:251], v[40:47], v19
    v_mfma_f32_16x16x32_bf16 v[96:99], v[44:47], a[160:163], v[96:99]
    v_exp_f32 v51, v51
    v_mfma_f32_16x16x32_bf16 v[100:103], v[44:47], a[164:167], v[100:103]
    v_exp_f32 v52, v52
    v_mfma_f32_16x16x32_bf16 v[104:107], v[44:47], a[168:171], v[104:107]
    v_exp_f32 v53, v53
    v_mfma_f32_16x16x32_bf16 v[108:111], v[44:47], a[172:175], v[108:111]
    v_exp_f32 v54, v54
    v_mfma_f32_16x16x32_bf16 v[112:115], v[44:47], a[176:179], v[112:115]
    v_exp_f32 v55, v55
    v_mfma_f32_16x16x32_bf16 v[116:119], v[44:47], a[180:183], v[116:119]
    v_cvt_pk_bf16_f32 v40, v48, v49
    v_cvt_pk_bf16_f32 v41, v50, v51
    v_mfma_f32_16x16x32_bf16 v[120:123], v[44:47], a[184:187], v[120:123]
    v_cvt_pk_bf16_f32 v42, v52, v53
    v_cvt_pk_bf16_f32 v43, v54, v55
    v_mfma_f32_16x16x32_bf16 v[124:127], v[44:47], a[188:191], v[124:127]
    v_mfma_f32_16x16x32_bf16 v[56:59], a[96:99], a[48:51], 0
    v_mfma_f32_16x16x32_bf16 v[56:59], a[100:103], a[52:55], v[56:59]
    v_mfma_f32_16x16x32_bf16 v[56:59], a[104:107], a[56:59], v[56:59]
    v_mfma_f32_16x16x32_bf16 v[56:59], a[108:111], a[60:63], v[56:59]
    v_mfma_f32_16x16x32_bf16 v[60:63], a[124:127], a[60:63], 0
    v_mfma_f32_16x16x32_bf16 v[60:63], a[120:123], a[56:59], v[60:63]
    v_exp_f32 v56, v56
    v_mfma_f32_16x16x32_bf16 v[60:63], a[116:119], a[52:55], v[60:63]
    v_exp_f32 v57, v57
    v_mfma_f32_16x16x32_bf16 v[60:63], a[112:115], a[48:51], v[60:63]
    v_exp_f32 v58, v58
    v_mfma_f32_16x16x32_bf16 v[128:131], v[40:43], a[160:163], v[128:131]
    v_exp_f32 v59, v59
    v_mfma_f32_16x16x32_bf16 v[132:135], v[40:43], a[164:167], v[132:135]
    v_exp_f32 v60, v60
    v_mfma_f32_16x16x32_bf16 v[136:139], v[40:43], a[168:171], v[136:139]
    v_exp_f32 v61, v61
    v_mfma_f32_16x16x32_bf16 v[140:143], v[40:43], a[172:175], v[140:143]
    v_exp_f32 v62, v62
    v_mfma_f32_16x16x32_bf16 v[144:147], v[40:43], a[176:179], v[144:147]
    v_exp_f32 v63, v63
    v_mfma_f32_16x16x32_bf16 v[148:151], v[40:43], a[180:183], v[148:151]
    v_cvt_pk_bf16_f32 v44, v56, v57
    v_cvt_pk_bf16_f32 v45, v58, v59
    v_mfma_f32_16x16x32_bf16 v[152:155], v[40:43], a[184:187], v[152:155]
    v_cvt_pk_bf16_f32 v46, v60, v61
    v_cvt_pk_bf16_f32 v47, v62, v63
    v_mfma_f32_16x16x32_bf16 v[156:159], v[40:43], a[188:191], v[156:159]
    v_mfma_f32_16x16x32_bf16 v[48:51], a[96:99], a[64:67], 0
    v_mfma_f32_16x16x32_bf16 v[48:51], a[100:103], a[68:71], v[48:51]
    v_mfma_f32_16x16x32_bf16 v[48:51], a[104:107], a[72:75], v[48:51]
    v_mfma_f32_16x16x32_bf16 v[48:51], a[108:111], a[76:79], v[48:51]
    v_mfma_f32_16x16x32_bf16 v[52:55], a[124:127], a[76:79], 0
    v_mfma_f32_16x16x32_bf16 v[52:55], a[120:123], a[72:75], v[52:55]
    v_exp_f32 v48, v48
    v_mfma_f32_16x16x32_bf16 v[52:55], a[116:119], a[68:71], v[52:55]
    v_exp_f32 v49, v49
    v_mfma_f32_16x16x32_bf16 v[52:55], a[112:115], a[64:67], v[52:55]
    v_exp_f32 v50, v50
    v_smfmac_f32_16x16x64_bf16 a[240:243], a[248:251], v[40:47], v19
    s_barrier
    v_mfma_f32_16x16x32_bf16 v[160:163], v[44:47], a[160:163], v[160:163]
    ds_read_b128 a[128:131], v3 offset:8448
    v_cvt_pk_bf16_f32 v40, v48, v49
    v_mfma_f32_16x16x32_bf16 v[164:167], v[44:47], a[164:167], v[164:167]
    v_exp_f32 v51, v51
    v_mfma_f32_16x16x32_bf16 v[168:171], v[44:47], a[168:171], v[168:171]
    ds_read_b128 a[132:135], v3 offset:8512
    v_cvt_pk_bf16_f32 v41, v50, v51
    v_mfma_f32_16x16x32_bf16 v[172:175], v[44:47], a[172:175], v[172:175]
    v_exp_f32 v52, v52
    v_mfma_f32_16x16x32_bf16 v[176:179], v[44:47], a[176:179], v[176:179]
    ds_read_b128 a[136:139], v3 offset:8576
    v_mfma_f32_16x16x32_bf16 v[180:183], v[44:47], a[180:183], v[180:183]
    v_exp_f32 v53, v53
    v_mfma_f32_16x16x32_bf16 v[184:187], v[44:47], a[184:187], v[184:187]
    ds_read_b128 a[140:143], v3 offset:8640
    v_cvt_pk_bf16_f32 v42, v52, v53
    v_mfma_f32_16x16x32_bf16 v[188:191], v[44:47], a[188:191], v[188:191]
    v_exp_f32 v54, v54
    v_mfma_f32_16x16x32_bf16 v[56:59], a[96:99], a[80:83], 0
    v_exp_f32 v55, v55
    v_mfma_f32_16x16x32_bf16 v[56:59], a[100:103], a[84:87], v[56:59]
    ds_read_b128 a[156:159], v3 offset:9152
    v_cvt_pk_bf16_f32 v43, v54, v55
    v_mfma_f32_16x16x32_bf16 v[56:59], a[104:107], a[88:91], v[56:59]
    v_mfma_f32_16x16x32_bf16 v[56:59], a[108:111], a[92:95], v[56:59]
    ds_read_b128 a[152:155], v3 offset:9088
    v_mfma_f32_16x16x32_bf16 v[60:63], a[124:127], a[92:95], 0
    v_mfma_f32_16x16x32_bf16 v[60:63], a[120:123], a[88:91], v[60:63]
    ds_read_b128 a[148:151], v3 offset:9024
    v_mfma_f32_16x16x32_bf16 v[60:63], a[116:119], a[84:87], v[60:63]
    v_exp_f32 v56, v56
    v_mfma_f32_16x16x32_bf16 v[60:63], a[112:115], a[80:83], v[60:63]
    ds_read_b128 a[144:147], v3 offset:8960
    v_mfma_f32_16x16x32_bf16 v[192:195], v[40:43], a[160:163], v[192:195]
    v_exp_f32 v57, v57
    v_mfma_f32_16x16x32_bf16 v[196:199], v[40:43], a[164:167], v[196:199]
    ds_read_b64_tr_b16 a[192:193], v4 offset:42240
    v_cvt_pk_bf16_f32 v44, v56, v57
    v_mfma_f32_16x16x32_bf16 v[200:203], v[40:43], a[168:171], v[200:203]
    v_exp_f32 v58, v58
    v_mfma_f32_16x16x32_bf16 v[204:207], v[40:43], a[172:175], v[204:207]
    ds_read_b64_tr_b16 a[194:195], v4 offset:42752
    v_mfma_f32_16x16x32_bf16 v[208:211], v[40:43], a[176:179], v[208:211]
    v_exp_f32 v59, v59
    v_mfma_f32_16x16x32_bf16 v[212:215], v[40:43], a[180:183], v[212:215]
    ds_read_b64_tr_b16 a[196:197], v4 offset:42256
    v_cvt_pk_bf16_f32 v45, v58, v59
    v_mfma_f32_16x16x32_bf16 v[216:219], v[40:43], a[184:187], v[216:219]
    v_exp_f32 v60, v60
    v_mfma_f32_16x16x32_bf16 v[220:223], v[40:43], a[188:191], v[220:223]
    s_waitcnt lgkmcnt(10)
    ds_read_b64_tr_b16 a[198:199], v4 offset:42768
    v_mfma_f32_16x16x32_bf16 v[48:51], a[128:131], a[0:3], 0
    s_waitcnt lgkmcnt(10)
    v_exp_f32 v61, v61
    v_mfma_f32_16x16x32_bf16 v[48:51], a[132:135], a[4:7], v[48:51]
    s_waitcnt lgkmcnt(9)
    ds_read_b64_tr_b16 a[200:201], v4 offset:42272
    v_cvt_pk_bf16_f32 v46, v60, v61
    v_mfma_f32_16x16x32_bf16 v[48:51], a[136:139], a[8:11], v[48:51]
    s_waitcnt lgkmcnt(9)
    v_exp_f32 v62, v62
    v_mfma_f32_16x16x32_bf16 v[48:51], a[140:143], a[12:15], v[48:51]
    s_waitcnt lgkmcnt(8)
    v_exp_f32 v63, v63
    v_mfma_f32_16x16x32_bf16 v[52:55], a[156:159], a[12:15], 0
    s_waitcnt lgkmcnt(7)
    ds_read_b64_tr_b16 a[202:203], v4 offset:42784
    v_cvt_pk_bf16_f32 v47, v62, v63
    v_mfma_f32_16x16x32_bf16 v[52:55], a[152:155], a[8:11], v[52:55]
    s_waitcnt lgkmcnt(7)
    v_exp_f32 v48, v48
    v_mfma_f32_16x16x32_bf16 v[52:55], a[148:151], a[4:7], v[52:55]
    s_waitcnt lgkmcnt(6)
    ds_read_b64_tr_b16 a[204:205], v4 offset:42288
    v_mfma_f32_16x16x32_bf16 v[52:55], a[144:147], a[0:3], v[52:55]
    v_exp_f32 v49, v49
    v_smfmac_f32_16x16x64_bf16 a[244:247], a[248:251], v[40:47], v19
    ds_read_b64_tr_b16 a[206:207], v4 offset:42800
    v_mfma_f32_16x16x32_bf16 v[224:227], v[44:47], a[160:163], v[224:227]
    v_exp_f32 v50, v50
    v_mfma_f32_16x16x32_bf16 v[228:231], v[44:47], a[164:167], v[228:231]
    ds_read_b64_tr_b16 a[208:209], v4 offset:42304
    v_cvt_pk_bf16_f32 v40, v48, v49
    v_mfma_f32_16x16x32_bf16 v[232:235], v[44:47], a[168:171], v[232:235]
    v_exp_f32 v51, v51
    v_mfma_f32_16x16x32_bf16 v[236:239], v[44:47], a[172:175], v[236:239]
    ds_read_b64_tr_b16 a[210:211], v4 offset:42816
    v_cvt_pk_bf16_f32 v41, v50, v51
    v_mfma_f32_16x16x32_bf16 v[240:243], v[44:47], a[176:179], v[240:243]
    v_exp_f32 v52, v52
    v_mfma_f32_16x16x32_bf16 v[244:247], v[44:47], a[180:183], v[244:247]
    ds_read_b64_tr_b16 a[212:213], v4 offset:42320
    v_mfma_f32_16x16x32_bf16 v[248:251], v[44:47], a[184:187], v[248:251]
    v_exp_f32 v53, v53
    v_mfma_f32_16x16x32_bf16 v[252:255], v[44:47], a[188:191], v[252:255]
    ds_read_b64_tr_b16 a[214:215], v4 offset:42832
    v_cvt_pk_bf16_f32 v42, v52, v53
    v_mfma_f32_16x16x32_bf16 v[56:59], a[128:131], a[16:19], 0
    v_exp_f32 v54, v54
    v_mfma_f32_16x16x32_bf16 v[56:59], a[132:135], a[20:23], v[56:59]
    ds_read_b64_tr_b16 a[216:217], v4 offset:42336
    v_mfma_f32_16x16x32_bf16 v[56:59], a[136:139], a[24:27], v[56:59]
    v_exp_f32 v55, v55
    v_mfma_f32_16x16x32_bf16 v[56:59], a[140:143], a[28:31], v[56:59]
    ds_read_b64_tr_b16 a[218:219], v4 offset:42848
    v_cvt_pk_bf16_f32 v43, v54, v55
    v_mfma_f32_16x16x32_bf16 v[60:63], a[156:159], a[28:31], 0
    v_mfma_f32_16x16x32_bf16 v[60:63], a[152:155], a[24:27], v[60:63]
    ds_read_b64_tr_b16 a[220:221], v4 offset:42352
    v_mfma_f32_16x16x32_bf16 v[60:63], a[148:151], a[20:23], v[60:63]
    v_exp_f32 v56, v56
    v_mfma_f32_16x16x32_bf16 v[60:63], a[144:147], a[16:19], v[60:63]
    s_waitcnt lgkmcnt(13)
    ds_read_b64_tr_b16 a[222:223], v4 offset:42864
    v_mfma_f32_16x16x32_bf16 v[64:67], v[40:43], a[192:195], v[64:67]
    s_waitcnt lgkmcnt(12)
    v_exp_f32 v57, v57
    v_mfma_f32_16x16x32_bf16 v[68:71], v[40:43], a[196:199], v[68:71]
    s_waitcnt lgkmcnt(10)
    v_exp_f32 v58, v58
    v_mfma_f32_16x16x32_bf16 v[72:75], v[40:43], a[200:203], v[72:75]
    s_waitcnt lgkmcnt(8)
    v_exp_f32 v59, v59
    v_mfma_f32_16x16x32_bf16 v[76:79], v[40:43], a[204:207], v[76:79]
    s_waitcnt lgkmcnt(6)
    v_exp_f32 v60, v60
    v_mfma_f32_16x16x32_bf16 v[80:83], v[40:43], a[208:211], v[80:83]
    s_waitcnt lgkmcnt(4)
    v_exp_f32 v61, v61
    v_mfma_f32_16x16x32_bf16 v[84:87], v[40:43], a[212:215], v[84:87]
    s_waitcnt lgkmcnt(2)
    v_exp_f32 v62, v62
    v_mfma_f32_16x16x32_bf16 v[88:91], v[40:43], a[216:219], v[88:91]
    s_waitcnt lgkmcnt(0)
    v_exp_f32 v63, v63
    v_mfma_f32_16x16x32_bf16 v[92:95], v[40:43], a[220:223], v[92:95]
    v_cvt_pk_bf16_f32 v44, v56, v57
    v_cvt_pk_bf16_f32 v45, v58, v59
    v_mfma_f32_16x16x32_bf16 v[48:51], a[128:131], a[32:35], 0
    v_cvt_pk_bf16_f32 v46, v60, v61
    v_cvt_pk_bf16_f32 v47, v62, v63
    v_mfma_f32_16x16x32_bf16 v[48:51], a[132:135], a[36:39], v[48:51]
    v_mfma_f32_16x16x32_bf16 v[48:51], a[136:139], a[40:43], v[48:51]
    v_mfma_f32_16x16x32_bf16 v[48:51], a[140:143], a[44:47], v[48:51]
    v_mfma_f32_16x16x32_bf16 v[52:55], a[156:159], a[44:47], 0
    v_mfma_f32_16x16x32_bf16 v[52:55], a[152:155], a[40:43], v[52:55]
    s_cmp_lg_u32 s29, 61
    v_mfma_f32_16x16x32_bf16 v[52:55], a[148:151], a[36:39], v[52:55]
    v_mfma_f32_16x16x32_bf16 v[52:55], a[144:147], a[32:35], v[52:55]
    s_cbranch_scc1 L_A2
    v_smfmac_f32_16x16x64_bf16 a[236:239], a[248:251], v[40:47], v19
    s_add_u32 s46, s43, 26624
    s_add_u32 s47, s43, 30720
    v_xor_b32 v24, 0x140, v23
    v_exp_f32 v48, v48
    v_exp_f32 v49, v49
    v_exp_f32 v50, v50
    v_mfma_f32_16x16x32_bf16 v[96:99], v[44:47], a[192:195], v[96:99]
    v_exp_f32 v51, v51
    v_exp_f32 v52, v52
    v_exp_f32 v53, v53
    v_exp_f32 v54, v54
    v_mfma_f32_16x16x32_bf16 v[100:103], v[44:47], a[196:199], v[100:103]
    v_add_u32 v5, s43, v21
    v_xor_b32 v6, 64, v5
    v_exp_f32 v55, v55
    v_cvt_pk_bf16_f32 v40, v48, v49
    v_cvt_pk_bf16_f32 v41, v50, v51
    v_cvt_pk_bf16_f32 v42, v52, v53
    v_mfma_f32_16x16x32_bf16 v[104:107], v[44:47], a[200:203], v[104:107]
    v_accvgpr_read_b32 v34, a236
    v_accvgpr_read_b32 v38, a237
    v_add_f32 v34, v34, v38
    v_subrev_u32 v38, s38, v34
    v_max_u32 v16, v16, v38
    v_rcp_f32 v34, v34
    v_cvt_pk_bf16_f32 v43, v54, v55
    v_mfma_f32_16x16x32_bf16 v[108:111], v[44:47], a[204:207], v[108:111]
    v_mov_b32_dpp v34, v34 row_ror:12 row_mask:0xa bank_mask:0xf
    v_accvgpr_read_b32 v36, a238
    v_accvgpr_read_b32 v39, a239
    v_add_f32 v36, v36, v39
    v_subrev_u32 v39, s38, v36
    v_max_u32 v16, v16, v39
    v_rcp_f32 v36, v36
    v_mfma_f32_16x16x32_bf16 v[112:115], v[44:47], a[208:211], v[112:115]
    v_mov_b32_dpp v34, v34 row_ror:8 row_mask:0xc bank_mask:0xf
    v_mov_b32_dpp v36, v36 row_ror:12 row_mask:0xa bank_mask:0xf
    v_mfma_f32_16x16x32_bf16 v[116:119], v[44:47], a[212:215], v[116:119]
    v_mul_f32_dpp v64, v34, v64 row_newbcast:0 row_mask:0xf bank_mask:0xf
    v_mul_f32_dpp v65, v34, v65 row_newbcast:1 row_mask:0xf bank_mask:0xf
    v_mul_f32_dpp v66, v34, v66 row_newbcast:2 row_mask:0xf bank_mask:0xf
    v_mul_f32_dpp v67, v34, v67 row_newbcast:3 row_mask:0xf bank_mask:0xf
    v_mul_f32_dpp v68, v34, v68 row_newbcast:0 row_mask:0xf bank_mask:0xf
    v_mul_f32_dpp v69, v34, v69 row_newbcast:1 row_mask:0xf bank_mask:0xf
    v_mul_f32_dpp v70, v34, v70 row_newbcast:2 row_mask:0xf bank_mask:0xf
    v_mul_f32_dpp v71, v34, v71 row_newbcast:3 row_mask:0xf bank_mask:0xf
    v_mfma_f32_16x16x32_bf16 v[120:123], v[44:47], a[216:219], v[120:123]
    v_mul_f32_dpp v72, v34, v72 row_newbcast:0 row_mask:0xf bank_mask:0xf
    v_mul_f32_dpp v73, v34, v73 row_newbcast:1 row_mask:0xf bank_mask:0xf
    v_mul_f32_dpp v74, v34, v74 row_newbcast:2 row_mask:0xf bank_mask:0xf
    v_mul_f32_dpp v75, v34, v75 row_newbcast:3 row_mask:0xf bank_mask:0xf
    v_mul_f32_dpp v76, v34, v76 row_newbcast:0 row_mask:0xf bank_mask:0xf
    v_mul_f32_dpp v77, v34, v77 row_newbcast:1 row_mask:0xf bank_mask:0xf
    v_mul_f32_dpp v78, v34, v78 row_newbcast:2 row_mask:0xf bank_mask:0xf
    v_mul_f32_dpp v79, v34, v79 row_newbcast:3 row_mask:0xf bank_mask:0xf
    v_mfma_f32_16x16x32_bf16 v[124:127], v[44:47], a[220:223], v[124:127]
    v_cvt_pk_bf16_f32 v64, v64, v68
    v_cvt_pk_bf16_f32 v68, v66, v70
    v_cvt_pk_bf16_f32 v66, v65, v69
    v_cvt_pk_bf16_f32 v70, v67, v71
    v_cvt_pk_bf16_f32 v65, v72, v76
    v_cvt_pk_bf16_f32 v67, v73, v77
    v_cvt_pk_bf16_f32 v69, v74, v78
    v_cvt_pk_bf16_f32 v71, v75, v79
    v_mfma_f32_16x16x32_bf16 v[56:59], a[128:131], a[48:51], 0
    ds_write_b128 v23, v[64:67] offset:0
    v_mul_f32_dpp v80, v34, v80 row_newbcast:0 row_mask:0xf bank_mask:0xf
    v_mul_f32_dpp v81, v34, v81 row_newbcast:1 row_mask:0xf bank_mask:0xf
    v_mul_f32_dpp v82, v34, v82 row_newbcast:2 row_mask:0xf bank_mask:0xf
    v_mfma_f32_16x16x32_bf16 v[56:59], a[132:135], a[52:55], v[56:59]
    ds_write_b128 v23, v[68:71] offset:512
    v_mul_f32_dpp v83, v34, v83 row_newbcast:3 row_mask:0xf bank_mask:0xf
    v_mul_f32_dpp v84, v34, v84 row_newbcast:0 row_mask:0xf bank_mask:0xf
    v_mul_f32_dpp v85, v34, v85 row_newbcast:1 row_mask:0xf bank_mask:0xf
    v_mfma_f32_16x16x32_bf16 v[56:59], a[136:139], a[56:59], v[56:59]
    v_mul_f32_dpp v86, v34, v86 row_newbcast:2 row_mask:0xf bank_mask:0xf
    v_mul_f32_dpp v87, v34, v87 row_newbcast:3 row_mask:0xf bank_mask:0xf
    v_mul_f32_dpp v88, v34, v88 row_newbcast:0 row_mask:0xf bank_mask:0xf
    v_mul_f32_dpp v89, v34, v89 row_newbcast:1 row_mask:0xf bank_mask:0xf
    v_mul_f32_dpp v90, v34, v90 row_newbcast:2 row_mask:0xf bank_mask:0xf
    v_mul_f32_dpp v91, v34, v91 row_newbcast:3 row_mask:0xf bank_mask:0xf
    v_mul_f32_dpp v92, v34, v92 row_newbcast:0 row_mask:0xf bank_mask:0xf
    v_mul_f32_dpp v93, v34, v93 row_newbcast:1 row_mask:0xf bank_mask:0xf
    v_mfma_f32_16x16x32_bf16 v[56:59], a[140:143], a[60:63], v[56:59]
    v_mul_f32_dpp v94, v34, v94 row_newbcast:2 row_mask:0xf bank_mask:0xf
    v_mul_f32_dpp v95, v34, v95 row_newbcast:3 row_mask:0xf bank_mask:0xf
    v_cvt_pk_bf16_f32 v80, v80, v84
    v_cvt_pk_bf16_f32 v84, v82, v86
    v_cvt_pk_bf16_f32 v82, v81, v85
    v_cvt_pk_bf16_f32 v86, v83, v87
    v_cvt_pk_bf16_f32 v81, v88, v92
    v_cvt_pk_bf16_f32 v83, v89, v93
    v_mfma_f32_16x16x32_bf16 v[60:63], a[156:159], a[60:63], 0
    ds_write_b128 v24, v[80:83] offset:0
    v_cvt_pk_bf16_f32 v85, v90, v94
    v_cvt_pk_bf16_f32 v87, v91, v95
    v_mov_b32_dpp v36, v36 row_ror:8 row_mask:0xc bank_mask:0xf
    v_mfma_f32_16x16x32_bf16 v[60:63], a[152:155], a[56:59], v[60:63]
    v_exp_f32 v56, v56
    v_exp_f32 v57, v57
    v_exp_f32 v58, v58
    v_exp_f32 v59, v59
    v_mfma_f32_16x16x32_bf16 v[60:63], a[148:151], a[52:55], v[60:63]
    ds_write_b128 v24, v[84:87] offset:512
    v_mul_f32_dpp v96, v36, v96 row_newbcast:0 row_mask:0xf bank_mask:0xf
    v_mul_f32_dpp v97, v36, v97 row_newbcast:1 row_mask:0xf bank_mask:0xf
    v_mul_f32_dpp v98, v36, v98 row_newbcast:2 row_mask:0xf bank_mask:0xf
    v_mfma_f32_16x16x32_bf16 v[60:63], a[144:147], a[48:51], v[60:63]
    ds_read_b64_tr_b16 v[64:65], v5 offset:0
    ds_read_b64_tr_b16 v[66:67], v6 offset:0
    ds_read_b64_tr_b16 v[68:69], v5 offset:1024
    ds_read_b64_tr_b16 v[70:71], v6 offset:1024
    v_mul_f32_dpp v99, v36, v99 row_newbcast:3 row_mask:0xf bank_mask:0xf
    v_mul_f32_dpp v100, v36, v100 row_newbcast:0 row_mask:0xf bank_mask:0xf
    v_mfma_f32_16x16x32_bf16 v[128:131], v[40:43], a[192:195], v[128:131]
    ds_read_b64_tr_b16 v[72:73], v5 offset:2048
    ds_read_b64_tr_b16 v[74:75], v6 offset:2048
    ds_read_b64_tr_b16 v[76:77], v5 offset:3072
    ds_read_b64_tr_b16 v[78:79], v6 offset:3072
    v_cvt_pk_bf16_f32 v44, v56, v57
    v_cvt_pk_bf16_f32 v45, v58, v59
    v_mfma_f32_16x16x32_bf16 v[132:135], v[40:43], a[196:199], v[132:135]
    v_exp_f32 v60, v60
    v_exp_f32 v61, v61
    v_exp_f32 v62, v62
    v_exp_f32 v63, v63
    v_mfma_f32_16x16x32_bf16 v[136:139], v[40:43], a[200:203], v[136:139]
    s_waitcnt lgkmcnt(6)
    s_waitcnt lgkmcnt(4)
    v_mul_f32_dpp v101, v36, v101 row_newbcast:1 row_mask:0xf bank_mask:0xf
    v_mul_f32_dpp v102, v36, v102 row_newbcast:2 row_mask:0xf bank_mask:0xf
    v_mul_f32_dpp v103, v36, v103 row_newbcast:3 row_mask:0xf bank_mask:0xf
    v_mul_f32_dpp v104, v36, v104 row_newbcast:0 row_mask:0xf bank_mask:0xf
    v_mul_f32_dpp v105, v36, v105 row_newbcast:1 row_mask:0xf bank_mask:0xf
    v_cvt_pk_bf16_f32 v46, v60, v61
    v_cvt_pk_bf16_f32 v47, v62, v63
    v_mfma_f32_16x16x32_bf16 v[140:143], v[40:43], a[204:207], v[140:143]
    s_waitcnt lgkmcnt(2)
    s_waitcnt lgkmcnt(0)
    buffer_store_dwordx4 v[64:67], v10, s[24:27], s46 offen offset:0 sc1
    v_mfma_f32_16x16x32_bf16 v[144:147], v[40:43], a[208:211], v[144:147]
    buffer_store_dwordx4 v[68:71], v10, s[24:27], s46 offen offset:1024 sc1
    v_mul_f32_dpp v106, v36, v106 row_newbcast:2 row_mask:0xf bank_mask:0xf
    v_mfma_f32_16x16x32_bf16 v[148:151], v[40:43], a[212:215], v[148:151]
    buffer_store_dwordx4 v[72:75], v10, s[24:27], s46 offen offset:2048 sc1
    v_mul_f32_dpp v107, v36, v107 row_newbcast:3 row_mask:0xf bank_mask:0xf
    v_mfma_f32_16x16x32_bf16 v[152:155], v[40:43], a[216:219], v[152:155]
    buffer_store_dwordx4 v[76:79], v10, s[24:27], s46 offen offset:3072 sc1
    v_mul_f32_dpp v108, v36, v108 row_newbcast:0 row_mask:0xf bank_mask:0xf
    v_mfma_f32_16x16x32_bf16 v[156:159], v[40:43], a[220:223], v[156:159]
    s_add_u32 s46, s43, 34816
    v_mul_f32_dpp v109, v36, v109 row_newbcast:1 row_mask:0xf bank_mask:0xf
    v_mul_f32_dpp v110, v36, v110 row_newbcast:2 row_mask:0xf bank_mask:0xf
    v_mul_f32_dpp v111, v36, v111 row_newbcast:3 row_mask:0xf bank_mask:0xf
    v_cvt_pk_bf16_f32 v96, v96, v100
    v_cvt_pk_bf16_f32 v100, v98, v102
    v_cvt_pk_bf16_f32 v98, v97, v101
    v_cvt_pk_bf16_f32 v102, v99, v103
    v_cvt_pk_bf16_f32 v97, v104, v108
    v_mfma_f32_16x16x32_bf16 v[48:51], a[128:131], a[64:67], 0
    v_cvt_pk_bf16_f32 v99, v105, v109
    v_cvt_pk_bf16_f32 v101, v106, v110
    v_cvt_pk_bf16_f32 v103, v107, v111
    v_mul_f32_dpp v112, v36, v112 row_newbcast:0 row_mask:0xf bank_mask:0xf
    v_mul_f32_dpp v113, v36, v113 row_newbcast:1 row_mask:0xf bank_mask:0xf
    v_mul_f32_dpp v114, v36, v114 row_newbcast:2 row_mask:0xf bank_mask:0xf
    v_mul_f32_dpp v115, v36, v115 row_newbcast:3 row_mask:0xf bank_mask:0xf
    v_mul_f32_dpp v116, v36, v116 row_newbcast:0 row_mask:0xf bank_mask:0xf
    v_mfma_f32_16x16x32_bf16 v[48:51], a[132:135], a[68:71], v[48:51]
    ds_write_b128 v23, v[96:99] offset:4096
    v_mul_f32_dpp v117, v36, v117 row_newbcast:1 row_mask:0xf bank_mask:0xf
    v_mul_f32_dpp v118, v36, v118 row_newbcast:2 row_mask:0xf bank_mask:0xf
    v_mul_f32_dpp v119, v36, v119 row_newbcast:3 row_mask:0xf bank_mask:0xf
    v_mfma_f32_16x16x32_bf16 v[48:51], a[136:139], a[72:75], v[48:51]
    ds_write_b128 v23, v[100:103] offset:4608
    v_mul_f32_dpp v120, v36, v120 row_newbcast:0 row_mask:0xf bank_mask:0xf
    v_mul_f32_dpp v121, v36, v121 row_newbcast:1 row_mask:0xf bank_mask:0xf
    v_mul_f32_dpp v122, v36, v122 row_newbcast:2 row_mask:0xf bank_mask:0xf
    v_mfma_f32_16x16x32_bf16 v[48:51], a[140:143], a[76:79], v[48:51]
    v_mul_f32_dpp v123, v36, v123 row_newbcast:3 row_mask:0xf bank_mask:0xf
    v_mul_f32_dpp v124, v36, v124 row_newbcast:0 row_mask:0xf bank_mask:0xf
    v_mul_f32_dpp v125, v36, v125 row_newbcast:1 row_mask:0xf bank_mask:0xf
    v_mul_f32_dpp v126, v36, v126 row_newbcast:2 row_mask:0xf bank_mask:0xf
    v_mul_f32_dpp v127, v36, v127 row_newbcast:3 row_mask:0xf bank_mask:0xf
    v_cvt_pk_bf16_f32 v112, v112, v116
    v_cvt_pk_bf16_f32 v116, v114, v118
    v_cvt_pk_bf16_f32 v114, v113, v117
    v_mfma_f32_16x16x32_bf16 v[52:55], a[156:159], a[76:79], 0
    v_cvt_pk_bf16_f32 v118, v115, v119
    v_cvt_pk_bf16_f32 v113, v120, v124
    v_cvt_pk_bf16_f32 v115, v121, v125
    v_cvt_pk_bf16_f32 v117, v122, v126
    v_cvt_pk_bf16_f32 v119, v123, v127
    v_mfma_f32_16x16x32_bf16 v[52:55], a[152:155], a[72:75], v[52:55]
    v_exp_f32 v48, v48
    v_exp_f32 v49, v49
    v_exp_f32 v50, v50
    v_exp_f32 v51, v51
    v_mfma_f32_16x16x32_bf16 v[52:55], a[148:151], a[68:71], v[52:55]
    ds_write_b128 v24, v[112:115] offset:4096
    v_mfma_f32_16x16x32_bf16 v[52:55], a[144:147], a[64:67], v[52:55]
    ds_write_b128 v24, v[116:119] offset:4608
    v_smfmac_f32_16x16x64_bf16 a[240:243], a[248:251], v[40:47], v19
    ds_read_b64_tr_b16 v[96:97], v5 offset:4096
    ds_read_b64_tr_b16 v[98:99], v6 offset:4096
    ds_read_b64_tr_b16 v[100:101], v5 offset:5120
    ds_read_b64_tr_b16 v[102:103], v6 offset:5120
    v_mfma_f32_16x16x32_bf16 v[160:163], v[44:47], a[192:195], v[160:163]
    v_exp_f32 v52, v52
    v_exp_f32 v53, v53
    v_exp_f32 v54, v54
    v_exp_f32 v55, v55
    v_mfma_f32_16x16x32_bf16 v[164:167], v[44:47], a[196:199], v[164:167]
    ds_read_b64_tr_b16 v[104:105], v5 offset:6144
    ds_read_b64_tr_b16 v[106:107], v6 offset:6144
    ds_read_b64_tr_b16 v[108:109], v5 offset:7168
    v_cvt_pk_bf16_f32 v40, v48, v49
    v_cvt_pk_bf16_f32 v41, v50, v51
    v_cvt_pk_bf16_f32 v42, v52, v53
    v_cvt_pk_bf16_f32 v43, v54, v55
    v_mfma_f32_16x16x32_bf16 v[168:171], v[44:47], a[200:203], v[168:171]
    s_waitcnt lgkmcnt(5)
    s_waitcnt lgkmcnt(3)
    buffer_store_dwordx4 v[96:99], v10, s[24:27], s47 offen offset:0 sc1
    v_mfma_f32_16x16x32_bf16 v[172:175], v[44:47], a[204:207], v[172:175]
    ds_read_b64_tr_b16 v[110:111], v6 offset:7168
    buffer_store_dwordx4 v[100:103], v10, s[24:27], s47 offen offset:1024 sc1
    v_mfma_f32_16x16x32_bf16 v[176:179], v[44:47], a[208:211], v[176:179]
    s_waitcnt lgkmcnt(2)
    buffer_store_dwordx4 v[104:107], v10, s[24:27], s47 offen offset:2048 sc1
    v_accvgpr_read_b32 v34, a240
    v_mfma_f32_16x16x32_bf16 v[180:183], v[44:47], a[212:215], v[180:183]
    v_accvgpr_read_b32 v38, a241
    v_add_f32 v34, v34, v38
    v_subrev_u32 v38, s38, v34
    v_max_u32 v16, v16, v38
    v_rcp_f32 v34, v34
    v_accvgpr_read_b32 v36, a242
    v_accvgpr_read_b32 v39, a243
    v_mfma_f32_16x16x32_bf16 v[184:187], v[44:47], a[216:219], v[184:187]
    s_waitcnt lgkmcnt(0)
    buffer_store_dwordx4 v[108:111], v10, s[24:27], s47 offen offset:3072 sc1
    v_mov_b32_dpp v34, v34 row_ror:12 row_mask:0xa bank_mask:0xf
    v_mfma_f32_16x16x32_bf16 v[188:191], v[44:47], a[220:223], v[188:191]
    s_add_u32 s47, s43, 38912
    v_mov_b32_dpp v34, v34 row_ror:8 row_mask:0xc bank_mask:0xf
    v_add_f32 v36, v36, v39
    v_subrev_u32 v39, s38, v36
    v_max_u32 v16, v16, v39
    v_rcp_f32 v36, v36
    v_mfma_f32_16x16x32_bf16 v[56:59], a[128:131], a[80:83], 0
    v_mul_f32_dpp v128, v34, v128 row_newbcast:0 row_mask:0xf bank_mask:0xf
    v_mul_f32_dpp v129, v34, v129 row_newbcast:1 row_mask:0xf bank_mask:0xf
    v_mul_f32_dpp v130, v34, v130 row_newbcast:2 row_mask:0xf bank_mask:0xf
    v_mul_f32_dpp v131, v34, v131 row_newbcast:3 row_mask:0xf bank_mask:0xf
    v_mul_f32_dpp v132, v34, v132 row_newbcast:0 row_mask:0xf bank_mask:0xf
    v_mul_f32_dpp v133, v34, v133 row_newbcast:1 row_mask:0xf bank_mask:0xf
    v_mul_f32_dpp v134, v34, v134 row_newbcast:2 row_mask:0xf bank_mask:0xf
    v_mul_f32_dpp v135, v34, v135 row_newbcast:3 row_mask:0xf bank_mask:0xf
    v_mfma_f32_16x16x32_bf16 v[56:59], a[132:135], a[84:87], v[56:59]
    v_mul_f32_dpp v136, v34, v136 row_newbcast:0 row_mask:0xf bank_mask:0xf
    v_mul_f32_dpp v137, v34, v137 row_newbcast:1 row_mask:0xf bank_mask:0xf
    v_mul_f32_dpp v138, v34, v138 row_newbcast:2 row_mask:0xf bank_mask:0xf
    v_mul_f32_dpp v139, v34, v139 row_newbcast:3 row_mask:0xf bank_mask:0xf
    v_mul_f32_dpp v140, v34, v140 row_newbcast:0 row_mask:0xf bank_mask:0xf
    v_mul_f32_dpp v141, v34, v141 row_newbcast:1 row_mask:0xf bank_mask:0xf
    v_mul_f32_dpp v142, v34, v142 row_newbcast:2 row_mask:0xf bank_mask:0xf
    v_mul_f32_dpp v143, v34, v143 row_newbcast:3 row_mask:0xf bank_mask:0xf
    v_mfma_f32_16x16x32_bf16 v[56:59], a[136:139], a[88:91], v[56:59]
    v_cvt_pk_bf16_f32 v128, v128, v132
    v_cvt_pk_bf16_f32 v132, v130, v134
    v_cvt_pk_bf16_f32 v130, v129, v133
    v_cvt_pk_bf16_f32 v134, v131, v135
    v_cvt_pk_bf16_f32 v129, v136, v140
    v_cvt_pk_bf16_f32 v131, v137, v141
    v_cvt_pk_bf16_f32 v133, v138, v142
    v_cvt_pk_bf16_f32 v135, v139, v143
    v_mfma_f32_16x16x32_bf16 v[56:59], a[140:143], a[92:95], v[56:59]
    ds_write_b128 v23, v[128:131] offset:8192
    v_mul_f32_dpp v144, v34, v144 row_newbcast:0 row_mask:0xf bank_mask:0xf
    v_mul_f32_dpp v145, v34, v145 row_newbcast:1 row_mask:0xf bank_mask:0xf
    v_mul_f32_dpp v146, v34, v146 row_newbcast:2 row_mask:0xf bank_mask:0xf
    v_mfma_f32_16x16x32_bf16 v[60:63], a[156:159], a[92:95], 0
    ds_write_b128 v23, v[132:135] offset:8704
    v_mul_f32_dpp v147, v34, v147 row_newbcast:3 row_mask:0xf bank_mask:0xf
    v_mul_f32_dpp v148, v34, v148 row_newbcast:0 row_mask:0xf bank_mask:0xf
    v_mul_f32_dpp v149, v34, v149 row_newbcast:1 row_mask:0xf bank_mask:0xf
    v_mfma_f32_16x16x32_bf16 v[60:63], a[152:155], a[88:91], v[60:63]
    v_exp_f32 v56, v56
    v_exp_f32 v57, v57
    v_exp_f32 v58, v58
    v_exp_f32 v59, v59
    v_mfma_f32_16x16x32_bf16 v[60:63], a[148:151], a[84:87], v[60:63]
    v_mul_f32_dpp v150, v34, v150 row_newbcast:2 row_mask:0xf bank_mask:0xf
    v_mul_f32_dpp v151, v34, v151 row_newbcast:3 row_mask:0xf bank_mask:0xf
    v_mul_f32_dpp v152, v34, v152 row_newbcast:0 row_mask:0xf bank_mask:0xf
    v_mul_f32_dpp v153, v34, v153 row_newbcast:1 row_mask:0xf bank_mask:0xf
    v_mul_f32_dpp v154, v34, v154 row_newbcast:2 row_mask:0xf bank_mask:0xf
    v_mul_f32_dpp v155, v34, v155 row_newbcast:3 row_mask:0xf bank_mask:0xf
    v_mul_f32_dpp v156, v34, v156 row_newbcast:0 row_mask:0xf bank_mask:0xf
    v_mul_f32_dpp v157, v34, v157 row_newbcast:1 row_mask:0xf bank_mask:0xf
    v_mfma_f32_16x16x32_bf16 v[60:63], a[144:147], a[80:83], v[60:63]
    v_mul_f32_dpp v158, v34, v158 row_newbcast:2 row_mask:0xf bank_mask:0xf
    v_mul_f32_dpp v159, v34, v159 row_newbcast:3 row_mask:0xf bank_mask:0xf
    v_cvt_pk_bf16_f32 v144, v144, v148
    v_cvt_pk_bf16_f32 v148, v146, v150
    v_cvt_pk_bf16_f32 v146, v145, v149
    v_cvt_pk_bf16_f32 v150, v147, v151
    v_cvt_pk_bf16_f32 v145, v152, v156
    v_cvt_pk_bf16_f32 v147, v153, v157
    v_mfma_f32_16x16x32_bf16 v[192:195], v[40:43], a[192:195], v[192:195]
    v_cvt_pk_bf16_f32 v149, v154, v158
    v_cvt_pk_bf16_f32 v151, v155, v159
    v_mov_b32_dpp v36, v36 row_ror:12 row_mask:0xa bank_mask:0xf
    v_cvt_pk_bf16_f32 v44, v56, v57
    v_cvt_pk_bf16_f32 v45, v58, v59
    v_mfma_f32_16x16x32_bf16 v[196:199], v[40:43], a[196:199], v[196:199]
    v_exp_f32 v60, v60
    v_exp_f32 v61, v61
    v_exp_f32 v62, v62
    v_exp_f32 v63, v63
    v_mfma_f32_16x16x32_bf16 v[200:203], v[40:43], a[200:203], v[200:203]
    ds_write_b128 v24, v[144:147] offset:8192
    v_mov_b32_dpp v36, v36 row_ror:8 row_mask:0xc bank_mask:0xf
    v_cvt_pk_bf16_f32 v46, v60, v61
    v_cvt_pk_bf16_f32 v47, v62, v63
    v_mfma_f32_16x16x32_bf16 v[204:207], v[40:43], a[204:207], v[204:207]
    ds_write_b128 v24, v[148:151] offset:8704
    v_mul_f32_dpp v160, v36, v160 row_newbcast:0 row_mask:0xf bank_mask:0xf
    v_mul_f32_dpp v161, v36, v161 row_newbcast:1 row_mask:0xf bank_mask:0xf
    v_mul_f32_dpp v162, v36, v162 row_newbcast:2 row_mask:0xf bank_mask:0xf
    v_mfma_f32_16x16x32_bf16 v[208:211], v[40:43], a[208:211], v[208:211]
    ds_read_b64_tr_b16 v[128:129], v5 offset:8192
    ds_read_b64_tr_b16 v[130:131], v6 offset:8192
    ds_read_b64_tr_b16 v[132:133], v5 offset:9216
    ds_read_b64_tr_b16 v[134:135], v6 offset:9216
    v_mul_f32_dpp v163, v36, v163 row_newbcast:3 row_mask:0xf bank_mask:0xf
    v_mul_f32_dpp v164, v36, v164 row_newbcast:0 row_mask:0xf bank_mask:0xf
    v_mfma_f32_16x16x32_bf16 v[212:215], v[40:43], a[212:215], v[212:215]
    ds_read_b64_tr_b16 v[136:137], v5 offset:10240
    ds_read_b64_tr_b16 v[138:139], v6 offset:10240
    ds_read_b64_tr_b16 v[140:141], v5 offset:11264
    ds_read_b64_tr_b16 v[142:143], v6 offset:11264
    v_mul_f32_dpp v165, v36, v165 row_newbcast:1 row_mask:0xf bank_mask:0xf
    v_mul_f32_dpp v166, v36, v166 row_newbcast:2 row_mask:0xf bank_mask:0xf
    v_mfma_f32_16x16x32_bf16 v[216:219], v[40:43], a[216:219], v[216:219]
    v_mul_f32_dpp v167, v36, v167 row_newbcast:3 row_mask:0xf bank_mask:0xf
    v_mul_f32_dpp v168, v36, v168 row_newbcast:0 row_mask:0xf bank_mask:0xf
    v_mul_f32_dpp v169, v36, v169 row_newbcast:1 row_mask:0xf bank_mask:0xf
    v_mul_f32_dpp v170, v36, v170 row_newbcast:2 row_mask:0xf bank_mask:0xf
    v_mul_f32_dpp v171, v36, v171 row_newbcast:3 row_mask:0xf bank_mask:0xf
    v_mul_f32_dpp v172, v36, v172 row_newbcast:0 row_mask:0xf bank_mask:0xf
    v_mul_f32_dpp v173, v36, v173 row_newbcast:1 row_mask:0xf bank_mask:0xf
    v_mul_f32_dpp v174, v36, v174 row_newbcast:2 row_mask:0xf bank_mask:0xf
    v_mfma_f32_16x16x32_bf16 v[220:223], v[40:43], a[220:223], v[220:223]
    s_waitcnt lgkmcnt(6)
    s_waitcnt lgkmcnt(4)
    buffer_store_dwordx4 v[128:131], v10, s[24:27], s46 offen offset:0 sc1
    v_smfmac_f32_16x16x64_bf16 a[244:247], a[248:251], v[40:47], v19
    s_waitcnt lgkmcnt(2)
    s_waitcnt lgkmcnt(0)
    buffer_store_dwordx4 v[132:135], v10, s[24:27], s46 offen offset:1024 sc1
    v_mfma_f32_16x16x32_bf16 v[224:227], v[44:47], a[192:195], v[224:227]
    buffer_store_dwordx4 v[136:139], v10, s[24:27], s46 offen offset:2048 sc1
    v_mul_f32_dpp v175, v36, v175 row_newbcast:3 row_mask:0xf bank_mask:0xf
    v_mfma_f32_16x16x32_bf16 v[228:231], v[44:47], a[196:199], v[228:231]
    buffer_store_dwordx4 v[140:143], v10, s[24:27], s46 offen offset:3072 sc1
    v_cvt_pk_bf16_f32 v160, v160, v164
    v_mfma_f32_16x16x32_bf16 v[232:235], v[44:47], a[200:203], v[232:235]
    s_add_u32 s46, s43, 43008
    v_cvt_pk_bf16_f32 v164, v162, v166
    v_cvt_pk_bf16_f32 v162, v161, v165
    v_cvt_pk_bf16_f32 v166, v163, v167
    v_cvt_pk_bf16_f32 v161, v168, v172
    v_cvt_pk_bf16_f32 v163, v169, v173
    v_cvt_pk_bf16_f32 v165, v170, v174
    v_cvt_pk_bf16_f32 v167, v171, v175
    v_mul_f32_dpp v176, v36, v176 row_newbcast:0 row_mask:0xf bank_mask:0xf
    v_mfma_f32_16x16x32_bf16 v[236:239], v[44:47], a[204:207], v[236:239]
    ds_write_b128 v23, v[160:163] offset:12288
    v_mul_f32_dpp v177, v36, v177 row_newbcast:1 row_mask:0xf bank_mask:0xf
    v_mul_f32_dpp v178, v36, v178 row_newbcast:2 row_mask:0xf bank_mask:0xf
    v_mul_f32_dpp v179, v36, v179 row_newbcast:3 row_mask:0xf bank_mask:0xf
    v_mfma_f32_16x16x32_bf16 v[240:243], v[44:47], a[208:211], v[240:243]
    ds_write_b128 v23, v[164:167] offset:12800
    v_mul_f32_dpp v180, v36, v180 row_newbcast:0 row_mask:0xf bank_mask:0xf
    v_mul_f32_dpp v181, v36, v181 row_newbcast:1 row_mask:0xf bank_mask:0xf
    v_mul_f32_dpp v182, v36, v182 row_newbcast:2 row_mask:0xf bank_mask:0xf
    v_mfma_f32_16x16x32_bf16 v[244:247], v[44:47], a[212:215], v[244:247]
    v_mul_f32_dpp v183, v36, v183 row_newbcast:3 row_mask:0xf bank_mask:0xf
    v_mul_f32_dpp v184, v36, v184 row_newbcast:0 row_mask:0xf bank_mask:0xf
    v_mul_f32_dpp v185, v36, v185 row_newbcast:1 row_mask:0xf bank_mask:0xf
    v_mul_f32_dpp v186, v36, v186 row_newbcast:2 row_mask:0xf bank_mask:0xf
    v_mul_f32_dpp v187, v36, v187 row_newbcast:3 row_mask:0xf bank_mask:0xf
    v_mul_f32_dpp v188, v36, v188 row_newbcast:0 row_mask:0xf bank_mask:0xf
    v_mul_f32_dpp v189, v36, v189 row_newbcast:1 row_mask:0xf bank_mask:0xf
    v_mul_f32_dpp v190, v36, v190 row_newbcast:2 row_mask:0xf bank_mask:0xf
    v_mfma_f32_16x16x32_bf16 v[248:251], v[44:47], a[216:219], v[248:251]
    v_mul_f32_dpp v191, v36, v191 row_newbcast:3 row_mask:0xf bank_mask:0xf
    v_cvt_pk_bf16_f32 v176, v176, v180
    v_cvt_pk_bf16_f32 v180, v178, v182
    v_cvt_pk_bf16_f32 v178, v177, v181
    v_cvt_pk_bf16_f32 v182, v179, v183
    v_cvt_pk_bf16_f32 v177, v184, v188
    v_cvt_pk_bf16_f32 v179, v185, v189
    v_cvt_pk_bf16_f32 v181, v186, v190
    v_mfma_f32_16x16x32_bf16 v[252:255], v[44:47], a[220:223], v[252:255]
    ds_write_b128 v24, v[176:179] offset:12288
    v_cvt_pk_bf16_f32 v183, v187, v191
    v_accvgpr_read_b32 v34, a244
    v_accvgpr_read_b32 v38, a245
    ds_write_b128 v24, v[180:183] offset:12800
    v_add_f32 v34, v34, v38
    v_subrev_u32 v38, s38, v34
    v_max_u32 v16, v16, v38
    v_rcp_f32 v34, v34
    ds_read_b64_tr_b16 v[160:161], v5 offset:12288
    ds_read_b64_tr_b16 v[162:163], v6 offset:12288
    ds_read_b64_tr_b16 v[164:165], v5 offset:13312
    ds_read_b64_tr_b16 v[166:167], v6 offset:13312
    ds_read_b64_tr_b16 v[168:169], v5 offset:14336
    ds_read_b64_tr_b16 v[170:171], v6 offset:14336
    ds_read_b64_tr_b16 v[172:173], v5 offset:15360
    ds_read_b64_tr_b16 v[174:175], v6 offset:15360
    v_mov_b32_dpp v34, v34 row_ror:12 row_mask:0xa bank_mask:0xf
    v_accvgpr_read_b32 v36, a246
    s_nop 0
    v_mov_b32_dpp v34, v34 row_ror:8 row_mask:0xc bank_mask:0xf
    v_accvgpr_read_b32 v39, a247
    v_add_f32 v36, v36, v39
    v_subrev_u32 v39, s38, v36
    v_max_u32 v16, v16, v39
    v_rcp_f32 v36, v36
    v_mul_f32_dpp v192, v34, v192 row_newbcast:0 row_mask:0xf bank_mask:0xf
    v_mul_f32_dpp v193, v34, v193 row_newbcast:1 row_mask:0xf bank_mask:0xf
    v_mul_f32_dpp v194, v34, v194 row_newbcast:2 row_mask:0xf bank_mask:0xf
    v_mul_f32_dpp v195, v34, v195 row_newbcast:3 row_mask:0xf bank_mask:0xf
    v_mul_f32_dpp v196, v34, v196 row_newbcast:0 row_mask:0xf bank_mask:0xf
    v_mul_f32_dpp v197, v34, v197 row_newbcast:1 row_mask:0xf bank_mask:0xf
    v_mul_f32_dpp v198, v34, v198 row_newbcast:2 row_mask:0xf bank_mask:0xf
    v_mul_f32_dpp v199, v34, v199 row_newbcast:3 row_mask:0xf bank_mask:0xf
    v_mul_f32_dpp v200, v34, v200 row_newbcast:0 row_mask:0xf bank_mask:0xf
    v_mul_f32_dpp v201, v34, v201 row_newbcast:1 row_mask:0xf bank_mask:0xf
    s_waitcnt lgkmcnt(6)
    s_waitcnt lgkmcnt(4)
    s_waitcnt lgkmcnt(2)
    buffer_store_dwordx4 v[160:163], v10, s[24:27], s47 offen offset:0 sc1
    s_waitcnt lgkmcnt(0)
    buffer_store_dwordx4 v[164:167], v10, s[24:27], s47 offen offset:1024 sc1
    v_mul_f32_dpp v202, v34, v202 row_newbcast:2 row_mask:0xf bank_mask:0xf
    v_mul_f32_dpp v203, v34, v203 row_newbcast:3 row_mask:0xf bank_mask:0xf
    buffer_store_dwordx4 v[168:171], v10, s[24:27], s47 offen offset:2048 sc1
    v_mul_f32_dpp v204, v34, v204 row_newbcast:0 row_mask:0xf bank_mask:0xf
    v_mul_f32_dpp v205, v34, v205 row_newbcast:1 row_mask:0xf bank_mask:0xf
    v_mul_f32_dpp v206, v34, v206 row_newbcast:2 row_mask:0xf bank_mask:0xf
    buffer_store_dwordx4 v[172:175], v10, s[24:27], s47 offen offset:3072 sc1
    v_mul_f32_dpp v207, v34, v207 row_newbcast:3 row_mask:0xf bank_mask:0xf
    v_cvt_pk_bf16_f32 v192, v192, v196
    v_cvt_pk_bf16_f32 v196, v194, v198
    v_cvt_pk_bf16_f32 v194, v193, v197
    v_cvt_pk_bf16_f32 v198, v195, v199
    v_cvt_pk_bf16_f32 v193, v200, v204
    v_cvt_pk_bf16_f32 v195, v201, v205
    v_cvt_pk_bf16_f32 v197, v202, v206
    v_cvt_pk_bf16_f32 v199, v203, v207
    v_mul_f32_dpp v208, v34, v208 row_newbcast:0 row_mask:0xf bank_mask:0xf
    v_mul_f32_dpp v209, v34, v209 row_newbcast:1 row_mask:0xf bank_mask:0xf
    v_mul_f32_dpp v210, v34, v210 row_newbcast:2 row_mask:0xf bank_mask:0xf
    v_mul_f32_dpp v211, v34, v211 row_newbcast:3 row_mask:0xf bank_mask:0xf
    ds_write_b128 v23, v[192:195] offset:16384
    ds_write_b128 v23, v[196:199] offset:16896
    v_mul_f32_dpp v212, v34, v212 row_newbcast:0 row_mask:0xf bank_mask:0xf
    v_mul_f32_dpp v213, v34, v213 row_newbcast:1 row_mask:0xf bank_mask:0xf
    v_mul_f32_dpp v214, v34, v214 row_newbcast:2 row_mask:0xf bank_mask:0xf
    v_mul_f32_dpp v215, v34, v215 row_newbcast:3 row_mask:0xf bank_mask:0xf
    v_mul_f32_dpp v216, v34, v216 row_newbcast:0 row_mask:0xf bank_mask:0xf
    v_mul_f32_dpp v217, v34, v217 row_newbcast:1 row_mask:0xf bank_mask:0xf
    v_mul_f32_dpp v218, v34, v218 row_newbcast:2 row_mask:0xf bank_mask:0xf
    v_mul_f32_dpp v219, v34, v219 row_newbcast:3 row_mask:0xf bank_mask:0xf
    v_mul_f32_dpp v220, v34, v220 row_newbcast:0 row_mask:0xf bank_mask:0xf
    v_mul_f32_dpp v221, v34, v221 row_newbcast:1 row_mask:0xf bank_mask:0xf
    v_mul_f32_dpp v222, v34, v222 row_newbcast:2 row_mask:0xf bank_mask:0xf
    v_mul_f32_dpp v223, v34, v223 row_newbcast:3 row_mask:0xf bank_mask:0xf
    v_cvt_pk_bf16_f32 v208, v208, v212
    v_cvt_pk_bf16_f32 v212, v210, v214
    v_cvt_pk_bf16_f32 v210, v209, v213
    v_cvt_pk_bf16_f32 v214, v211, v215
    v_cvt_pk_bf16_f32 v209, v216, v220
    v_cvt_pk_bf16_f32 v211, v217, v221
    v_cvt_pk_bf16_f32 v213, v218, v222
    v_cvt_pk_bf16_f32 v215, v219, v223
    ds_write_b128 v24, v[208:211] offset:16384
    ds_write_b128 v24, v[212:215] offset:16896
    s_add_u32 s47, s43, 47104
    ds_read_b64_tr_b16 v[192:193], v5 offset:16384
    ds_read_b64_tr_b16 v[194:195], v6 offset:16384
    ds_read_b64_tr_b16 v[196:197], v5 offset:17408
    ds_read_b64_tr_b16 v[198:199], v6 offset:17408
    ds_read_b64_tr_b16 v[200:201], v5 offset:18432
    ds_read_b64_tr_b16 v[202:203], v6 offset:18432
    ds_read_b64_tr_b16 v[204:205], v5 offset:19456
    ds_read_b64_tr_b16 v[206:207], v6 offset:19456
    v_mov_b32_dpp v36, v36 row_ror:12 row_mask:0xa bank_mask:0xf
    s_nop 1
    v_mov_b32_dpp v36, v36 row_ror:8 row_mask:0xc bank_mask:0xf
    s_nop 1
    v_mul_f32_dpp v224, v36, v224 row_newbcast:0 row_mask:0xf bank_mask:0xf
    v_mul_f32_dpp v225, v36, v225 row_newbcast:1 row_mask:0xf bank_mask:0xf
    v_mul_f32_dpp v226, v36, v226 row_newbcast:2 row_mask:0xf bank_mask:0xf
    v_mul_f32_dpp v227, v36, v227 row_newbcast:3 row_mask:0xf bank_mask:0xf
    v_mul_f32_dpp v228, v36, v228 row_newbcast:0 row_mask:0xf bank_mask:0xf
    v_mul_f32_dpp v229, v36, v229 row_newbcast:1 row_mask:0xf bank_mask:0xf
    v_mul_f32_dpp v230, v36, v230 row_newbcast:2 row_mask:0xf bank_mask:0xf
    v_mul_f32_dpp v231, v36, v231 row_newbcast:3 row_mask:0xf bank_mask:0xf
    v_mul_f32_dpp v232, v36, v232 row_newbcast:0 row_mask:0xf bank_mask:0xf
    v_mul_f32_dpp v233, v36, v233 row_newbcast:1 row_mask:0xf bank_mask:0xf
    s_waitcnt lgkmcnt(6)
    s_waitcnt lgkmcnt(4)
    s_waitcnt lgkmcnt(2)
    buffer_store_dwordx4 v[192:195], v10, s[24:27], s46 offen offset:0 sc1
    s_waitcnt lgkmcnt(0)
    buffer_store_dwordx4 v[196:199], v10, s[24:27], s46 offen offset:1024 sc1
    v_mul_f32_dpp v234, v36, v234 row_newbcast:2 row_mask:0xf bank_mask:0xf
    v_mul_f32_dpp v235, v36, v235 row_newbcast:3 row_mask:0xf bank_mask:0xf
    buffer_store_dwordx4 v[200:203], v10, s[24:27], s46 offen offset:2048 sc1
    v_mul_f32_dpp v236, v36, v236 row_newbcast:0 row_mask:0xf bank_mask:0xf
    v_mul_f32_dpp v237, v36, v237 row_newbcast:1 row_mask:0xf bank_mask:0xf
    v_mul_f32_dpp v238, v36, v238 row_newbcast:2 row_mask:0xf bank_mask:0xf
    buffer_store_dwordx4 v[204:207], v10, s[24:27], s46 offen offset:3072 sc1
    v_mul_f32_dpp v239, v36, v239 row_newbcast:3 row_mask:0xf bank_mask:0xf
    v_cvt_pk_bf16_f32 v224, v224, v228
    v_cvt_pk_bf16_f32 v228, v226, v230
    v_cvt_pk_bf16_f32 v226, v225, v229
    v_cvt_pk_bf16_f32 v230, v227, v231
    v_cvt_pk_bf16_f32 v225, v232, v236
    v_cvt_pk_bf16_f32 v227, v233, v237
    v_cvt_pk_bf16_f32 v229, v234, v238
    v_cvt_pk_bf16_f32 v231, v235, v239
    v_mul_f32_dpp v240, v36, v240 row_newbcast:0 row_mask:0xf bank_mask:0xf
    v_mul_f32_dpp v241, v36, v241 row_newbcast:1 row_mask:0xf bank_mask:0xf
    v_mul_f32_dpp v242, v36, v242 row_newbcast:2 row_mask:0xf bank_mask:0xf
    v_mul_f32_dpp v243, v36, v243 row_newbcast:3 row_mask:0xf bank_mask:0xf
    ds_write_b128 v23, v[224:227] offset:20480
    ds_write_b128 v23, v[228:231] offset:20992
    v_mul_f32_dpp v244, v36, v244 row_newbcast:0 row_mask:0xf bank_mask:0xf
    v_mul_f32_dpp v245, v36, v245 row_newbcast:1 row_mask:0xf bank_mask:0xf
    v_mul_f32_dpp v246, v36, v246 row_newbcast:2 row_mask:0xf bank_mask:0xf
    v_mul_f32_dpp v247, v36, v247 row_newbcast:3 row_mask:0xf bank_mask:0xf
    v_mul_f32_dpp v248, v36, v248 row_newbcast:0 row_mask:0xf bank_mask:0xf
    v_mul_f32_dpp v249, v36, v249 row_newbcast:1 row_mask:0xf bank_mask:0xf
    v_mul_f32_dpp v250, v36, v250 row_newbcast:2 row_mask:0xf bank_mask:0xf
    v_mul_f32_dpp v251, v36, v251 row_newbcast:3 row_mask:0xf bank_mask:0xf
    v_mul_f32_dpp v252, v36, v252 row_newbcast:0 row_mask:0xf bank_mask:0xf
    v_mul_f32_dpp v253, v36, v253 row_newbcast:1 row_mask:0xf bank_mask:0xf
    v_mul_f32_dpp v254, v36, v254 row_newbcast:2 row_mask:0xf bank_mask:0xf
    v_mul_f32_dpp v255, v36, v255 row_newbcast:3 row_mask:0xf bank_mask:0xf
    v_cvt_pk_bf16_f32 v240, v240, v244
    v_cvt_pk_bf16_f32 v244, v242, v246
    v_cvt_pk_bf16_f32 v242, v241, v245
    v_cvt_pk_bf16_f32 v246, v243, v247
    v_cvt_pk_bf16_f32 v241, v248, v252
    v_cvt_pk_bf16_f32 v243, v249, v253
    v_cvt_pk_bf16_f32 v245, v250, v254
    v_cvt_pk_bf16_f32 v247, v251, v255
    ds_write_b128 v24, v[240:243] offset:20480
    ds_write_b128 v24, v[244:247] offset:20992
    ds_read_b64_tr_b16 v[224:225], v5 offset:20480
    ds_read_b64_tr_b16 v[226:227], v6 offset:20480
    ds_read_b64_tr_b16 v[228:229], v5 offset:21504
    ds_read_b64_tr_b16 v[230:231], v6 offset:21504
    ds_read_b64_tr_b16 v[232:233], v5 offset:22528
    ds_read_b64_tr_b16 v[234:235], v6 offset:22528
    ds_read_b64_tr_b16 v[236:237], v5 offset:23552
    ds_read_b64_tr_b16 v[238:239], v6 offset:23552
    s_waitcnt lgkmcnt(6)
    s_waitcnt lgkmcnt(4)
    s_waitcnt lgkmcnt(2)
    buffer_store_dwordx4 v[224:227], v10, s[24:27], s47 offen offset:0 sc1
    s_waitcnt lgkmcnt(0)
    buffer_store_dwordx4 v[228:231], v10, s[24:27], s47 offen offset:1024 sc1
    buffer_store_dwordx4 v[232:235], v10, s[24:27], s47 offen offset:2048 sc1
    buffer_store_dwordx4 v[236:239], v10, s[24:27], s47 offen offset:3072 sc1
    s_waitcnt vmcnt(0)
    s_mov_b32 s3, 0x20000000
    v_cmp_lt_u32 s[4:5], s3, v15
    v_cmp_lt_u32 s[6:7], s3, v16
    s_or_b64 s[8:9], s[4:5], s[6:7]
    s_cbranch_scc1 L_FIX
    s_endpgm
L_ROLE_B:
    v_mfma_f32_16x16x32_bf16 v[48:51], a[96:99], a[0:3], 0
    s_add_u32 m0, s43, 12288
    s_add_u32 s46, s43, 4294912000
    buffer_load_dwordx4 v11, s[12:15], s46 offen offset:0 nt lds
    v_mfma_f32_16x16x32_bf16 v[48:51], a[100:103], a[4:7], v[48:51]
    buffer_load_dwordx4 v12, s[12:15], s46 offen offset:1024 nt lds
    v_mfma_f32_16x16x32_bf16 v[48:51], a[104:107], a[8:11], v[48:51]
    buffer_load_dwordx4 v13, s[12:15], s46 offen offset:2048 nt lds
    buffer_load_dwordx4 v14, s[12:15], s46 offen offset:3072 nt lds
    v_mfma_f32_16x16x32_bf16 v[48:51], a[108:111], a[12:15], v[48:51]
    s_waitcnt vmcnt(8)
    ds_read_b128 v[24:27], v5 offset:4096
    v_mfma_f32_16x16x32_bf16 v[52:55], a[124:127], a[12:15], 0
    ds_read_b128 v[28:31], v6 offset:4096
    v_mfma_f32_16x16x32_bf16 v[52:55], a[120:123], a[8:11], v[52:55]
    s_waitcnt lgkmcnt(1)
    v_lshlrev_b32 v32, 16, v24
    v_and_b32 v24, s36, v24
    v_mul_f32 v32, s35, v32
    v_mul_f32 v24, s35, v24
    v_cvt_pk_bf16_f32 v24, v32, v24
    v_accvgpr_write_b32 a16, v24
    v_lshlrev_b32 v33, 16, v25
    v_and_b32 v25, s36, v25
    v_mul_f32 v33, s35, v33
    v_mul_f32 v25, s35, v25
    v_cvt_pk_bf16_f32 v25, v33, v25
    v_accvgpr_write_b32 a17, v25
    v_lshlrev_b32 v32, 16, v26
    v_and_b32 v26, s36, v26
    v_mul_f32 v32, s35, v32
    v_mul_f32 v26, s35, v26
    v_cvt_pk_bf16_f32 v26, v32, v26
    v_accvgpr_write_b32 a18, v26
    v_lshlrev_b32 v33, 16, v27
    v_and_b32 v27, s36, v27
    v_mul_f32 v33, s35, v33
    v_mul_f32 v27, s35, v27
    v_cvt_pk_bf16_f32 v27, v33, v27
    v_accvgpr_write_b32 a19, v27
    v_mfma_f32_16x16x32_bf16 v[52:55], a[116:119], a[4:7], v[52:55]
    s_waitcnt lgkmcnt(0)
    ds_read_b128 v[24:27], v7 offset:4096
    v_lshlrev_b32 v32, 16, v28
    v_and_b32 v28, s36, v28
    v_mul_f32 v32, s35, v32
    v_mul_f32 v28, s35, v28
    v_cvt_pk_bf16_f32 v28, v32, v28
    v_accvgpr_write_b32 a20, v28
    v_lshlrev_b32 v33, 16, v29
    v_and_b32 v29, s36, v29
    v_mul_f32 v33, s35, v33
    v_mul_f32 v29, s35, v29
    v_cvt_pk_bf16_f32 v29, v33, v29
    v_accvgpr_write_b32 a21, v29
    v_lshlrev_b32 v32, 16, v30
    v_and_b32 v30, s36, v30
    v_mul_f32 v32, s35, v32
    v_mul_f32 v30, s35, v30
    v_cvt_pk_bf16_f32 v30, v32, v30
    v_accvgpr_write_b32 a22, v30
    v_lshlrev_b32 v33, 16, v31
    v_and_b32 v31, s36, v31
    v_mul_f32 v33, s35, v33
    v_mul_f32 v31, s35, v31
    v_cvt_pk_bf16_f32 v31, v33, v31
    v_accvgpr_write_b32 a23, v31
    v_mfma_f32_16x16x32_bf16 v[52:55], a[112:115], a[0:3], v[52:55]
    ds_read_b128 v[28:31], v8 offset:4096
    v_exp_f32 v48, v48
    v_exp_f32 v50, v50
    v_mfma_f32_16x16x32_bf16 v[56:59], a[96:99], a[16:19], 0
    s_waitcnt lgkmcnt(1)
    v_lshlrev_b32 v32, 16, v24
    v_and_b32 v24, s36, v24
    v_mul_f32 v32, s35, v32
    v_mul_f32 v24, s35, v24
    v_cvt_pk_bf16_f32 v24, v32, v24
    v_accvgpr_write_b32 a24, v24
    v_lshlrev_b32 v33, 16, v25
    v_and_b32 v25, s36, v25
    v_mul_f32 v33, s35, v33
    v_mul_f32 v25, s35, v25
    v_cvt_pk_bf16_f32 v25, v33, v25
    v_accvgpr_write_b32 a25, v25
    v_lshlrev_b32 v32, 16, v26
    v_and_b32 v26, s36, v26
    v_mul_f32 v32, s35, v32
    v_mul_f32 v26, s35, v26
    v_cvt_pk_bf16_f32 v26, v32, v26
    v_accvgpr_write_b32 a26, v26
    v_lshlrev_b32 v33, 16, v27
    v_and_b32 v27, s36, v27
    v_mul_f32 v33, s35, v33
    v_mul_f32 v27, s35, v27
    v_cvt_pk_bf16_f32 v27, v33, v27
    v_accvgpr_write_b32 a27, v27
    v_exp_f32 v49, v49
    v_mfma_f32_16x16x32_bf16 v[56:59], a[100:103], a[20:23], v[56:59]
    s_waitcnt lgkmcnt(0)
    v_lshlrev_b32 v32, 16, v28
    v_and_b32 v28, s36, v28
    v_mul_f32 v32, s35, v32
    v_mul_f32 v28, s35, v28
    v_cvt_pk_bf16_f32 v28, v32, v28
    v_accvgpr_write_b32 a28, v28
    v_lshlrev_b32 v33, 16, v29
    v_and_b32 v29, s36, v29
    v_mul_f32 v33, s35, v33
    v_mul_f32 v29, s35, v29
    v_cvt_pk_bf16_f32 v29, v33, v29
    v_accvgpr_write_b32 a29, v29
    v_lshlrev_b32 v32, 16, v30
    v_and_b32 v30, s36, v30
    v_mul_f32 v32, s35, v32
    v_mul_f32 v30, s35, v30
    v_cvt_pk_bf16_f32 v30, v32, v30
    v_accvgpr_write_b32 a30, v30
    v_lshlrev_b32 v33, 16, v31
    v_and_b32 v31, s36, v31
    v_mul_f32 v33, s35, v33
    v_mul_f32 v31, s35, v31
    v_cvt_pk_bf16_f32 v31, v33, v31
    v_accvgpr_write_b32 a31, v31
    s_add_u32 m0, s43, 16384
    s_add_u32 s46, s43, 4294916096
    buffer_load_dwordx4 v11, s[12:15], s46 offen offset:0 nt lds
    v_mfma_f32_16x16x32_bf16 v[56:59], a[104:107], a[24:27], v[56:59]
    buffer_load_dwordx4 v12, s[12:15], s46 offen offset:1024 nt lds
    buffer_load_dwordx4 v13, s[12:15], s46 offen offset:2048 nt lds
    v_exp_f32 v51, v51
    v_mfma_f32_16x16x32_bf16 v[56:59], a[108:111], a[28:31], v[56:59]
    v_exp_f32 v54, v54
    v_exp_f32 v55, v55
    v_cvt_pk_bf16_f32 v41, v50, v51
    v_mfma_f32_16x16x32_bf16 v[60:63], a[124:127], a[28:31], 0
    v_exp_f32 v52, v52
    v_cvt_pk_bf16_f32 v40, v48, v49
    v_mfma_f32_16x16x32_bf16 v[60:63], a[120:123], a[24:27], v[60:63]
    v_exp_f32 v53, v53
    v_mfma_f32_16x16x32_bf16 v[60:63], a[116:119], a[20:23], v[60:63]
    v_cvt_pk_bf16_f32 v42, v52, v53
    v_cvt_pk_bf16_f32 v43, v54, v55
    v_mfma_f32_16x16x32_bf16 v[60:63], a[112:115], a[16:19], v[60:63]
    buffer_load_dwordx4 v14, s[12:15], s46 offen offset:3072 nt lds
    v_mfma_f32_16x16x32_bf16 v[64:67], v[40:43], a[160:163], 0
    s_waitcnt vmcnt(8)
    ds_read_b128 v[24:27], v5 offset:8192
    ds_read_b128 v[28:31], v6 offset:8192
    v_exp_f32 v56, v56
    v_mfma_f32_16x16x32_bf16 v[68:71], v[40:43], a[164:167], 0
    s_mov_b32 s32, 8192
    s_mov_b32 s33, 12288
    s_mov_b32 m0, 8448
    s_nop 0
    buffer_load_dwordx4 v10, s[16:19], s32 offen offset:0 nt lds
    s_mov_b32 m0, 8480
    s_nop 0
    buffer_load_dwordx4 v10, s[16:19], s32 offen offset:1024 nt lds
    v_mfma_f32_16x16x32_bf16 v[72:75], v[40:43], a[168:171], 0
    s_waitcnt lgkmcnt(1)
    v_lshlrev_b32 v32, 16, v24
    v_and_b32 v24, s36, v24
    v_mul_f32 v32, s35, v32
    v_mul_f32 v24, s35, v24
    v_cvt_pk_bf16_f32 v24, v32, v24
    v_accvgpr_write_b32 a32, v24
    v_lshlrev_b32 v33, 16, v25
    v_and_b32 v25, s36, v25
    v_mul_f32 v33, s35, v33
    v_lshlrev_b32 v32, 16, v26
    v_and_b32 v26, s36, v26
    v_mul_f32 v32, s35, v32
    s_mov_b32 m0, 8512
    s_nop 0
    buffer_load_dwordx4 v10, s[16:19], s32 offen offset:2048 nt lds
    s_mov_b32 m0, 8544
    s_nop 0
    buffer_load_dwordx4 v10, s[16:19], s32 offen offset:3072 nt lds
    v_exp_f32 v57, v57
    v_exp_f32 v62, v62
    v_mfma_f32_16x16x32_bf16 v[76:79], v[40:43], a[172:175], 0
    s_waitcnt lgkmcnt(0)
    v_mul_f32 v25, s35, v25
    v_cvt_pk_bf16_f32 v25, v33, v25
    v_accvgpr_write_b32 a33, v25
    v_mul_f32 v26, s35, v26
    v_cvt_pk_bf16_f32 v26, v32, v26
    v_accvgpr_write_b32 a34, v26
    v_lshlrev_b32 v33, 16, v27
    v_and_b32 v27, s36, v27
    v_mul_f32 v33, s35, v33
    v_mul_f32 v27, s35, v27
    v_cvt_pk_bf16_f32 v27, v33, v27
    v_accvgpr_write_b32 a35, v27
    v_lshlrev_b32 v32, 16, v28
    v_and_b32 v28, s36, v28
    v_mul_f32 v32, s35, v32
    v_mul_f32 v28, s35, v28
    v_cvt_pk_bf16_f32 v28, v32, v28
    v_lshlrev_b32 v33, 16, v29
    v_and_b32 v29, s36, v29
    v_mul_f32 v33, s35, v33
    v_mul_f32 v29, s35, v29
    v_lshlrev_b32 v32, 16, v30
    v_and_b32 v30, s36, v30
    v_mul_f32 v32, s35, v32
    v_exp_f32 v58, v58
    v_mfma_f32_16x16x32_bf16 v[80:83], v[40:43], a[176:179], 0
    ds_read_b128 v[24:27], v7 offset:8192
    v_accvgpr_write_b32 a36, v28
    v_cvt_pk_bf16_f32 v29, v33, v29
    v_accvgpr_write_b32 a37, v29
    v_mul_f32 v30, s35, v30
    v_cvt_pk_bf16_f32 v30, v32, v30
    v_lshlrev_b32 v33, 16, v31
    v_and_b32 v31, s36, v31
    v_mul_f32 v33, s35, v33
    v_mul_f32 v31, s35, v31
    v_cvt_pk_bf16_f32 v31, v33, v31
    s_mov_b32 m0, 12672
    s_nop 0
    buffer_load_dwordx4 v10, s[16:19], s33 offen offset:0 nt lds
    s_mov_b32 m0, 12704
    s_nop 0
    buffer_load_dwordx4 v10, s[16:19], s33 offen offset:1024 nt lds
    v_exp_f32 v61, v61
    v_mfma_f32_16x16x32_bf16 v[84:87], v[40:43], a[180:183], 0
    v_exp_f32 v63, v63
    v_mfma_f32_16x16x32_bf16 v[88:91], v[40:43], a[184:187], 0
    s_waitcnt lgkmcnt(0)
    v_accvgpr_write_b32 a38, v30
    v_accvgpr_write_b32 a39, v31
    v_lshlrev_b32 v32, 16, v24
    v_mul_f32 v32, s35, v32
    v_lshlrev_b32 v33, 16, v25
    v_mfma_f32_16x16x32_bf16 v[92:95], v[40:43], a[188:191], 0
    ds_read_b128 v[28:31], v8 offset:8192
    v_and_b32 v24, s36, v24
    v_mul_f32 v24, s35, v24
    v_cvt_pk_bf16_f32 v24, v32, v24
    v_accvgpr_write_b32 a40, v24
    v_mul_f32 v33, s35, v33
    v_cvt_pk_bf16_f32 v44, v56, v57
    v_cvt_pk_bf16_f32 v47, v62, v63
    v_mfma_f32_16x16x32_bf16 v[48:51], a[96:99], a[32:35], 0
    v_and_b32 v25, s36, v25
    v_mul_f32 v25, s35, v25
    v_cvt_pk_bf16_f32 v25, v33, v25
    v_accvgpr_write_b32 a41, v25
    v_lshlrev_b32 v32, 16, v26
    v_and_b32 v26, s36, v26
    v_mul_f32 v32, s35, v32
    v_mul_f32 v26, s35, v26
    v_cvt_pk_bf16_f32 v26, v32, v26
    v_accvgpr_write_b32 a42, v26
    v_lshlrev_b32 v33, 16, v27
    v_and_b32 v27, s36, v27
    v_mul_f32 v33, s35, v33
    v_mul_f32 v27, s35, v27
    v_cvt_pk_bf16_f32 v27, v33, v27
    v_accvgpr_write_b32 a43, v27
    v_mfma_f32_16x16x32_bf16 v[48:51], a[100:103], a[36:39], v[48:51]
    s_waitcnt lgkmcnt(0)
    v_lshlrev_b32 v32, 16, v28
    v_and_b32 v28, s36, v28
    v_mul_f32 v32, s35, v32
    v_mul_f32 v28, s35, v28
    v_cvt_pk_bf16_f32 v28, v32, v28
    v_accvgpr_write_b32 a44, v28
    v_lshlrev_b32 v33, 16, v29
    v_and_b32 v29, s36, v29
    v_mul_f32 v33, s35, v33
    v_mul_f32 v29, s35, v29
    v_cvt_pk_bf16_f32 v29, v33, v29
    v_accvgpr_write_b32 a45, v29
    v_lshlrev_b32 v32, 16, v30
    v_and_b32 v30, s36, v30
    v_mul_f32 v32, s35, v32
    v_mul_f32 v30, s35, v30
    v_cvt_pk_bf16_f32 v30, v32, v30
    v_accvgpr_write_b32 a46, v30
    v_lshlrev_b32 v33, 16, v31
    v_and_b32 v31, s36, v31
    v_mul_f32 v33, s35, v33
    v_mul_f32 v31, s35, v31
    v_cvt_pk_bf16_f32 v31, v33, v31
    v_accvgpr_write_b32 a47, v31
    v_exp_f32 v60, v60
    v_mfma_f32_16x16x32_bf16 v[48:51], a[104:107], a[40:43], v[48:51]
    s_mov_b32 m0, 12736
    s_nop 0
    buffer_load_dwordx4 v10, s[16:19], s33 offen offset:2048 nt lds
    v_mfma_f32_16x16x32_bf16 v[48:51], a[108:111], a[44:47], v[48:51]
    s_mov_b32 m0, 12768
    s_nop 0
    buffer_load_dwordx4 v10, s[16:19], s33 offen offset:3072 nt lds
    v_mfma_f32_16x16x32_bf16 v[52:55], a[124:127], a[44:47], 0
    s_mov_b32 m0, 42240
    s_nop 0
    buffer_load_dwordx4 v10, s[20:23], s32 offen offset:0 nt lds
    v_cvt_pk_bf16_f32 v46, v60, v61
    v_mfma_f32_16x16x32_bf16 v[52:55], a[120:123], a[40:43], v[52:55]
    s_mov_b32 m0, 42256
    s_nop 0
    buffer_load_dwordx4 v10, s[20:23], s32 offen offset:1024 nt lds
    v_exp_f32 v59, v59
    v_mfma_f32_16x16x32_bf16 v[52:55], a[116:119], a[36:39], v[52:55]
    s_mov_b32 m0, 42272
    s_nop 0
    buffer_load_dwordx4 v10, s[20:23], s32 offen offset:2048 nt lds
    v_cvt_pk_bf16_f32 v45, v58, v59
    v_mfma_f32_16x16x32_bf16 v[52:55], a[112:115], a[32:35], v[52:55]
    s_mov_b32 m0, 42288
    s_nop 0
    buffer_load_dwordx4 v10, s[20:23], s32 offen offset:3072 nt lds
    v_smfmac_f32_16x16x64_bf16 a[224:227], a[248:251], v[40:47], v19
    v_exp_f32 v49, v49
    v_mfma_f32_16x16x32_bf16 v[96:99], v[44:47], a[160:163], 0
    s_mov_b32 m0, 46400
    s_nop 0
    buffer_load_dwordx4 v10, s[20:23], s33 offen offset:0 nt lds
    v_mfma_f32_16x16x32_bf16 v[100:103], v[44:47], a[164:167], 0
    s_mov_b32 m0, 46416
    s_nop 0
    buffer_load_dwordx4 v10, s[20:23], s33 offen offset:1024 nt lds
    v_mfma_f32_16x16x32_bf16 v[104:107], v[44:47], a[168:171], 0
    s_mov_b32 m0, 46432
    s_nop 0
    buffer_load_dwordx4 v10, s[20:23], s33 offen offset:2048 nt lds
    s_mov_b32 m0, 46448
    s_nop 0
    buffer_load_dwordx4 v10, s[20:23], s33 offen offset:3072 nt lds
    v_exp_f32 v50, v50
    v_mfma_f32_16x16x32_bf16 v[108:111], v[44:47], a[172:175], 0
    s_waitcnt vmcnt(20)
    ds_read_b128 v[24:27], v5 offset:12288
    ds_read_b128 v[28:31], v6 offset:12288
    v_exp_f32 v53, v53
    v_mfma_f32_16x16x32_bf16 v[112:115], v[44:47], a[176:179], 0
    s_mov_b32 s32, 16384
    v_exp_f32 v48, v48
    v_mfma_f32_16x16x32_bf16 v[116:119], v[44:47], a[180:183], 0
    s_waitcnt lgkmcnt(1)
    s_waitcnt lgkmcnt(0)
    v_lshlrev_b32 v32, 16, v24
    v_and_b32 v24, s36, v24
    v_mul_f32 v32, s35, v32
    v_mul_f32 v24, s35, v24
    v_cvt_pk_bf16_f32 v24, v32, v24
    v_accvgpr_write_b32 a48, v24
    v_lshlrev_b32 v33, 16, v25
    v_and_b32 v25, s36, v25
    v_mul_f32 v33, s35, v33
    v_mul_f32 v25, s35, v25
    v_cvt_pk_bf16_f32 v25, v33, v25
    v_accvgpr_write_b32 a49, v25
    v_lshlrev_b32 v32, 16, v26
    v_and_b32 v26, s36, v26
    v_mul_f32 v32, s35, v32
    v_mul_f32 v26, s35, v26
    v_cvt_pk_bf16_f32 v26, v32, v26
    v_accvgpr_write_b32 a50, v26
    v_lshlrev_b32 v33, 16, v27
    v_and_b32 v27, s36, v27
    v_mul_f32 v33, s35, v33
    v_mul_f32 v27, s35, v27
    v_cvt_pk_bf16_f32 v27, v33, v27
    v_accvgpr_write_b32 a51, v27
    v_lshlrev_b32 v32, 16, v28
    v_and_b32 v28, s36, v28
    v_mul_f32 v32, s35, v32
    v_mul_f32 v28, s35, v28
    v_cvt_pk_bf16_f32 v28, v32, v28
    v_lshlrev_b32 v33, 16, v29
    v_and_b32 v29, s36, v29
    v_mul_f32 v33, s35, v33
    v_mul_f32 v29, s35, v29
    v_cvt_pk_bf16_f32 v29, v33, v29
    v_lshlrev_b32 v32, 16, v30
    v_and_b32 v30, s36, v30
    v_mul_f32 v32, s35, v32
    v_mul_f32 v30, s35, v30
    v_cvt_pk_bf16_f32 v30, v32, v30
    v_lshlrev_b32 v33, 16, v31
    v_and_b32 v31, s36, v31
    v_mul_f32 v33, s35, v33
    v_mul_f32 v31, s35, v31
    v_cvt_pk_bf16_f32 v31, v33, v31
    v_mfma_f32_16x16x32_bf16 v[120:123], v[44:47], a[184:187], 0
    ds_read_b128 v[24:27], v7 offset:12288
    v_accvgpr_write_b32 a52, v28
    v_accvgpr_write_b32 a53, v29
    v_accvgpr_write_b32 a54, v30
    v_accvgpr_write_b32 a55, v31
    v_mfma_f32_16x16x32_bf16 v[124:127], v[44:47], a[188:191], 0
    s_add_u32 s33, s32, 4096
    ds_read_b128 v[28:31], v8 offset:12288
    v_exp_f32 v51, v51
    v_exp_f32 v52, v52
    v_mfma_f32_16x16x32_bf16 v[56:59], a[96:99], a[48:51], 0
    s_waitcnt lgkmcnt(1)
    v_lshlrev_b32 v32, 16, v24
    v_and_b32 v24, s36, v24
    v_mul_f32 v32, s35, v32
    v_mul_f32 v24, s35, v24
    v_cvt_pk_bf16_f32 v24, v32, v24
    v_accvgpr_write_b32 a56, v24
    v_lshlrev_b32 v33, 16, v25
    v_and_b32 v25, s36, v25
    v_mul_f32 v33, s35, v33
    v_mul_f32 v25, s35, v25
    v_cvt_pk_bf16_f32 v25, v33, v25
    v_accvgpr_write_b32 a57, v25
    v_lshlrev_b32 v32, 16, v26
    v_and_b32 v26, s36, v26
    v_mul_f32 v32, s35, v32
    v_mul_f32 v26, s35, v26
    v_cvt_pk_bf16_f32 v26, v32, v26
    v_accvgpr_write_b32 a58, v26
    v_lshlrev_b32 v33, 16, v27
    v_and_b32 v27, s36, v27
    v_mul_f32 v33, s35, v33
    v_mul_f32 v27, s35, v27
    v_cvt_pk_bf16_f32 v27, v33, v27
    v_accvgpr_write_b32 a59, v27
    v_exp_f32 v54, v54
    v_mfma_f32_16x16x32_bf16 v[56:59], a[100:103], a[52:55], v[56:59]
    s_waitcnt lgkmcnt(0)
    v_lshlrev_b32 v32, 16, v28
    v_and_b32 v28, s36, v28
    v_mul_f32 v32, s35, v32
    v_mul_f32 v28, s35, v28
    v_cvt_pk_bf16_f32 v28, v32, v28
    v_accvgpr_write_b32 a60, v28
    v_lshlrev_b32 v33, 16, v29
    v_and_b32 v29, s36, v29
    v_mul_f32 v33, s35, v33
    v_mul_f32 v29, s35, v29
    v_cvt_pk_bf16_f32 v29, v33, v29
    v_accvgpr_write_b32 a61, v29
    v_lshlrev_b32 v32, 16, v30
    v_and_b32 v30, s36, v30
    v_mul_f32 v32, s35, v32
    v_mul_f32 v30, s35, v30
    v_cvt_pk_bf16_f32 v30, v32, v30
    v_accvgpr_write_b32 a62, v30
    v_lshlrev_b32 v33, 16, v31
    v_and_b32 v31, s36, v31
    v_mul_f32 v33, s35, v33
    v_mul_f32 v31, s35, v31
    v_cvt_pk_bf16_f32 v31, v33, v31
    v_accvgpr_write_b32 a63, v31
    v_mfma_f32_16x16x32_bf16 v[56:59], a[104:107], a[56:59], v[56:59]
    v_cvt_pk_bf16_f32 v40, v48, v49
    v_cvt_pk_bf16_f32 v42, v52, v53
    v_mfma_f32_16x16x32_bf16 v[56:59], a[108:111], a[60:63], v[56:59]
    v_exp_f32 v55, v55
    v_mfma_f32_16x16x32_bf16 v[60:63], a[124:127], a[60:63], 0
    v_cvt_pk_bf16_f32 v41, v50, v51
    v_cvt_pk_bf16_f32 v43, v54, v55
    v_mfma_f32_16x16x32_bf16 v[60:63], a[120:123], a[56:59], v[60:63]
    v_exp_f32 v59, v59
    v_mfma_f32_16x16x32_bf16 v[60:63], a[116:119], a[52:55], v[60:63]
    v_exp_f32 v57, v57
    v_mfma_f32_16x16x32_bf16 v[60:63], a[112:115], a[48:51], v[60:63]
    v_exp_f32 v56, v56
    v_mfma_f32_16x16x32_bf16 v[128:131], v[40:43], a[160:163], 0
    s_waitcnt vmcnt(16)
    ds_read_b128 v[24:27], v5 offset:16384
    v_exp_f32 v58, v58
    v_mfma_f32_16x16x32_bf16 v[132:135], v[40:43], a[164:167], 0
    v_exp_f32 v60, v60
    v_mfma_f32_16x16x32_bf16 v[136:139], v[40:43], a[168:171], 0
    s_waitcnt lgkmcnt(0)
    ds_read_b128 v[28:31], v6 offset:16384
    v_lshlrev_b32 v33, 16, v25
    v_and_b32 v25, s36, v25
    v_mfma_f32_16x16x32_bf16 v[140:143], v[40:43], a[172:175], 0
    v_lshlrev_b32 v32, 16, v24
    v_and_b32 v24, s36, v24
    v_mul_f32 v24, s35, v24
    v_mul_f32 v33, s35, v33
    v_mul_f32 v25, s35, v25
    v_cvt_pk_bf16_f32 v25, v33, v25
    v_lshlrev_b32 v33, 16, v27
    v_and_b32 v27, s36, v27
    v_mul_f32 v33, s35, v33
    v_mul_f32 v27, s35, v27
    v_cvt_pk_bf16_f32 v27, v33, v27
    v_mfma_f32_16x16x32_bf16 v[144:147], v[40:43], a[176:179], 0
    s_waitcnt lgkmcnt(0)
    v_mul_f32 v32, s35, v32
    v_cvt_pk_bf16_f32 v24, v32, v24
    v_accvgpr_write_b32 a64, v24
    v_accvgpr_write_b32 a65, v25
    v_lshlrev_b32 v32, 16, v26
    v_and_b32 v26, s36, v26
    v_mul_f32 v32, s35, v32
    v_mul_f32 v26, s35, v26
    v_cvt_pk_bf16_f32 v26, v32, v26
    v_lshlrev_b32 v33, 16, v29
    v_and_b32 v29, s36, v29
    v_mul_f32 v29, s35, v29
    v_mfma_f32_16x16x32_bf16 v[148:151], v[40:43], a[180:183], 0
    v_accvgpr_write_b32 a66, v26
    v_accvgpr_write_b32 a67, v27
    v_lshlrev_b32 v32, 16, v28
    v_and_b32 v28, s36, v28
    v_mul_f32 v32, s35, v32
    v_mul_f32 v28, s35, v28
    v_cvt_pk_bf16_f32 v28, v32, v28
    v_accvgpr_write_b32 a68, v28
    v_mul_f32 v33, s35, v33
    v_cvt_pk_bf16_f32 v29, v33, v29
    v_lshlrev_b32 v32, 16, v30
    v_mul_f32 v32, s35, v32
    v_lshlrev_b32 v33, 16, v31
    v_mfma_f32_16x16x32_bf16 v[152:155], v[40:43], a[184:187], 0
    ds_read_b128 v[24:27], v7 offset:16384
    v_accvgpr_write_b32 a69, v29
    v_and_b32 v30, s36, v30
    v_mul_f32 v30, s35, v30
    v_cvt_pk_bf16_f32 v30, v32, v30
    v_accvgpr_write_b32 a70, v30
    v_and_b32 v31, s36, v31
    v_mul_f32 v33, s35, v33
    v_mul_f32 v31, s35, v31
    v_cvt_pk_bf16_f32 v31, v33, v31
    v_accvgpr_write_b32 a71, v31
    v_mfma_f32_16x16x32_bf16 v[156:159], v[40:43], a[188:191], 0
    ds_read_b128 v[28:31], v8 offset:16384
    v_cvt_pk_bf16_f32 v45, v58, v59
    v_mfma_f32_16x16x32_bf16 v[224:227], a[96:99], a[64:67], 0
    s_waitcnt lgkmcnt(1)
    v_lshlrev_b32 v32, 16, v24
    v_and_b32 v24, s36, v24
    v_mul_f32 v32, s35, v32
    v_mul_f32 v24, s35, v24
    v_cvt_pk_bf16_f32 v24, v32, v24
    v_accvgpr_write_b32 a72, v24
    v_lshlrev_b32 v33, 16, v25
    v_and_b32 v25, s36, v25
    v_mul_f32 v33, s35, v33
    v_mul_f32 v25, s35, v25
    v_cvt_pk_bf16_f32 v25, v33, v25
    v_accvgpr_write_b32 a73, v25
    v_lshlrev_b32 v32, 16, v26
    v_and_b32 v26, s36, v26
    v_mul_f32 v32, s35, v32
    v_mul_f32 v26, s35, v26
    v_cvt_pk_bf16_f32 v26, v32, v26
    v_accvgpr_write_b32 a74, v26
    v_lshlrev_b32 v33, 16, v27
    v_and_b32 v27, s36, v27
    v_mul_f32 v33, s35, v33
    v_mul_f32 v27, s35, v27
    v_cvt_pk_bf16_f32 v27, v33, v27
    v_accvgpr_write_b32 a75, v27
    v_mfma_f32_16x16x32_bf16 v[224:227], a[100:103], a[68:71], v[224:227]
    s_waitcnt lgkmcnt(0)
    v_lshlrev_b32 v32, 16, v28
    v_and_b32 v28, s36, v28
    v_mul_f32 v32, s35, v32
    v_mul_f32 v28, s35, v28
    v_cvt_pk_bf16_f32 v28, v32, v28
    v_accvgpr_write_b32 a76, v28
    v_lshlrev_b32 v33, 16, v29
    v_and_b32 v29, s36, v29
    v_mul_f32 v33, s35, v33
    v_mul_f32 v29, s35, v29
    v_cvt_pk_bf16_f32 v29, v33, v29
    v_accvgpr_write_b32 a77, v29
    v_lshlrev_b32 v32, 16, v30
    v_and_b32 v30, s36, v30
    v_mul_f32 v32, s35, v32
    v_mul_f32 v30, s35, v30
    v_cvt_pk_bf16_f32 v30, v32, v30
    v_accvgpr_write_b32 a78, v30
    v_lshlrev_b32 v33, 16, v31
    v_and_b32 v31, s36, v31
    v_mul_f32 v33, s35, v33
    v_mul_f32 v31, s35, v31
    v_cvt_pk_bf16_f32 v31, v33, v31
    v_accvgpr_write_b32 a79, v31
    v_mfma_f32_16x16x32_bf16 v[224:227], a[104:107], a[72:75], v[224:227]
    v_exp_f32 v63, v63
    v_mfma_f32_16x16x32_bf16 v[224:227], a[108:111], a[76:79], v[224:227]
    v_exp_f32 v62, v62
    v_mfma_f32_16x16x32_bf16 v[228:231], a[124:127], a[76:79], 0
    v_exp_f32 v61, v61
    v_mfma_f32_16x16x32_bf16 v[228:231], a[120:123], a[72:75], v[228:231]
    s_waitcnt vmcnt(0)
    v_cvt_pk_bf16_f32 v46, v60, v61
    v_cvt_pk_bf16_f32 v47, v62, v63
    v_exp_f32 v224, v224
    v_mfma_f32_16x16x32_bf16 v[228:231], a[116:119], a[68:71], v[228:231]
    s_barrier
    ds_read_b64_tr_b16 a[202:203], v4 offset:42784
    ds_read_b64_tr_b16 a[210:211], v4 offset:42816
    v_cvt_pk_bf16_f32 v44, v56, v57
    v_mfma_f32_16x16x32_bf16 v[228:231], a[112:115], a[64:67], v[228:231]
    ds_read_b128 a[136:139], v3 offset:8576
    v_exp_f32 v226, v226
    v_smfmac_f32_16x16x64_bf16 a[228:231], a[248:251], v[40:47], v19
    ds_read_b128 a[128:131], v3 offset:8448
    ds_read_b128 a[152:155], v3 offset:9088
    s_mov_b32 m0, 16896
    s_nop 0
    buffer_load_dwordx4 v10, s[16:19], s32 offen offset:0 nt lds
    v_mfma_f32_16x16x32_bf16 v[160:163], v[44:47], a[160:163], 0
    ds_read_b128 a[144:147], v3 offset:8960
    v_exp_f32 v230, v230
    v_mfma_f32_16x16x32_bf16 v[164:167], v[44:47], a[164:167], 0
    ds_read_b128 a[132:135], v3 offset:8512
    ds_read_b128 a[140:143], v3 offset:8640
    v_exp_f32 v228, v228
    v_mfma_f32_16x16x32_bf16 v[168:171], v[44:47], a[168:171], 0
    ds_read_b64_tr_b16 a[198:199], v4 offset:42768
    v_exp_f32 v227, v227
    v_mfma_f32_16x16x32_bf16 v[172:175], v[44:47], a[172:175], 0
    ds_read_b64_tr_b16 a[196:197], v4 offset:42256
    s_mov_b32 m0, 16928
    s_nop 0
    buffer_load_dwordx4 v10, s[16:19], s32 offen offset:1024 nt lds
    v_mfma_f32_16x16x32_bf16 v[176:179], v[44:47], a[176:179], 0
    s_mov_b32 m0, 16960
    s_nop 0
    buffer_load_dwordx4 v10, s[16:19], s32 offen offset:2048 nt lds
    v_mfma_f32_16x16x32_bf16 v[180:183], v[44:47], a[180:183], 0
    ds_read_b64_tr_b16 a[200:201], v4 offset:42272
    v_exp_f32 v231, v231
    v_mfma_f32_16x16x32_bf16 v[184:187], v[44:47], a[184:187], 0
    ds_read_b128 a[148:151], v3 offset:9024
    ds_read_b64_tr_b16 a[206:207], v4 offset:42800
    v_exp_f32 v229, v229
    v_mfma_f32_16x16x32_bf16 v[188:191], v[44:47], a[188:191], 0
    s_waitcnt lgkmcnt(9)
    ds_read_b128 a[156:159], v3 offset:9152
    ds_read_b64_tr_b16 a[212:213], v4 offset:42320
    s_mov_b32 m0, 16992
    s_nop 0
    buffer_load_dwordx4 v10, s[16:19], s32 offen offset:3072 nt lds
    v_cvt_pk_bf16_f32 v233, v226, v227
    v_mfma_f32_16x16x32_bf16 v[48:51], a[128:131], a[0:3], 0
    s_waitcnt lgkmcnt(8)
    s_mov_b32 m0, 21120
    s_nop 0
    buffer_load_dwordx4 v10, s[16:19], s33 offen offset:0 nt lds
    v_mfma_f32_16x16x32_bf16 v[48:51], a[132:135], a[4:7], v[48:51]
    s_mov_b32 m0, 21152
    s_nop 0
    buffer_load_dwordx4 v10, s[16:19], s33 offen offset:1024 nt lds
    s_mov_b32 m0, 21184
    s_nop 0
    buffer_load_dwordx4 v10, s[16:19], s33 offen offset:2048 nt lds
    v_mfma_f32_16x16x32_bf16 v[48:51], a[136:139], a[8:11], v[48:51]
    s_waitcnt lgkmcnt(7)
    ds_read_b64_tr_b16 a[194:195], v4 offset:42752
    v_exp_f32 v225, v225
    v_mfma_f32_16x16x32_bf16 v[48:51], a[140:143], a[12:15], v[48:51]
    s_waitcnt lgkmcnt(2)
    s_mov_b32 m0, 21216
    s_nop 0
    buffer_load_dwordx4 v10, s[16:19], s33 offen offset:3072 nt lds
    v_mfma_f32_16x16x32_bf16 v[52:55], a[156:159], a[12:15], 0
    ds_read_b64_tr_b16 a[214:215], v4 offset:42832
    v_cvt_pk_bf16_f32 v235, v230, v231
    v_mfma_f32_16x16x32_bf16 v[52:55], a[152:155], a[8:11], v[52:55]
    ds_read_b64_tr_b16 a[204:205], v4 offset:42288
    v_cvt_pk_bf16_f32 v232, v224, v225
    v_cvt_pk_bf16_f32 v234, v228, v229
    v_mfma_f32_16x16x32_bf16 v[52:55], a[148:151], a[4:7], v[52:55]
    s_mov_b32 m0, 50688
    s_nop 0
    buffer_load_dwordx4 v10, s[20:23], s32 offen offset:0 nt lds
    v_mfma_f32_16x16x32_bf16 v[52:55], a[144:147], a[0:3], v[52:55]
    ds_read_b64_tr_b16 a[192:193], v4 offset:42240
    v_exp_f32 v48, v48
    v_smfmac_f32_16x16x64_bf16 a[232:235], a[248:251], v[232:239], v19
    ds_read_b64_tr_b16 a[222:223], v4 offset:42864
    v_exp_f32 v50, v50
    v_mfma_f32_16x16x32_bf16 v[192:195], v[232:235], a[160:163], 0
    ds_read_b64_tr_b16 a[218:219], v4 offset:42848
    v_exp_f32 v53, v53
    v_mfma_f32_16x16x32_bf16 v[196:199], v[232:235], a[164:167], 0
    v_exp_f32 v52, v52
    v_mfma_f32_16x16x32_bf16 v[200:203], v[232:235], a[168:171], 0
    s_mov_b32 m0, 50704
    s_nop 0
    buffer_load_dwordx4 v10, s[20:23], s32 offen offset:1024 nt lds
    v_cvt_pk_bf16_f32 v42, v52, v53
    v_mfma_f32_16x16x32_bf16 v[204:207], v[232:235], a[172:175], 0
    v_exp_f32 v55, v55
    v_mfma_f32_16x16x32_bf16 v[208:211], v[232:235], a[176:179], 0
    v_exp_f32 v49, v49
    v_mfma_f32_16x16x32_bf16 v[212:215], v[232:235], a[180:183], 0
    s_mov_b32 m0, 50720
    s_nop 0
    buffer_load_dwordx4 v10, s[20:23], s32 offen offset:2048 nt lds
    v_mfma_f32_16x16x32_bf16 v[216:219], v[232:235], a[184:187], 0
    s_mov_b32 m0, 50736
    s_nop 0
    buffer_load_dwordx4 v10, s[20:23], s32 offen offset:3072 nt lds
    v_mfma_f32_16x16x32_bf16 v[220:223], v[232:235], a[188:191], 0
    s_mov_b32 m0, 54848
    s_nop 0
    buffer_load_dwordx4 v10, s[20:23], s33 offen offset:0 nt lds
    v_mfma_f32_16x16x32_bf16 v[56:59], a[128:131], a[16:19], 0
    v_exp_f32 v51, v51
    v_mfma_f32_16x16x32_bf16 v[56:59], a[132:135], a[20:23], v[56:59]
    v_exp_f32 v54, v54
    v_mfma_f32_16x16x32_bf16 v[56:59], a[136:139], a[24:27], v[56:59]
    s_mov_b32 m0, 54864
    s_nop 0
    buffer_load_dwordx4 v10, s[20:23], s33 offen offset:1024 nt lds
    v_mfma_f32_16x16x32_bf16 v[56:59], a[140:143], a[28:31], v[56:59]
    ds_read_b64_tr_b16 a[208:209], v4 offset:42304
    v_cvt_pk_bf16_f32 v43, v54, v55
    v_mfma_f32_16x16x32_bf16 v[60:63], a[156:159], a[28:31], 0
    ds_read_b64_tr_b16 a[220:221], v4 offset:42352
    v_cvt_pk_bf16_f32 v41, v50, v51
    v_mfma_f32_16x16x32_bf16 v[60:63], a[152:155], a[24:27], v[60:63]
    ds_read_b64_tr_b16 a[216:217], v4 offset:42336
    v_cvt_pk_bf16_f32 v40, v48, v49
    v_mfma_f32_16x16x32_bf16 v[60:63], a[148:151], a[20:23], v[60:63]
    v_exp_f32 v57, v57
    v_mfma_f32_16x16x32_bf16 v[60:63], a[144:147], a[16:19], v[60:63]
    s_waitcnt lgkmcnt(5)
    v_exp_f32 v56, v56
    v_mfma_f32_16x16x32_bf16 v[64:67], v[40:43], a[192:195], v[64:67]
    s_mov_b32 m0, 54880
    s_nop 0
    buffer_load_dwordx4 v10, s[20:23], s33 offen offset:2048 nt lds
    v_mfma_f32_16x16x32_bf16 v[68:71], v[40:43], a[196:199], v[68:71]
    v_exp_f32 v63, v63
    v_mfma_f32_16x16x32_bf16 v[72:75], v[40:43], a[200:203], v[72:75]
    v_exp_f32 v62, v62
    v_mfma_f32_16x16x32_bf16 v[76:79], v[40:43], a[204:207], v[76:79]
    s_waitcnt lgkmcnt(2)
    s_mov_b32 m0, 54896
    s_nop 0
    buffer_load_dwordx4 v10, s[20:23], s33 offen offset:3072 nt lds
    v_exp_f32 v61, v61
    v_mfma_f32_16x16x32_bf16 v[80:83], v[40:43], a[208:211], v[80:83]
    v_exp_f32 v59, v59
    v_mfma_f32_16x16x32_bf16 v[84:87], v[40:43], a[212:215], v[84:87]
    s_waitcnt lgkmcnt(0)
    v_exp_f32 v58, v58
    v_mfma_f32_16x16x32_bf16 v[88:91], v[40:43], a[216:219], v[88:91]
    v_exp_f32 v60, v60
    v_cvt_pk_bf16_f32 v47, v62, v63
    v_mfma_f32_16x16x32_bf16 v[92:95], v[40:43], a[220:223], v[92:95]
    s_add_u32 s32, s32, 8192
    v_cvt_pk_bf16_f32 v44, v56, v57
    v_cvt_pk_bf16_f32 v45, v58, v59
    v_mfma_f32_16x16x32_bf16 v[48:51], a[128:131], a[32:35], 0
    s_add_u32 s33, s32, 4096
    s_mov_b32 m0, 25344
    s_nop 0
    buffer_load_dwordx4 v10, s[16:19], s32 offen offset:0 nt lds
    s_mov_b32 m0, 25376
    s_nop 0
    buffer_load_dwordx4 v10, s[16:19], s32 offen offset:1024 nt lds
    v_mfma_f32_16x16x32_bf16 v[48:51], a[132:135], a[36:39], v[48:51]
    s_mov_b32 m0, 25408
    s_nop 0
    buffer_load_dwordx4 v10, s[16:19], s32 offen offset:2048 nt lds
    s_mov_b32 m0, 25440
    s_nop 0
    buffer_load_dwordx4 v10, s[16:19], s32 offen offset:3072 nt lds
    s_mov_b32 m0, 29568
    s_nop 0
    buffer_load_dwordx4 v10, s[16:19], s33 offen offset:0 nt lds
    v_mfma_f32_16x16x32_bf16 v[48:51], a[136:139], a[40:43], v[48:51]
    s_mov_b32 m0, 29600
    s_nop 0
    buffer_load_dwordx4 v10, s[16:19], s33 offen offset:1024 nt lds
    s_mov_b32 m0, 29632
    s_nop 0
    buffer_load_dwordx4 v10, s[16:19], s33 offen offset:2048 nt lds
    s_mov_b32 m0, 29664
    s_nop 0
    buffer_load_dwordx4 v10, s[16:19], s33 offen offset:3072 nt lds
    v_mfma_f32_16x16x32_bf16 v[48:51], a[140:143], a[44:47], v[48:51]
    s_mov_b32 m0, 59136
    s_nop 0
    buffer_load_dwordx4 v10, s[20:23], s32 offen offset:0 nt lds
    s_mov_b32 m0, 59152
    s_nop 0
    buffer_load_dwordx4 v10, s[20:23], s32 offen offset:1024 nt lds
    v_cvt_pk_bf16_f32 v46, v60, v61
    v_mfma_f32_16x16x32_bf16 v[52:55], a[156:159], a[44:47], 0
    s_mov_b32 m0, 59168
    s_nop 0
    buffer_load_dwordx4 v10, s[20:23], s32 offen offset:2048 nt lds
    s_mov_b32 m0, 59184
    s_nop 0
    buffer_load_dwordx4 v10, s[20:23], s32 offen offset:3072 nt lds
    s_mov_b32 m0, 63296
    s_nop 0
    buffer_load_dwordx4 v10, s[20:23], s33 offen offset:0 nt lds
    s_mov_b32 m0, 63312
    s_nop 0
    buffer_load_dwordx4 v10, s[20:23], s33 offen offset:1024 nt lds
    v_mfma_f32_16x16x32_bf16 v[52:55], a[152:155], a[40:43], v[52:55]
    s_mov_b32 m0, 63328
    s_nop 0
    buffer_load_dwordx4 v10, s[20:23], s33 offen offset:2048 nt lds
    s_mov_b32 m0, 63344
    s_nop 0
    buffer_load_dwordx4 v10, s[20:23], s33 offen offset:3072 nt lds
    v_mfma_f32_16x16x32_bf16 v[52:55], a[148:151], a[36:39], v[52:55]
    s_add_u32 s45, s45, 1024
    s_cmp_lt_u32 s45, 24576
    s_cselect_b32 s34, s45, 94208
    s_lshr_b32 s39, s45, 4
    s_and_b32 s39, s39, 0xc0
    v_xor_b32 v0, s39, v11
    s_add_u32 m0, s34, 67584
    s_add_u32 s46, s34, 94208
    buffer_load_dwordx4 v0, s[12:15], s46 offen nt lds
    s_add_u32 m0, s34, 92160
    s_add_u32 s46, s34, 118784
    buffer_load_dwordx4 v0, s[12:15], s46 offen nt lds
    v_mfma_f32_16x16x32_bf16 v[52:55], a[144:147], a[32:35], v[52:55]
    s_add_u32 s32, s32, 8192
    s_add_u32 s33, s32, 4096
    s_add_u32 m0, s34, 116736
    s_add_u32 s46, s34, 143360
    buffer_load_dwordx4 v0, s[12:15], s46 offen nt lds
    s_add_u32 m0, s34, 141312
    s_add_u32 s46, s34, 167936
    buffer_load_dwordx4 v0, s[12:15], s46 offen nt lds
    s_add_u32 m0, s30, 0
    s_nop 0
    buffer_load_dwordx4 v10, s[16:19], s32 offen offset:0 nt lds
    s_add_u32 m0, s30, 32
    s_nop 0
    buffer_load_dwordx4 v10, s[16:19], s32 offen offset:1024 nt lds
    s_add_u32 m0, s30, 64
    s_nop 0
    buffer_load_dwordx4 v10, s[16:19], s32 offen offset:2048 nt lds
    s_add_u32 m0, s30, 96
    s_nop 0
    buffer_load_dwordx4 v10, s[16:19], s32 offen offset:3072 nt lds
    s_add_u32 m0, s30, 4224
    s_nop 0
    buffer_load_dwordx4 v10, s[16:19], s33 offen offset:0 nt lds
    s_add_u32 m0, s30, 4256
    s_nop 0
    buffer_load_dwordx4 v10, s[16:19], s33 offen offset:1024 nt lds
    s_add_u32 m0, s30, 4288
    s_nop 0
    buffer_load_dwordx4 v10, s[16:19], s33 offen offset:2048 nt lds
    s_add_u32 m0, s30, 4320
    s_nop 0
    buffer_load_dwordx4 v10, s[16:19], s33 offen offset:3072 nt lds
    s_add_u32 m0, s30, 33792
    s_nop 0
    buffer_load_dwordx4 v10, s[20:23], s32 offen offset:0 nt lds
    s_add_u32 m0, s30, 33808
    s_nop 0
    buffer_load_dwordx4 v10, s[20:23], s32 offen offset:1024 nt lds
    s_add_u32 m0, s30, 33824
    s_nop 0
    buffer_load_dwordx4 v10, s[20:23], s32 offen offset:2048 nt lds
    s_add_u32 m0, s30, 33840
    s_nop 0
    buffer_load_dwordx4 v10, s[20:23], s32 offen offset:3072 nt lds
    s_add_u32 m0, s30, 37952
    s_nop 0
    buffer_load_dwordx4 v10, s[20:23], s33 offen offset:0 nt lds
    s_add_u32 m0, s30, 37968
    s_nop 0
    buffer_load_dwordx4 v10, s[20:23], s33 offen offset:1024 nt lds
    s_add_u32 m0, s30, 37984
    s_nop 0
    buffer_load_dwordx4 v10, s[20:23], s33 offen offset:2048 nt lds
    s_add_u32 m0, s30, 38000
    s_nop 0
    buffer_load_dwordx4 v10, s[20:23], s33 offen offset:3072 nt lds
    s_waitcnt vmcnt(36)
.p2align 5
L_B1:
    v_smfmac_f32_16x16x64_bf16 a[224:227], a[248:251], v[40:47], v19
    s_mov_b32 s31, s30
    s_waitcnt vmcnt(40)
    v_exp_f32 v48, v48
    v_mfma_f32_16x16x32_bf16 v[96:99], v[44:47], a[192:195], v[96:99]
    s_barrier
    v_mfma_f32_16x16x32_bf16 v[100:103], v[44:47], a[196:199], v[100:103]
    s_xor_b32 s30, s30, 16896
    v_exp_f32 v55, v55
    v_add_u32 v3, s30, v1
    v_add_u32 v4, s30, v2
    v_mfma_f32_16x16x32_bf16 v[104:107], v[44:47], a[200:203], v[104:107]
    s_add_u32 s45, s45, 1024
    v_exp_f32 v53, v53
    v_mfma_f32_16x16x32_bf16 v[108:111], v[44:47], a[204:207], v[108:111]
    s_lshr_b32 s39, s45, 4
    v_exp_f32 v50, v50
    v_mfma_f32_16x16x32_bf16 v[112:115], v[44:47], a[208:211], v[112:115]
    s_and_b32 s39, s39, 0xc0
    ds_read_b128 a[96:99], v3 offset:0
    v_exp_f32 v52, v52
    v_mfma_f32_16x16x32_bf16 v[116:119], v[44:47], a[212:215], v[116:119]
    s_cmp_lt_u32 s45, 24576
    s_cselect_b32 s34, s45, 94208
    v_exp_f32 v51, v51
    v_mfma_f32_16x16x32_bf16 v[120:123], v[44:47], a[216:219], v[120:123]
    ds_read_b128 a[100:103], v3 offset:64
    v_xor_b32 v0, s39, v11
    v_mfma_f32_16x16x32_bf16 v[124:127], v[44:47], a[220:223], v[124:127]
    s_add_u32 m0, s34, 67584
    s_add_u32 s46, s34, 94208
    v_cvt_pk_bf16_f32 v41, v50, v51
    v_mfma_f32_16x16x32_bf16 v[56:59], a[128:131], a[48:51], 0
    s_add_u32 s40, s40, 1024
    ds_read_b128 a[104:107], v3 offset:128
    v_cvt_pk_bf16_f32 v42, v52, v53
    buffer_load_dwordx4 v0, s[12:15], s46 offen nt lds
    v_mfma_f32_16x16x32_bf16 v[56:59], a[132:135], a[52:55], v[56:59]
    v_exp_f32 v54, v54
    v_mfma_f32_16x16x32_bf16 v[56:59], a[136:139], a[56:59], v[56:59]
    s_add_u32 m0, s34, 92160
    s_add_u32 s46, s34, 118784
    ds_read_b128 a[108:111], v3 offset:192
    v_cvt_pk_bf16_f32 v43, v54, v55
    v_mfma_f32_16x16x32_bf16 v[56:59], a[140:143], a[60:63], v[56:59]
    s_cmp_lt_u32 s40, s44
    s_cselect_b32 s41, s40, 94208
    buffer_load_dwordx4 v0, s[12:15], s46 offen nt lds
    v_mfma_f32_16x16x32_bf16 v[60:63], a[156:159], a[60:63], 0
    s_add_u32 s41, s41, s43
    ds_read_b128 a[124:127], v3 offset:704
    v_add_u32 v9, s41, v20
    v_mfma_f32_16x16x32_bf16 v[60:63], a[152:155], a[56:59], v[60:63]
    s_add_u32 m0, s34, 116736
    s_add_u32 s46, s34, 143360
    v_exp_f32 v49, v49
    v_mfma_f32_16x16x32_bf16 v[60:63], a[148:151], a[52:55], v[60:63]
    s_add_u32 s32, s32, 8192
    ds_read2st64_b32 v[26:27], v9 offset0:2 offset1:3
    v_cvt_pk_bf16_f32 v40, v48, v49
    v_mfma_f32_16x16x32_bf16 v[60:63], a[144:147], a[48:51], v[60:63]
    buffer_load_dwordx4 v0, s[12:15], s46 offen nt lds
    v_mfma_f32_16x16x32_bf16 v[128:131], v[40:43], a[192:195], v[128:131]
    s_add_u32 m0, s34, 141312
    s_add_u32 s46, s34, 167936
    ds_read_b128 a[120:123], v3 offset:640
    v_exp_f32 v59, v59
    v_mfma_f32_16x16x32_bf16 v[132:135], v[40:43], a[196:199], v[132:135]
    buffer_load_dwordx4 v0, s[12:15], s46 offen nt lds
    v_mfma_f32_16x16x32_bf16 v[136:139], v[40:43], a[200:203], v[136:139]
    ds_read_b128 a[116:119], v3 offset:576
    v_exp_f32 v61, v61
    v_mfma_f32_16x16x32_bf16 v[140:143], v[40:43], a[204:207], v[140:143]
    s_add_u32 s33, s32, 4096
    v_exp_f32 v56, v56
    v_mfma_f32_16x16x32_bf16 v[144:147], v[40:43], a[208:211], v[144:147]
    s_add_u32 m0, s31, 8448
    ds_read_b128 a[112:115], v3 offset:512
    v_exp_f32 v60, v60
    v_mfma_f32_16x16x32_bf16 v[148:151], v[40:43], a[212:215], v[148:151]
    buffer_load_dwordx4 v10, s[16:19], s32 offen offset:0 nt lds
    v_mfma_f32_16x16x32_bf16 v[152:155], v[40:43], a[216:219], v[152:155]
    s_add_u32 m0, s31, 8480
    v_exp_f32 v62, v62
    v_mfma_f32_16x16x32_bf16 v[156:159], v[40:43], a[220:223], v[156:159]
    ds_read_b64_tr_b16 a[160:161], v4 offset:33792
    buffer_load_dwordx4 v10, s[16:19], s32 offen offset:1024 nt lds
    v_mfma_f32_16x16x32_bf16 v[224:227], a[128:131], a[64:67], 0
    s_add_u32 m0, s31, 8512
    v_exp_f32 v57, v57
    v_mfma_f32_16x16x32_bf16 v[224:227], a[132:135], a[68:71], v[224:227]
    v_exp_f32 v63, v63
    v_mfma_f32_16x16x32_bf16 v[224:227], a[136:139], a[72:75], v[224:227]
    ds_read_b64_tr_b16 a[162:163], v4 offset:34304
    buffer_load_dwordx4 v10, s[16:19], s32 offen offset:2048 nt lds
    v_mfma_f32_16x16x32_bf16 v[224:227], a[140:143], a[76:79], v[224:227]
    s_add_u32 m0, s31, 8544
    v_exp_f32 v58, v58
    v_cvt_pk_bf16_f32 v47, v62, v63
    v_mfma_f32_16x16x32_bf16 v[228:231], a[156:159], a[76:79], 0
    buffer_load_dwordx4 v10, s[16:19], s32 offen offset:3072 nt lds
    v_mfma_f32_16x16x32_bf16 v[228:231], a[152:155], a[72:75], v[228:231]
    s_waitcnt lgkmcnt(5)
    ds_read2st64_b32 v[24:25], v9 offset0:0 offset1:1
    v_cvt_pk_bf16_f32 v45, v58, v59
    v_lshlrev_b32 v31, 16, v27
    v_mfma_f32_16x16x32_bf16 v[228:231], a[148:151], a[68:71], v[228:231]
    s_add_u32 m0, s31, 12672
    ds_read_b64_tr_b16 a[164:165], v4 offset:33808
    v_cvt_pk_bf16_f32 v44, v56, v57
    v_cvt_pk_bf16_f32 v46, v60, v61
    v_mfma_f32_16x16x32_bf16 v[228:231], a[144:147], a[64:67], v[228:231]
    buffer_load_dwordx4 v10, s[16:19], s33 offen offset:0 nt lds
    v_lshlrev_b32 v30, 16, v26
    v_smfmac_f32_16x16x64_bf16 a[228:231], a[248:251], v[40:47], v19
    ds_read_b64_tr_b16 a[166:167], v4 offset:34320
    v_mul_f32 v31, s35, v31
    v_mfma_f32_16x16x32_bf16 v[160:163], v[44:47], a[192:195], v[160:163]
    v_exp_f32 v224, v224
    v_mfma_f32_16x16x32_bf16 v[164:167], v[44:47], a[196:199], v[164:167]
    ds_read_b64_tr_b16 a[168:169], v4 offset:33824
    v_exp_f32 v227, v227
    v_mfma_f32_16x16x32_bf16 v[168:171], v[44:47], a[200:203], v[168:171]
    v_exp_f32 v226, v226
    v_mfma_f32_16x16x32_bf16 v[172:175], v[44:47], a[204:207], v[172:175]
    s_add_u32 m0, s31, 12704
    v_exp_f32 v229, v229
    v_mfma_f32_16x16x32_bf16 v[176:179], v[44:47], a[208:211], v[176:179]
    s_waitcnt lgkmcnt(3)
    ds_read_b64_tr_b16 a[170:171], v4 offset:34336
    v_cvt_pk_bf16_f32 v233, v226, v227
    v_mfma_f32_16x16x32_bf16 v[180:183], v[44:47], a[212:215], v[180:183]
    buffer_load_dwordx4 v10, s[16:19], s33 offen offset:1024 nt lds
    v_mfma_f32_16x16x32_bf16 v[184:187], v[44:47], a[216:219], v[184:187]
    s_add_u32 m0, s31, 12736
    ds_read_b64_tr_b16 a[172:173], v4 offset:33840
    v_and_b32 v26, s36, v26
    v_mfma_f32_16x16x32_bf16 v[188:191], v[44:47], a[220:223], v[188:191]
    v_exp_f32 v225, v225
    v_mfma_f32_16x16x32_bf16 v[48:51], a[96:99], a[0:3], 0
    v_lshlrev_b32 v28, 16, v24
    v_mul_f32 v30, s35, v30
    v_mfma_f32_16x16x32_bf16 v[48:51], a[100:103], a[4:7], v[48:51]
    buffer_load_dwordx4 v10, s[16:19], s33 offen offset:2048 nt lds
    v_mfma_f32_16x16x32_bf16 v[48:51], a[104:107], a[8:11], v[48:51]
    v_and_b32 v24, s36, v24
    v_exp_f32 v228, v228
    v_mfma_f32_16x16x32_bf16 v[48:51], a[108:111], a[12:15], v[48:51]
    ds_read_b64_tr_b16 a[174:175], v4 offset:34352
    v_cvt_pk_bf16_f32 v234, v228, v229
    v_mfma_f32_16x16x32_bf16 v[52:55], a[124:127], a[12:15], 0
    v_exp_f32 v230, v230
    v_mfma_f32_16x16x32_bf16 v[52:55], a[120:123], a[8:11], v[52:55]
    ds_read_b64_tr_b16 a[176:177], v4 offset:33856
    v_exp_f32 v231, v231
    v_mfma_f32_16x16x32_bf16 v[52:55], a[116:119], a[4:7], v[52:55]
    v_mul_f32 v26, s35, v26
    v_cvt_pk_bf16_f32 v232, v224, v225
    v_cvt_pk_bf16_f32 v235, v230, v231
    v_mfma_f32_16x16x32_bf16 v[52:55], a[112:115], a[0:3], v[52:55]
    s_add_u32 m0, s31, 12768
    v_exp_f32 v51, v51
    v_smfmac_f32_16x16x64_bf16 a[232:235], a[248:251], v[232:239], v19
    ds_read_b64_tr_b16 a[178:179], v4 offset:34368
    v_and_b32 v27, s36, v27
    v_mfma_f32_16x16x32_bf16 v[192:195], v[232:235], a[192:195], v[192:195]
    v_exp_f32 v49, v49
    v_mfma_f32_16x16x32_bf16 v[196:199], v[232:235], a[196:199], v[196:199]
    ds_read_b64_tr_b16 a[180:181], v4 offset:33872
    buffer_load_dwordx4 v10, s[16:19], s33 offen offset:3072 nt lds
    v_exp_f32 v54, v54
    v_mfma_f32_16x16x32_bf16 v[200:203], v[232:235], a[200:203], v[200:203]
    s_add_u32 m0, s31, 42240
    v_exp_f32 v48, v48
    v_mfma_f32_16x16x32_bf16 v[204:207], v[232:235], a[204:207], v[204:207]
    v_lshlrev_b32 v29, 16, v25
    v_exp_f32 v50, v50
    v_mfma_f32_16x16x32_bf16 v[208:211], v[232:235], a[208:211], v[208:211]
    ds_read_b64_tr_b16 a[182:183], v4 offset:34384
    buffer_load_dwordx4 v10, s[20:23], s32 offen offset:0 nt lds
    v_mfma_f32_16x16x32_bf16 v[212:215], v[232:235], a[212:215], v[212:215]
    s_add_u32 m0, s31, 42256
    v_exp_f32 v55, v55
    v_mfma_f32_16x16x32_bf16 v[216:219], v[232:235], a[216:219], v[216:219]
    buffer_load_dwordx4 v10, s[20:23], s32 offen offset:1024 nt lds
    v_mfma_f32_16x16x32_bf16 v[220:223], v[232:235], a[220:223], v[220:223]
    s_add_u32 m0, s31, 42272
    v_mul_f32 v27, s35, v27
    v_cvt_pk_bf16_f32 v40, v48, v49
    v_mfma_f32_16x16x32_bf16 v[56:59], a[96:99], a[16:19], 0
    ds_read_b64_tr_b16 a[184:185], v4 offset:33888
    buffer_load_dwordx4 v10, s[20:23], s32 offen offset:2048 nt lds
    v_exp_f32 v53, v53
    v_mfma_f32_16x16x32_bf16 v[56:59], a[100:103], a[20:23], v[56:59]
    v_mul_f32 v28, s35, v28
    v_and_b32 v25, s36, v25
    v_exp_f32 v52, v52
    v_mfma_f32_16x16x32_bf16 v[56:59], a[104:107], a[24:27], v[56:59]
    s_add_u32 m0, s31, 42288
    v_mul_f32 v24, s35, v24
    v_mul_f32 v29, s35, v29
    v_cvt_pk_bf16_f32 v41, v50, v51
    v_mfma_f32_16x16x32_bf16 v[56:59], a[108:111], a[28:31], v[56:59]
    buffer_load_dwordx4 v10, s[20:23], s32 offen offset:3072 nt lds
    v_mfma_f32_16x16x32_bf16 v[60:63], a[124:127], a[28:31], 0
    s_add_u32 m0, s31, 46400
    ds_read_b64_tr_b16 a[186:187], v4 offset:34400
    v_cvt_pk_bf16_f32 v42, v52, v53
    v_mfma_f32_16x16x32_bf16 v[60:63], a[120:123], a[24:27], v[60:63]
    buffer_load_dwordx4 v10, s[20:23], s33 offen offset:0 nt lds
    v_mfma_f32_16x16x32_bf16 v[60:63], a[116:119], a[20:23], v[60:63]
    s_add_u32 m0, s31, 46416
    ds_read_b64_tr_b16 a[188:189], v4 offset:33904
    v_cvt_pk_bf16_f32 v43, v54, v55
    v_mfma_f32_16x16x32_bf16 v[60:63], a[112:115], a[16:19], v[60:63]
    buffer_load_dwordx4 v10, s[20:23], s33 offen offset:1024 nt lds
    v_mfma_f32_16x16x32_bf16 v[64:67], v[40:43], a[160:163], v[64:67]
    s_waitcnt lgkmcnt(11)
    v_mul_f32 v25, s35, v25
    v_exp_f32 v56, v56
    v_mfma_f32_16x16x32_bf16 v[68:71], v[40:43], a[164:167], v[68:71]
    s_waitcnt lgkmcnt(9)
    v_exp_f32 v57, v57
    v_mfma_f32_16x16x32_bf16 v[72:75], v[40:43], a[168:171], v[72:75]
    s_waitcnt lgkmcnt(7)
    ds_read_b64_tr_b16 a[190:191], v4 offset:34416
    v_cvt_pk_bf16_f32 v25, v29, v25
    v_cvt_pk_bf16_f32 v44, v56, v57
    v_mfma_f32_16x16x32_bf16 v[76:79], v[40:43], a[172:175], v[76:79]
    s_waitcnt lgkmcnt(6)
    v_exp_f32 v59, v59
    v_mfma_f32_16x16x32_bf16 v[80:83], v[40:43], a[176:179], v[80:83]
    s_waitcnt lgkmcnt(4)
    ds_write_b32 v9, v25 offset:256
    v_cvt_pk_bf16_f32 v26, v30, v26
    v_cvt_pk_bf16_f32 v27, v31, v27
    v_exp_f32 v60, v60
    v_mfma_f32_16x16x32_bf16 v[84:87], v[40:43], a[180:183], v[84:87]
    s_waitcnt lgkmcnt(3)
    v_exp_f32 v58, v58
    v_mfma_f32_16x16x32_bf16 v[88:91], v[40:43], a[184:187], v[88:91]
    s_waitcnt lgkmcnt(1)
    ds_write_b32 v9, v27 offset:768
    v_mfma_f32_16x16x32_bf16 v[92:95], v[40:43], a[188:191], v[92:95]
    s_add_u32 m0, s31, 46432
    v_exp_f32 v63, v63
    v_mfma_f32_16x16x32_bf16 v[48:51], a[96:99], a[32:35], 0
    buffer_load_dwordx4 v10, s[20:23], s33 offen offset:2048 nt lds
    v_cvt_pk_bf16_f32 v45, v58, v59
    v_mfma_f32_16x16x32_bf16 v[48:51], a[100:103], a[36:39], v[48:51]
    s_add_u32 m0, s31, 46448
    v_exp_f32 v62, v62
    v_mfma_f32_16x16x32_bf16 v[48:51], a[104:107], a[40:43], v[48:51]
    ds_write_b32 v9, v26 offset:512
    v_mfma_f32_16x16x32_bf16 v[48:51], a[108:111], a[44:47], v[48:51]
    buffer_load_dwordx4 v10, s[20:23], s33 offen offset:3072 nt lds
    v_mfma_f32_16x16x32_bf16 v[52:55], a[124:127], a[44:47], 0
    s_add_u32 s45, s45, 1024
    v_exp_f32 v61, v61
    v_mfma_f32_16x16x32_bf16 v[52:55], a[120:123], a[40:43], v[52:55]
    v_exp_f32 v50, v50
    v_mfma_f32_16x16x32_bf16 v[52:55], a[116:119], a[36:39], v[52:55]
    s_lshr_b32 s39, s45, 4
    v_cvt_pk_bf16_f32 v24, v28, v24
    v_cvt_pk_bf16_f32 v46, v60, v61
    v_cvt_pk_bf16_f32 v47, v62, v63
    v_mfma_f32_16x16x32_bf16 v[52:55], a[112:115], a[32:35], v[52:55]
    s_cmp_lt_u32 s45, 24576
    s_cselect_b32 s34, s45, 94208
    ds_write_b32 v9, v24 offset:0
    v_smfmac_f32_16x16x64_bf16 a[224:227], a[248:251], v[40:47], v19
    s_waitcnt vmcnt(40)
    s_and_b32 s39, s39, 0xc0
    v_xor_b32 v0, s39, v11
    v_mfma_f32_16x16x32_bf16 v[96:99], v[44:47], a[160:163], v[96:99]
    s_barrier
    v_mfma_f32_16x16x32_bf16 v[100:103], v[44:47], a[164:167], v[100:103]
    s_add_u32 s40, s40, 1024
    ds_read_b128 a[128:131], v3 offset:8448
    v_exp_f32 v51, v51
    v_mfma_f32_16x16x32_bf16 v[104:107], v[44:47], a[168:171], v[104:107]
    s_add_u32 m0, s34, 67584
    s_add_u32 s46, s34, 94208
    v_exp_f32 v48, v48
    v_mfma_f32_16x16x32_bf16 v[108:111], v[44:47], a[172:175], v[108:111]
    ds_read_b128 a[132:135], v3 offset:8512
    buffer_load_dwordx4 v0, s[12:15], s46 offen nt lds
    v_mfma_f32_16x16x32_bf16 v[112:115], v[44:47], a[176:179], v[112:115]
    s_add_u32 m0, s34, 92160
    s_add_u32 s46, s34, 118784
    v_exp_f32 v54, v54
    v_mfma_f32_16x16x32_bf16 v[116:119], v[44:47], a[180:183], v[116:119]
    s_cmp_lt_u32 s40, s44
    s_cselect_b32 s41, s40, 94208
    buffer_load_dwordx4 v0, s[12:15], s46 offen nt lds
    v_mfma_f32_16x16x32_bf16 v[120:123], v[44:47], a[184:187], v[120:123]
    s_add_u32 s32, s32, 8192
    ds_read_b128 a[136:139], v3 offset:8576
    v_exp_f32 v55, v55
    v_mfma_f32_16x16x32_bf16 v[124:127], v[44:47], a[188:191], v[124:127]
    s_add_u32 m0, s34, 116736
    s_add_u32 s46, s34, 143360
    v_exp_f32 v52, v52
    v_cvt_pk_bf16_f32 v43, v54, v55
    v_mfma_f32_16x16x32_bf16 v[56:59], a[96:99], a[48:51], 0
    s_add_u32 s41, s41, s43
    ds_read_b128 a[140:143], v3 offset:8640
    v_exp_f32 v49, v49
    v_mfma_f32_16x16x32_bf16 v[56:59], a[100:103], a[52:55], v[56:59]
    v_cvt_pk_bf16_f32 v41, v50, v51
    v_add_u32 v9, s41, v20
    v_mfma_f32_16x16x32_bf16 v[56:59], a[104:107], a[56:59], v[56:59]
    s_add_u32 s33, s32, 4096
    ds_read_b128 a[156:159], v3 offset:9152
    buffer_load_dwordx4 v0, s[12:15], s46 offen nt lds
    v_mfma_f32_16x16x32_bf16 v[56:59], a[108:111], a[60:63], v[56:59]
    s_add_u32 m0, s34, 141312
    s_add_u32 s46, s34, 167936
    v_cvt_pk_bf16_f32 v40, v48, v49
    v_mfma_f32_16x16x32_bf16 v[60:63], a[124:127], a[60:63], 0
    v_exp_f32 v53, v53
    v_mfma_f32_16x16x32_bf16 v[60:63], a[120:123], a[56:59], v[60:63]
    ds_read_b128 a[152:155], v3 offset:9088
    ds_read2st64_b32 v[24:25], v9 offset0:0 offset1:1
    v_cvt_pk_bf16_f32 v42, v52, v53
    v_mfma_f32_16x16x32_bf16 v[60:63], a[116:119], a[52:55], v[60:63]
    ds_read2st64_b32 v[26:27], v9 offset0:2 offset1:3
    buffer_load_dwordx4 v0, s[12:15], s46 offen nt lds
    v_mfma_f32_16x16x32_bf16 v[60:63], a[112:115], a[48:51], v[60:63]
    s_add_u32 m0, s30, 0
    v_exp_f32 v56, v56
    v_mfma_f32_16x16x32_bf16 v[128:131], v[40:43], a[160:163], v[128:131]
    buffer_load_dwordx4 v10, s[16:19], s32 offen offset:0 nt lds
    v_mfma_f32_16x16x32_bf16 v[132:135], v[40:43], a[164:167], v[132:135]
    ds_read_b128 a[148:151], v3 offset:9024
    v_exp_f32 v59, v59
    v_mfma_f32_16x16x32_bf16 v[136:139], v[40:43], a[168:171], v[136:139]
    v_exp_f32 v58, v58
    v_mfma_f32_16x16x32_bf16 v[140:143], v[40:43], a[172:175], v[140:143]
    s_add_u32 m0, s30, 32
    v_exp_f32 v60, v60
    v_mfma_f32_16x16x32_bf16 v[144:147], v[40:43], a[176:179], v[144:147]
    v_exp_f32 v61, v61
    v_mfma_f32_16x16x32_bf16 v[148:151], v[40:43], a[180:183], v[148:151]
    buffer_load_dwordx4 v10, s[16:19], s32 offen offset:1024 nt lds
    v_mfma_f32_16x16x32_bf16 v[152:155], v[40:43], a[184:187], v[152:155]
    s_waitcnt lgkmcnt(2)
    ds_read_b128 a[144:147], v3 offset:8960
    v_lshlrev_b32 v29, 16, v25
    v_mfma_f32_16x16x32_bf16 v[156:159], v[40:43], a[188:191], v[156:159]
    s_add_u32 m0, s30, 64
    v_exp_f32 v57, v57
    v_cvt_pk_bf16_f32 v45, v58, v59
    v_and_b32 v25, s36, v25
    v_mfma_f32_16x16x32_bf16 v[224:227], a[96:99], a[64:67], 0
    s_waitcnt lgkmcnt(2)
    ds_read_b64_tr_b16 a[192:193], v4 offset:42240
    v_mul_f32 v25, s35, v25
    v_mfma_f32_16x16x32_bf16 v[224:227], a[100:103], a[68:71], v[224:227]
    v_exp_f32 v63, v63
    v_mul_f32 v29, s35, v29
    v_mfma_f32_16x16x32_bf16 v[224:227], a[104:107], a[72:75], v[224:227]
    ds_read_b64_tr_b16 a[194:195], v4 offset:42752
    v_cvt_pk_bf16_f32 v44, v56, v57
    v_mfma_f32_16x16x32_bf16 v[224:227], a[108:111], a[76:79], v[224:227]
    buffer_load_dwordx4 v10, s[16:19], s32 offen offset:2048 nt lds
    v_mfma_f32_16x16x32_bf16 v[228:231], a[124:127], a[76:79], 0
    s_add_u32 m0, s30, 96
    ds_read_b64_tr_b16 a[196:197], v4 offset:42256
    v_cvt_pk_bf16_f32 v46, v60, v61
    v_lshlrev_b32 v28, 16, v24
    v_mfma_f32_16x16x32_bf16 v[228:231], a[120:123], a[72:75], v[228:231]
    s_add_u32 s29, s29, 2
    v_exp_f32 v62, v62
    v_exp_f32 v224, v224
    v_mfma_f32_16x16x32_bf16 v[228:231], a[116:119], a[68:71], v[228:231]
    ds_read_b64_tr_b16 a[198:199], v4 offset:42768
    v_cvt_pk_bf16_f32 v47, v62, v63
    v_mfma_f32_16x16x32_bf16 v[228:231], a[112:115], a[64:67], v[228:231]
    buffer_load_dwordx4 v10, s[16:19], s32 offen offset:3072 nt lds
    v_smfmac_f32_16x16x64_bf16 a[228:231], a[248:251], v[40:47], v19
    ds_read_b64_tr_b16 a[200:201], v4 offset:42272
    v_lshlrev_b32 v31, 16, v27
    v_mfma_f32_16x16x32_bf16 v[160:163], v[44:47], a[160:163], v[160:163]
    s_add_u32 m0, s30, 4224
    v_lshlrev_b32 v30, 16, v26
    v_exp_f32 v228, v228
    v_mfma_f32_16x16x32_bf16 v[164:167], v[44:47], a[164:167], v[164:167]
    ds_read_b64_tr_b16 a[202:203], v4 offset:42784
    v_exp_f32 v227, v227
    v_exp_f32 v229, v229
    v_mfma_f32_16x16x32_bf16 v[168:171], v[44:47], a[168:171], v[168:171]
    buffer_load_dwordx4 v10, s[16:19], s33 offen offset:0 nt lds
    v_mfma_f32_16x16x32_bf16 v[172:175], v[44:47], a[172:175], v[172:175]
    s_add_u32 m0, s30, 4256
    ds_read_b64_tr_b16 a[204:205], v4 offset:42288
    v_mul_f32 v30, s35, v30
    v_mfma_f32_16x16x32_bf16 v[176:179], v[44:47], a[176:179], v[176:179]
    buffer_load_dwordx4 v10, s[16:19], s33 offen offset:1024 nt lds
    v_cvt_pk_bf16_f32 v234, v228, v229
    v_mfma_f32_16x16x32_bf16 v[180:183], v[44:47], a[180:183], v[180:183]
    s_add_u32 m0, s30, 4288
    ds_read_b64_tr_b16 a[206:207], v4 offset:42800
    v_and_b32 v26, s36, v26
    v_mfma_f32_16x16x32_bf16 v[184:187], v[44:47], a[184:187], v[184:187]
    v_exp_f32 v231, v231
    v_mfma_f32_16x16x32_bf16 v[188:191], v[44:47], a[188:191], v[188:191]
    ds_read_b64_tr_b16 a[208:209], v4 offset:42304
    v_and_b32 v27, s36, v27
    v_mfma_f32_16x16x32_bf16 v[48:51], a[128:131], a[0:3], 0
    buffer_load_dwordx4 v10, s[16:19], s33 offen offset:2048 nt lds
    v_mfma_f32_16x16x32_bf16 v[48:51], a[132:135], a[4:7], v[48:51]
    v_exp_f32 v225, v225
    v_mfma_f32_16x16x32_bf16 v[48:51], a[136:139], a[8:11], v[48:51]
    v_exp_f32 v230, v230
    v_mfma_f32_16x16x32_bf16 v[48:51], a[140:143], a[12:15], v[48:51]
    v_and_b32 v24, s36, v24
    v_cvt_pk_bf16_f32 v235, v230, v231
    v_mfma_f32_16x16x32_bf16 v[52:55], a[156:159], a[12:15], 0
    v_mul_f32 v24, s35, v24
    v_cvt_pk_bf16_f32 v232, v224, v225
    v_mfma_f32_16x16x32_bf16 v[52:55], a[152:155], a[8:11], v[52:55]
    s_waitcnt lgkmcnt(10)
    v_exp_f32 v226, v226
    v_mfma_f32_16x16x32_bf16 v[52:55], a[148:151], a[4:7], v[52:55]
    s_waitcnt lgkmcnt(9)
    v_cvt_pk_bf16_f32 v233, v226, v227
    v_exp_f32 v49, v49
    v_mfma_f32_16x16x32_bf16 v[52:55], a[144:147], a[0:3], v[52:55]
    s_add_u32 m0, s30, 4320
    v_exp_f32 v51, v51
    v_smfmac_f32_16x16x64_bf16 a[232:235], a[248:251], v[232:239], v19
    ds_read_b64_tr_b16 a[210:211], v4 offset:42816
    v_exp_f32 v50, v50
    v_mfma_f32_16x16x32_bf16 v[192:195], v[232:235], a[160:163], v[192:195]
    buffer_load_dwordx4 v10, s[16:19], s33 offen offset:3072 nt lds
    v_mul_f32 v28, s35, v28
    v_mfma_f32_16x16x32_bf16 v[196:199], v[232:235], a[164:167], v[196:199]
    s_add_u32 m0, s30, 33792
    ds_read_b64_tr_b16 a[212:213], v4 offset:42320
    v_mul_f32 v31, s35, v31
    v_mfma_f32_16x16x32_bf16 v[200:203], v[232:235], a[168:171], v[200:203]
    buffer_load_dwordx4 v10, s[20:23], s32 offen offset:0 nt lds
    v_mfma_f32_16x16x32_bf16 v[204:207], v[232:235], a[172:175], v[204:207]
    s_add_u32 m0, s30, 33808
    ds_read_b64_tr_b16 a[214:215], v4 offset:42832
    v_mul_f32 v27, s35, v27
    v_exp_f32 v55, v55
    v_mfma_f32_16x16x32_bf16 v[208:211], v[232:235], a[176:179], v[208:211]
    buffer_load_dwordx4 v10, s[20:23], s32 offen offset:1024 nt lds
    v_mfma_f32_16x16x32_bf16 v[212:215], v[232:235], a[180:183], v[212:215]
    v_exp_f32 v53, v53
    v_mfma_f32_16x16x32_bf16 v[216:219], v[232:235], a[184:187], v[216:219]
    s_add_u32 m0, s30, 33824
    v_cvt_pk_bf16_f32 v24, v28, v24
    v_cvt_pk_bf16_f32 v41, v50, v51
    v_mfma_f32_16x16x32_bf16 v[220:223], v[232:235], a[188:191], v[220:223]
    buffer_load_dwordx4 v10, s[20:23], s32 offen offset:2048 nt lds
    v_exp_f32 v48, v48
    v_mfma_f32_16x16x32_bf16 v[56:59], a[128:131], a[16:19], 0
    s_add_u32 m0, s30, 33840
    ds_read_b64_tr_b16 a[216:217], v4 offset:42336
    ds_write_b32 v9, v24 offset:0
    v_mul_f32 v26, s35, v26
    v_mfma_f32_16x16x32_bf16 v[56:59], a[132:135], a[20:23], v[56:59]
    buffer_load_dwordx4 v10, s[20:23], s32 offen offset:3072 nt lds
    v_cvt_pk_bf16_f32 v26, v30, v26
    v_cvt_pk_bf16_f32 v40, v48, v49
    v_mfma_f32_16x16x32_bf16 v[56:59], a[136:139], a[24:27], v[56:59]
    v_exp_f32 v52, v52
    v_mfma_f32_16x16x32_bf16 v[56:59], a[140:143], a[28:31], v[56:59]
    s_add_u32 m0, s30, 37952
    ds_read_b64_tr_b16 a[218:219], v4 offset:42848
    v_cvt_pk_bf16_f32 v25, v29, v25
    v_mfma_f32_16x16x32_bf16 v[60:63], a[156:159], a[28:31], 0
    v_exp_f32 v54, v54
    v_mfma_f32_16x16x32_bf16 v[60:63], a[152:155], a[24:27], v[60:63]
    ds_read_b64_tr_b16 a[220:221], v4 offset:42352
    v_cvt_pk_bf16_f32 v42, v52, v53
    v_mfma_f32_16x16x32_bf16 v[60:63], a[148:151], a[20:23], v[60:63]
    v_cvt_pk_bf16_f32 v27, v31, v27
    v_cvt_pk_bf16_f32 v43, v54, v55
    v_mfma_f32_16x16x32_bf16 v[60:63], a[144:147], a[16:19], v[60:63]
    s_waitcnt lgkmcnt(14)
    buffer_load_dwordx4 v10, s[20:23], s33 offen offset:0 nt lds
    v_mfma_f32_16x16x32_bf16 v[64:67], v[40:43], a[192:195], v[64:67]
    s_waitcnt lgkmcnt(12)
    ds_read_b64_tr_b16 a[222:223], v4 offset:42864
    ds_write_b32 v9, v27 offset:768
    v_mfma_f32_16x16x32_bf16 v[68:71], v[40:43], a[196:199], v[68:71]
    s_waitcnt lgkmcnt(12)
    v_exp_f32 v63, v63
    v_mfma_f32_16x16x32_bf16 v[72:75], v[40:43], a[200:203], v[72:75]
    s_waitcnt lgkmcnt(10)
    v_exp_f32 v56, v56
    v_mfma_f32_16x16x32_bf16 v[76:79], v[40:43], a[204:207], v[76:79]
    s_waitcnt lgkmcnt(8)
    v_exp_f32 v60, v60
    v_mfma_f32_16x16x32_bf16 v[80:83], v[40:43], a[208:211], v[80:83]
    s_waitcnt lgkmcnt(6)
    ds_write_b32 v9, v26 offset:512
    v_mfma_f32_16x16x32_bf16 v[84:87], v[40:43], a[212:215], v[84:87]
    s_waitcnt lgkmcnt(4)
    v_exp_f32 v59, v59
    v_mfma_f32_16x16x32_bf16 v[88:91], v[40:43], a[216:219], v[88:91]
    s_waitcnt lgkmcnt(2)
    ds_write_b32 v9, v25 offset:256
    v_mfma_f32_16x16x32_bf16 v[92:95], v[40:43], a[220:223], v[92:95]
    s_add_u32 m0, s30, 37968
    v_exp_f32 v58, v58
    v_mfma_f32_16x16x32_bf16 v[48:51], a[128:131], a[32:35], 0
    buffer_load_dwordx4 v10, s[20:23], s33 offen offset:1024 nt lds
    v_mfma_f32_16x16x32_bf16 v[48:51], a[132:135], a[36:39], v[48:51]
    v_exp_f32 v62, v62
    v_mfma_f32_16x16x32_bf16 v[48:51], a[136:139], a[40:43], v[48:51]
    s_add_u32 m0, s30, 37984
    v_exp_f32 v61, v61
    v_cvt_pk_bf16_f32 v45, v58, v59
    v_mfma_f32_16x16x32_bf16 v[48:51], a[140:143], a[44:47], v[48:51]
    buffer_load_dwordx4 v10, s[20:23], s33 offen offset:2048 nt lds
    v_mfma_f32_16x16x32_bf16 v[52:55], a[156:159], a[44:47], 0
    s_add_u32 m0, s30, 38000
    v_exp_f32 v57, v57
    v_mfma_f32_16x16x32_bf16 v[52:55], a[152:155], a[40:43], v[52:55]
    s_cmp_lg_u32 s29, 31
    buffer_load_dwordx4 v10, s[20:23], s33 offen offset:3072 nt lds
    v_cvt_pk_bf16_f32 v46, v60, v61
    v_mfma_f32_16x16x32_bf16 v[52:55], a[148:151], a[36:39], v[52:55]
    v_cvt_pk_bf16_f32 v44, v56, v57
    v_cvt_pk_bf16_f32 v47, v62, v63
    v_mfma_f32_16x16x32_bf16 v[52:55], a[144:147], a[32:35], v[52:55]
    s_cbranch_scc1 L_B1
    v_smfmac_f32_16x16x64_bf16 a[224:227], a[248:251], v[40:47], v19
    s_waitcnt vmcnt(40)
    ds_read_b128 a[44:47], v8 offset:8192
    v_xor_b32 v24, 0x140, v23
    v_mfma_f32_16x16x32_bf16 v[96:99], v[44:47], a[192:195], v[96:99]
    s_barrier
    v_exp_f32 v54, v54
    v_mfma_f32_16x16x32_bf16 v[100:103], v[44:47], a[196:199], v[100:103]
    s_mov_b32 s31, s30
    ds_read_b128 a[20:23], v6 offset:4096
    ds_read_b128 a[36:39], v6 offset:8192
    v_exp_f32 v52, v52
    v_mfma_f32_16x16x32_bf16 v[104:107], v[44:47], a[200:203], v[104:107]
    s_xor_b32 s30, s30, 16896
    ds_read_b128 a[16:19], v5 offset:4096
    ds_read_b128 a[32:35], v5 offset:8192
    v_accvgpr_read_b32 v34, a224
    v_exp_f32 v48, v48
    v_exp_f32 v49, v49
    v_exp_f32 v53, v53
    v_add_u32 v3, s30, v1
    v_add_u32 v4, s30, v2
    v_mfma_f32_16x16x32_bf16 v[108:111], v[44:47], a[204:207], v[108:111]
    s_add_u32 s32, s32, 8192
    ds_read_b128 a[112:115], v3 offset:512
    ds_read_b64_tr_b16 a[184:185], v4 offset:33888
    v_accvgpr_read_b32 v38, a225
    v_accvgpr_read_b32 v39, a227
    v_mfma_f32_16x16x32_bf16 v[112:115], v[44:47], a[208:211], v[112:115]
    ds_read_b128 a[12:15], v8 offset:0
    ds_read_b128 a[120:123], v3 offset:640
    v_add_f32 v34, v34, v38
    v_exp_f32 v51, v51
    v_mfma_f32_16x16x32_bf16 v[116:119], v[44:47], a[212:215], v[116:119]
    ds_read_b128 a[40:43], v7 offset:8192
    ds_read_b64_tr_b16 a[176:177], v4 offset:33856
    v_accvgpr_read_b32 v36, a226
    v_mfma_f32_16x16x32_bf16 v[120:123], v[44:47], a[216:219], v[120:123]
    s_add_u32 s33, s32, 4096
    ds_read_b128 a[100:103], v3 offset:64
    ds_read_b128 a[108:111], v3 offset:192
    v_cvt_pk_bf16_f32 v42, v52, v53
    v_mfma_f32_16x16x32_bf16 v[124:127], v[44:47], a[220:223], v[124:127]
    ds_read_b64_tr_b16 a[182:183], v4 offset:34384
    v_subrev_u32 v38, s38, v34
    v_add_f32 v36, v36, v39
    v_mfma_f32_16x16x32_bf16 v[56:59], a[128:131], a[48:51], 0
    ds_read_b128 a[24:27], v7 offset:4096
    ds_read_b128 a[28:31], v8 offset:4096
    v_cvt_pk_bf16_f32 v40, v48, v49
    v_mfma_f32_16x16x32_bf16 v[56:59], a[132:135], a[52:55], v[56:59]
    s_add_u32 m0, s31, 8448
    ds_read_b64_tr_b16 a[162:163], v4 offset:34304
    v_subrev_u32 v39, s38, v36
    v_mfma_f32_16x16x32_bf16 v[56:59], a[136:139], a[56:59], v[56:59]
    ds_read_b64_tr_b16 a[164:165], v4 offset:33808
    buffer_load_dwordx4 v10, s[16:19], s32 offen offset:0 nt lds
    v_mfma_f32_16x16x32_bf16 v[56:59], a[140:143], a[60:63], v[56:59]
    s_add_u32 m0, s31, 8480
    v_rcp_f32 v34, v34
    v_mfma_f32_16x16x32_bf16 v[60:63], a[156:159], a[60:63], 0
    ds_read_b128 a[96:99], v3 offset:0
    v_mov_b32_dpp v34, v34 row_ror:12 row_mask:0xa bank_mask:0xf
    v_exp_f32 v55, v55
    v_mfma_f32_16x16x32_bf16 v[60:63], a[152:155], a[56:59], v[60:63]
    v_mov_b32_dpp v34, v34 row_ror:8 row_mask:0xc bank_mask:0xf
    v_exp_f32 v50, v50
    buffer_load_dwordx4 v10, s[16:19], s32 offen offset:1024 nt lds
    v_mfma_f32_16x16x32_bf16 v[60:63], a[148:151], a[52:55], v[60:63]
    ds_read_b64_tr_b16 a[160:161], v4 offset:33792
    ds_read_b64_tr_b16 a[190:191], v4 offset:34416
    v_mul_f32_dpp v67, v34, v67 row_newbcast:3 row_mask:0xf bank_mask:0xf
    v_mul_f32_dpp v71, v34, v71 row_newbcast:3 row_mask:0xf bank_mask:0xf
    v_cvt_pk_bf16_f32 v41, v50, v51
    v_cvt_pk_bf16_f32 v43, v54, v55
    v_mfma_f32_16x16x32_bf16 v[60:63], a[144:147], a[48:51], v[60:63]
    ds_read_b128 a[60:63], v8 offset:12288
    v_mul_f32_dpp v75, v34, v75 row_newbcast:3 row_mask:0xf bank_mask:0xf
    v_mul_f32_dpp v79, v34, v79 row_newbcast:3 row_mask:0xf bank_mask:0xf
    v_mfma_f32_16x16x32_bf16 v[128:131], v[40:43], a[192:195], v[128:131]
    v_mul_f32_dpp v83, v34, v83 row_newbcast:3 row_mask:0xf bank_mask:0xf
    v_mul_f32_dpp v87, v34, v87 row_newbcast:3 row_mask:0xf bank_mask:0xf
    v_mul_f32_dpp v91, v34, v91 row_newbcast:3 row_mask:0xf bank_mask:0xf
    v_mfma_f32_16x16x32_bf16 v[132:135], v[40:43], a[196:199], v[132:135]
    s_add_u32 m0, s31, 8512
    v_rcp_f32 v36, v36
    v_exp_f32 v57, v57
    v_mfma_f32_16x16x32_bf16 v[136:139], v[40:43], a[200:203], v[136:139]
    v_exp_f32 v58, v58
    v_mfma_f32_16x16x32_bf16 v[140:143], v[40:43], a[204:207], v[140:143]
    ds_read_b128 a[4:7], v6 offset:0
    v_exp_f32 v60, v60
    buffer_load_dwordx4 v10, s[16:19], s32 offen offset:2048 nt lds
    v_mfma_f32_16x16x32_bf16 v[144:147], v[40:43], a[208:211], v[144:147]
    ds_read_b64_tr_b16 a[166:167], v4 offset:34320
    ds_read_b64_tr_b16 a[178:179], v4 offset:34368
    v_mul_f32_dpp v92, v34, v92 row_newbcast:0 row_mask:0xf bank_mask:0xf
    v_mfma_f32_16x16x32_bf16 v[148:151], v[40:43], a[212:215], v[148:151]
    v_mul_f32_dpp v70, v34, v70 row_newbcast:2 row_mask:0xf bank_mask:0xf
    v_mul_f32_dpp v77, v34, v77 row_newbcast:1 row_mask:0xf bank_mask:0xf
    v_mul_f32_dpp v95, v34, v95 row_newbcast:3 row_mask:0xf bank_mask:0xf
    v_exp_f32 v63, v63
    v_mfma_f32_16x16x32_bf16 v[152:155], v[40:43], a[216:219], v[152:155]
    ds_read_b64_tr_b16 a[174:175], v4 offset:34352
    ds_read_b64_tr_b16 a[186:187], v4 offset:34400
    v_mov_b32_dpp v36, v36 row_ror:12 row_mask:0xa bank_mask:0xf
    v_exp_f32 v56, v56
    v_mfma_f32_16x16x32_bf16 v[156:159], v[40:43], a[220:223], v[156:159]
    v_mul_f32_dpp v66, v34, v66 row_newbcast:2 row_mask:0xf bank_mask:0xf
    v_exp_f32 v62, v62
    v_mfma_f32_16x16x32_bf16 v[224:227], a[128:131], a[64:67], 0
    s_add_u32 m0, s31, 8544
    ds_read_b128 a[104:107], v3 offset:128
    ds_read_b64_tr_b16 a[172:173], v4 offset:33840
    v_mov_b32_dpp v36, v36 row_ror:8 row_mask:0xc bank_mask:0xf
    v_mfma_f32_16x16x32_bf16 v[224:227], a[132:135], a[68:71], v[224:227]
    s_nop 0
    v_mul_f32_dpp v99, v36, v99 row_newbcast:3 row_mask:0xf bank_mask:0xf
    v_mul_f32_dpp v103, v36, v103 row_newbcast:3 row_mask:0xf bank_mask:0xf
    v_exp_f32 v59, v59
    buffer_load_dwordx4 v10, s[16:19], s32 offen offset:3072 nt lds
    v_mfma_f32_16x16x32_bf16 v[224:227], a[136:139], a[72:75], v[224:227]
    s_add_u32 m0, s31, 12672
    ds_read_b128 a[124:127], v3 offset:704
    v_max_u32 v15, v15, v39
    v_mul_f32_dpp v107, v36, v107 row_newbcast:3 row_mask:0xf bank_mask:0xf
    v_exp_f32 v61, v61
    v_mfma_f32_16x16x32_bf16 v[224:227], a[140:143], a[76:79], v[224:227]
    ds_read_b128 a[116:119], v3 offset:576
    ds_read_b64_tr_b16 a[180:181], v4 offset:33872
    v_mul_f32_dpp v82, v34, v82 row_newbcast:2 row_mask:0xf bank_mask:0xf
    v_mfma_f32_16x16x32_bf16 v[228:231], a[156:159], a[76:79], 0
    v_mul_f32_dpp v64, v34, v64 row_newbcast:0 row_mask:0xf bank_mask:0xf
    v_mul_f32_dpp v65, v34, v65 row_newbcast:1 row_mask:0xf bank_mask:0xf
    v_mul_f32_dpp v93, v34, v93 row_newbcast:1 row_mask:0xf bank_mask:0xf
    v_mfma_f32_16x16x32_bf16 v[228:231], a[152:155], a[72:75], v[228:231]
    v_mul_f32_dpp v110, v36, v110 row_newbcast:2 row_mask:0xf bank_mask:0xf
    v_cvt_pk_bf16_f32 v47, v62, v63
    buffer_load_dwordx4 v10, s[16:19], s33 offen offset:0 nt lds
    v_mfma_f32_16x16x32_bf16 v[228:231], a[148:151], a[68:71], v[228:231]
    s_add_u32 m0, s31, 12704
    ds_read_b128 a[0:3], v5 offset:0
    v_cvt_pk_bf16_f32 v44, v56, v57
    v_cvt_pk_bf16_f32 v45, v58, v59
    v_cvt_pk_bf16_f32 v46, v60, v61
    v_exp_f32 v226, v226
    v_mfma_f32_16x16x32_bf16 v[228:231], a[144:147], a[64:67], v[228:231]
    ds_read_b128 a[76:79], v8 offset:16384
    v_mul_f32_dpp v68, v34, v68 row_newbcast:0 row_mask:0xf bank_mask:0xf
    v_mul_f32_dpp v111, v36, v111 row_newbcast:3 row_mask:0xf bank_mask:0xf
    v_smfmac_f32_16x16x64_bf16 a[228:231], a[248:251], v[40:47], v19
    ds_read_b128 a[8:11], v7 offset:0
    v_mul_f32_dpp v76, v34, v76 row_newbcast:0 row_mask:0xf bank_mask:0xf
    v_mul_f32_dpp v78, v34, v78 row_newbcast:2 row_mask:0xf bank_mask:0xf
    v_mfma_f32_16x16x32_bf16 v[160:163], v[44:47], a[192:195], v[160:163]
    ds_read_b128 a[52:55], v6 offset:12288
    v_cvt_pk_bf16_f32 v64, v64, v68
    v_mul_f32_dpp v80, v34, v80 row_newbcast:0 row_mask:0xf bank_mask:0xf
    v_mfma_f32_16x16x32_bf16 v[164:167], v[44:47], a[196:199], v[164:167]
    ds_read_b128 a[56:59], v7 offset:12288
    ds_read_b128 a[72:75], v7 offset:16384
    v_mul_f32_dpp v98, v36, v98 row_newbcast:2 row_mask:0xf bank_mask:0xf
    v_mul_f32_dpp v105, v36, v105 row_newbcast:1 row_mask:0xf bank_mask:0xf
    v_exp_f32 v230, v230
    v_mfma_f32_16x16x32_bf16 v[168:171], v[44:47], a[200:203], v[168:171]
    v_mul_f32_dpp v72, v34, v72 row_newbcast:0 row_mask:0xf bank_mask:0xf
    v_cvt_pk_bf16_f32 v68, v66, v70
    v_exp_f32 v228, v228
    v_mfma_f32_16x16x32_bf16 v[172:175], v[44:47], a[204:207], v[172:175]
    v_mul_f32_dpp v73, v34, v73 row_newbcast:1 row_mask:0xf bank_mask:0xf
    v_mul_f32_dpp v100, v36, v100 row_newbcast:0 row_mask:0xf bank_mask:0xf
    v_mul_f32_dpp v115, v36, v115 row_newbcast:3 row_mask:0xf bank_mask:0xf
    v_mfma_f32_16x16x32_bf16 v[176:179], v[44:47], a[208:211], v[176:179]
    v_mul_f32_dpp v69, v34, v69 row_newbcast:1 row_mask:0xf bank_mask:0xf
    v_mul_f32_dpp v81, v34, v81 row_newbcast:1 row_mask:0xf bank_mask:0xf
    v_mul_f32_dpp v96, v36, v96 row_newbcast:0 row_mask:0xf bank_mask:0xf
    v_exp_f32 v229, v229
    v_mfma_f32_16x16x32_bf16 v[180:183], v[44:47], a[212:215], v[180:183]
    buffer_load_dwordx4 v10, s[16:19], s33 offen offset:1024 nt lds
    v_mfma_f32_16x16x32_bf16 v[184:187], v[44:47], a[216:219], v[184:187]
    s_add_u32 m0, s31, 12736
    ds_read_b64_tr_b16 a[188:189], v4 offset:33904
    v_mul_f32_dpp v106, v36, v106 row_newbcast:2 row_mask:0xf bank_mask:0xf
    v_mfma_f32_16x16x32_bf16 v[188:191], v[44:47], a[220:223], v[188:191]
    s_waitcnt lgkmcnt(6)
    ds_read_b128 a[48:51], v5 offset:12288
    v_mul_f32_dpp v97, v36, v97 row_newbcast:1 row_mask:0xf bank_mask:0xf
    v_mfma_f32_16x16x32_bf16 v[48:51], a[96:99], a[0:3], 0
    v_mul_f32_dpp v84, v34, v84 row_newbcast:0 row_mask:0xf bank_mask:0xf
    v_exp_f32 v225, v225
    v_exp_f32 v227, v227
    v_mfma_f32_16x16x32_bf16 v[48:51], a[100:103], a[4:7], v[48:51]
    s_waitcnt lgkmcnt(5)
    v_mul_f32_dpp v74, v34, v74 row_newbcast:2 row_mask:0xf bank_mask:0xf
    v_mul_f32_dpp v85, v34, v85 row_newbcast:1 row_mask:0xf bank_mask:0xf
    v_mul_f32_dpp v112, v36, v112 row_newbcast:0 row_mask:0xf bank_mask:0xf
    v_cvt_pk_bf16_f32 v234, v228, v229
    v_mfma_f32_16x16x32_bf16 v[48:51], a[104:107], a[8:11], v[48:51]
    v_mul_f32_dpp v117, v36, v117 row_newbcast:1 row_mask:0xf bank_mask:0xf
    v_mul_f32_dpp v119, v36, v119 row_newbcast:3 row_mask:0xf bank_mask:0xf
    v_exp_f32 v231, v231
    v_mfma_f32_16x16x32_bf16 v[48:51], a[108:111], a[12:15], v[48:51]
    v_mul_f32_dpp v122, v36, v122 row_newbcast:2 row_mask:0xf bank_mask:0xf
    v_exp_f32 v224, v224
    v_cvt_pk_bf16_f32 v233, v226, v227
    v_mfma_f32_16x16x32_bf16 v[52:55], a[124:127], a[12:15], 0
    v_mul_f32_dpp v86, v34, v86 row_newbcast:2 row_mask:0xf bank_mask:0xf
    v_mul_f32_dpp v104, v36, v104 row_newbcast:0 row_mask:0xf bank_mask:0xf
    buffer_load_dwordx4 v10, s[16:19], s33 offen offset:2048 nt lds
    v_mfma_f32_16x16x32_bf16 v[52:55], a[120:123], a[8:11], v[52:55]
    v_cvt_pk_bf16_f32 v80, v80, v84
    v_mul_f32_dpp v121, v36, v121 row_newbcast:1 row_mask:0xf bank_mask:0xf
    v_cvt_pk_bf16_f32 v232, v224, v225
    v_exp_f32 v51, v51
    v_mfma_f32_16x16x32_bf16 v[52:55], a[116:119], a[4:7], v[52:55]
    v_cvt_pk_bf16_f32 v66, v65, v69
    v_cvt_pk_bf16_f32 v70, v67, v71
    v_cvt_pk_bf16_f32 v69, v74, v78
    v_mul_f32_dpp v114, v36, v114 row_newbcast:2 row_mask:0xf bank_mask:0xf
    v_mul_f32_dpp v120, v36, v120 row_newbcast:0 row_mask:0xf bank_mask:0xf
    v_mul_f32_dpp v123, v36, v123 row_newbcast:3 row_mask:0xf bank_mask:0xf
    v_cvt_pk_bf16_f32 v235, v230, v231
    v_exp_f32 v50, v50
    v_mfma_f32_16x16x32_bf16 v[52:55], a[112:115], a[0:3], v[52:55]
    v_mul_f32_dpp v90, v34, v90 row_newbcast:2 row_mask:0xf bank_mask:0xf
    v_mul_f32_dpp v116, v36, v116 row_newbcast:0 row_mask:0xf bank_mask:0xf
    v_smfmac_f32_16x16x64_bf16 a[232:235], a[248:251], v[232:239], v19
    ds_read_b64_tr_b16 a[170:171], v4 offset:34336
    v_mul_f32_dpp v108, v36, v108 row_newbcast:0 row_mask:0xf bank_mask:0xf
    v_mfma_f32_16x16x32_bf16 v[192:195], v[232:235], a[192:195], v[192:195]
    v_mul_f32_dpp v89, v34, v89 row_newbcast:1 row_mask:0xf bank_mask:0xf
    v_cvt_pk_bf16_f32 v84, v82, v86
    v_mfma_f32_16x16x32_bf16 v[196:199], v[232:235], a[196:199], v[196:199]
    ds_read_b128 a[64:67], v5 offset:16384
    v_max_u32 v15, v15, v38
    v_mul_f32_dpp v88, v34, v88 row_newbcast:0 row_mask:0xf bank_mask:0xf
    v_mul_f32_dpp v113, v36, v113 row_newbcast:1 row_mask:0xf bank_mask:0xf
    v_exp_f32 v53, v53
    v_mfma_f32_16x16x32_bf16 v[200:203], v[232:235], a[200:203], v[200:203]
    v_cvt_pk_bf16_f32 v96, v96, v100
    v_accvgpr_read_b32 v38, a229
    v_exp_f32 v48, v48
    v_mfma_f32_16x16x32_bf16 v[204:207], v[232:235], a[204:207], v[204:207]
    ds_read_b64_tr_b16 a[168:169], v4 offset:33824
    v_mul_f32_dpp v94, v34, v94 row_newbcast:2 row_mask:0xf bank_mask:0xf
    v_mfma_f32_16x16x32_bf16 v[208:211], v[232:235], a[208:211], v[208:211]
    v_cvt_pk_bf16_f32 v82, v81, v85
    v_cvt_pk_bf16_f32 v85, v90, v94
    v_accvgpr_read_b32 v34, a228
    v_add_f32 v34, v34, v38
    v_exp_f32 v49, v49
    v_exp_f32 v52, v52
    v_mfma_f32_16x16x32_bf16 v[212:215], v[232:235], a[212:215], v[212:215]
    s_add_u32 m0, s31, 12768
    v_cvt_pk_bf16_f32 v81, v88, v92
    v_mul_f32_dpp v102, v36, v102 row_newbcast:2 row_mask:0xf bank_mask:0xf
    v_cvt_pk_bf16_f32 v100, v98, v102
    v_cvt_pk_bf16_f32 v112, v112, v116
    v_mfma_f32_16x16x32_bf16 v[216:219], v[232:235], a[216:219], v[216:219]
    buffer_load_dwordx4 v10, s[16:19], s33 offen offset:3072 nt lds
    v_mfma_f32_16x16x32_bf16 v[220:223], v[232:235], a[220:223], v[220:223]
    v_cvt_pk_bf16_f32 v86, v83, v87
    v_subrev_u32 v38, s38, v34
    v_exp_f32 v54, v54
    v_mfma_f32_16x16x32_bf16 v[56:59], a[96:99], a[16:19], 0
    v_cvt_pk_bf16_f32 v71, v75, v79
    v_mul_f32_dpp v101, v36, v101 row_newbcast:1 row_mask:0xf bank_mask:0xf
    v_mul_f32_dpp v109, v36, v109 row_newbcast:1 row_mask:0xf bank_mask:0xf
    v_mul_f32_dpp v127, v36, v127 row_newbcast:3 row_mask:0xf bank_mask:0xf
    v_exp_f32 v55, v55
    v_mfma_f32_16x16x32_bf16 v[56:59], a[100:103], a[20:23], v[56:59]
    ds_write_b128 v23, v[68:71] offset:512
    v_mul_f32_dpp v126, v36, v126 row_newbcast:2 row_mask:0xf bank_mask:0xf
    v_max_u32 v15, v15, v38
    v_rcp_f32 v34, v34
    v_cvt_pk_bf16_f32 v43, v54, v55
    v_mfma_f32_16x16x32_bf16 v[56:59], a[104:107], a[24:27], v[56:59]
    v_cvt_pk_bf16_f32 v83, v89, v93
    v_cvt_pk_bf16_f32 v87, v91, v95
    v_cvt_pk_bf16_f32 v98, v97, v101
    v_cvt_pk_bf16_f32 v97, v104, v108
    v_mov_b32_dpp v34, v34 row_ror:12 row_mask:0xa bank_mask:0xf
    v_mfma_f32_16x16x32_bf16 v[56:59], a[108:111], a[28:31], v[56:59]
    s_add_u32 m0, s31, 42240
    v_cvt_pk_bf16_f32 v101, v106, v110
    v_mov_b32_dpp v34, v34 row_ror:8 row_mask:0xc bank_mask:0xf
    v_cvt_pk_bf16_f32 v40, v48, v49
    v_mfma_f32_16x16x32_bf16 v[60:63], a[124:127], a[28:31], 0
    ds_read_b128 a[68:71], v6 offset:16384
    v_cvt_pk_bf16_f32 v65, v72, v76
    v_mul_f32_dpp v118, v36, v118 row_newbcast:2 row_mask:0xf bank_mask:0xf
    v_mul_f32_dpp v130, v34, v130 row_newbcast:2 row_mask:0xf bank_mask:0xf
    v_cvt_pk_bf16_f32 v41, v50, v51
    v_cvt_pk_bf16_f32 v42, v52, v53
    v_mfma_f32_16x16x32_bf16 v[60:63], a[120:123], a[24:27], v[60:63]
    v_cvt_pk_bf16_f32 v67, v73, v77
    v_cvt_pk_bf16_f32 v116, v114, v118
    v_exp_f32 v58, v58
    v_mfma_f32_16x16x32_bf16 v[60:63], a[116:119], a[20:23], v[60:63]
    ds_write_b128 v23, v[64:67] offset:0
    v_cvt_pk_bf16_f32 v102, v99, v103
    v_cvt_pk_bf16_f32 v103, v107, v111
    buffer_load_dwordx4 v10, s[20:23], s32 offen offset:0 nt lds
    v_mul_f32_dpp v131, v34, v131 row_newbcast:3 row_mask:0xf bank_mask:0xf
    v_mfma_f32_16x16x32_bf16 v[60:63], a[112:115], a[16:19], v[60:63]
    s_add_u32 m0, s31, 42256
    ds_write_b128 v24, v[80:83] offset:0
    v_mul_f32_dpp v124, v36, v124 row_newbcast:0 row_mask:0xf bank_mask:0xf
    v_mfma_f32_16x16x32_bf16 v[64:67], v[40:43], a[160:163], 0
    v_mul_f32_dpp v125, v36, v125 row_newbcast:1 row_mask:0xf bank_mask:0xf
    v_cvt_pk_bf16_f32 v114, v113, v117
    v_cvt_pk_bf16_f32 v117, v122, v126
    v_exp_f32 v57, v57
    v_mfma_f32_16x16x32_bf16 v[68:71], v[40:43], a[164:167], 0
    s_waitcnt lgkmcnt(4)
    v_mul_f32_dpp v135, v34, v135 row_newbcast:3 row_mask:0xf bank_mask:0xf
    v_mul_f32_dpp v139, v34, v139 row_newbcast:3 row_mask:0xf bank_mask:0xf
    v_mul_f32_dpp v143, v34, v143 row_newbcast:3 row_mask:0xf bank_mask:0xf
    v_mul_f32_dpp v147, v34, v147 row_newbcast:3 row_mask:0xf bank_mask:0xf
    v_mfma_f32_16x16x32_bf16 v[72:75], v[40:43], a[168:171], 0
    ds_write_b128 v24, v[84:87] offset:512
    v_cvt_pk_bf16_f32 v118, v115, v119
    v_mul_f32_dpp v129, v34, v129 row_newbcast:1 row_mask:0xf bank_mask:0xf
    v_mfma_f32_16x16x32_bf16 v[76:79], v[40:43], a[172:175], 0
    v_exp_f32 v60, v60
    v_exp_f32 v63, v63
    v_mfma_f32_16x16x32_bf16 v[80:83], v[40:43], a[176:179], 0
    v_mul_f32_dpp v133, v34, v133 row_newbcast:1 row_mask:0xf bank_mask:0xf
    v_mul_f32_dpp v138, v34, v138 row_newbcast:2 row_mask:0xf bank_mask:0xf
    v_accvgpr_read_b32 v36, a230
    v_exp_f32 v62, v62
    v_mfma_f32_16x16x32_bf16 v[84:87], v[40:43], a[180:183], 0
    v_mul_f32_dpp v151, v34, v151 row_newbcast:3 row_mask:0xf bank_mask:0xf
    v_mul_f32_dpp v155, v34, v155 row_newbcast:3 row_mask:0xf bank_mask:0xf
    v_mfma_f32_16x16x32_bf16 v[88:91], v[40:43], a[184:187], 0
    v_exp_f32 v56, v56
    v_mfma_f32_16x16x32_bf16 v[92:95], v[40:43], a[188:191], 0
    v_cvt_pk_bf16_f32 v115, v121, v125
    v_cvt_pk_bf16_f32 v119, v123, v127
    v_mul_f32_dpp v142, v34, v142 row_newbcast:2 row_mask:0xf bank_mask:0xf
    v_exp_f32 v61, v61
    v_mfma_f32_16x16x32_bf16 v[48:51], a[96:99], a[32:35], 0
    v_cvt_pk_bf16_f32 v99, v105, v109
    v_mul_f32_dpp v134, v34, v134 row_newbcast:2 row_mask:0xf bank_mask:0xf
    v_exp_f32 v59, v59
    v_cvt_pk_bf16_f32 v47, v62, v63
    v_mfma_f32_16x16x32_bf16 v[48:51], a[100:103], a[36:39], v[48:51]
    ds_write_b128 v24, v[116:119] offset:4608
    buffer_load_dwordx4 v10, s[20:23], s32 offen offset:1024 nt lds
    v_mul_f32_dpp v159, v34, v159 row_newbcast:3 row_mask:0xf bank_mask:0xf
    v_cvt_pk_bf16_f32 v45, v58, v59
    v_mfma_f32_16x16x32_bf16 v[48:51], a[104:107], a[40:43], v[48:51]
    v_accvgpr_read_b32 v39, a231
    v_add_f32 v36, v36, v39
    v_subrev_u32 v39, s38, v36
    v_rcp_f32 v36, v36
    v_accvgpr_read_b32 v38, a233
    v_mfma_f32_16x16x32_bf16 v[48:51], a[108:111], a[44:47], v[48:51]
    s_add_u32 m0, s31, 42272
    v_mul_f32_dpp v128, v34, v128 row_newbcast:0 row_mask:0xf bank_mask:0xf
    v_mov_b32_dpp v36, v36 row_ror:12 row_mask:0xa bank_mask:0xf
    v_mfma_f32_16x16x32_bf16 v[52:55], a[124:127], a[44:47], 0
    v_cvt_pk_bf16_f32 v113, v120, v124
    buffer_load_dwordx4 v10, s[20:23], s32 offen offset:2048 nt lds
    v_cvt_pk_bf16_f32 v44, v56, v57
    v_cvt_pk_bf16_f32 v46, v60, v61
    v_mfma_f32_16x16x32_bf16 v[52:55], a[120:123], a[40:43], v[52:55]
    s_add_u32 m0, s31, 42288
    ds_write_b128 v23, v[96:99] offset:4096
    v_mul_f32_dpp v132, v34, v132 row_newbcast:0 row_mask:0xf bank_mask:0xf
    v_mul_f32_dpp v150, v34, v150 row_newbcast:2 row_mask:0xf bank_mask:0xf
    v_mfma_f32_16x16x32_bf16 v[52:55], a[116:119], a[36:39], v[52:55]
    ds_write_b128 v24, v[112:115] offset:4096
    v_mul_f32_dpp v140, v34, v140 row_newbcast:0 row_mask:0xf bank_mask:0xf
    v_mul_f32_dpp v153, v34, v153 row_newbcast:1 row_mask:0xf bank_mask:0xf
    v_mov_b32_dpp v36, v36 row_ror:8 row_mask:0xc bank_mask:0xf
    v_mfma_f32_16x16x32_bf16 v[52:55], a[112:115], a[32:35], v[52:55]
    buffer_load_dwordx4 v10, s[20:23], s32 offen offset:3072 nt lds
    v_cvt_pk_bf16_f32 v128, v128, v132
    v_mul_f32_dpp v163, v36, v163 row_newbcast:3 row_mask:0xf bank_mask:0xf
    v_mul_f32_dpp v167, v36, v167 row_newbcast:3 row_mask:0xf bank_mask:0xf
    v_exp_f32 v49, v49
    v_smfmac_f32_16x16x64_bf16 a[236:239], a[248:251], v[40:47], v19
    s_add_u32 m0, s31, 46400
    ds_write_b128 v23, v[100:103] offset:4608
    v_mul_f32_dpp v157, v34, v157 row_newbcast:1 row_mask:0xf bank_mask:0xf
    v_mfma_f32_16x16x32_bf16 v[96:99], v[44:47], a[160:163], 0
    buffer_load_dwordx4 v10, s[20:23], s33 offen offset:0 nt lds
    v_mul_f32_dpp v144, v34, v144 row_newbcast:0 row_mask:0xf bank_mask:0xf
    v_mul_f32_dpp v146, v34, v146 row_newbcast:2 row_mask:0xf bank_mask:0xf
    v_mul_f32_dpp v171, v36, v171 row_newbcast:3 row_mask:0xf bank_mask:0xf
    v_exp_f32 v53, v53
    v_mfma_f32_16x16x32_bf16 v[100:103], v[44:47], a[164:167], 0
    s_add_u32 m0, s31, 46416
    v_mul_f32_dpp v136, v34, v136 row_newbcast:0 row_mask:0xf bank_mask:0xf
    v_mul_f32_dpp v162, v36, v162 row_newbcast:2 row_mask:0xf bank_mask:0xf
    v_mfma_f32_16x16x32_bf16 v[104:107], v[44:47], a[168:171], 0
    buffer_load_dwordx4 v10, s[20:23], s33 offen offset:1024 nt lds
    v_cvt_pk_bf16_f32 v132, v130, v134
    v_cvt_pk_bf16_f32 v130, v129, v133
    v_mul_f32_dpp v160, v36, v160 row_newbcast:0 row_mask:0xf bank_mask:0xf
    v_mfma_f32_16x16x32_bf16 v[108:111], v[44:47], a[172:175], 0
    s_add_u32 m0, s31, 46432
    v_mul_f32_dpp v148, v34, v148 row_newbcast:0 row_mask:0xf bank_mask:0xf
    v_mul_f32_dpp v154, v34, v154 row_newbcast:2 row_mask:0xf bank_mask:0xf
    v_mul_f32_dpp v166, v36, v166 row_newbcast:2 row_mask:0xf bank_mask:0xf
    v_mfma_f32_16x16x32_bf16 v[112:115], v[44:47], a[176:179], 0
    buffer_load_dwordx4 v10, s[20:23], s33 offen offset:2048 nt lds
    v_mul_f32_dpp v152, v34, v152 row_newbcast:0 row_mask:0xf bank_mask:0xf
    v_cvt_pk_bf16_f32 v144, v144, v148
    v_cvt_pk_bf16_f32 v148, v146, v150
    v_mfma_f32_16x16x32_bf16 v[116:119], v[44:47], a[180:183], 0
    s_add_u32 m0, s31, 46448
    v_mul_f32_dpp v137, v34, v137 row_newbcast:1 row_mask:0xf bank_mask:0xf
    v_cvt_pk_bf16_f32 v150, v147, v151
    v_cvt_pk_bf16_f32 v147, v153, v157
    v_mul_f32_dpp v175, v36, v175 row_newbcast:3 row_mask:0xf bank_mask:0xf
    v_mul_f32_dpp v177, v36, v177 row_newbcast:1 row_mask:0xf bank_mask:0xf
    v_mul_f32_dpp v179, v36, v179 row_newbcast:3 row_mask:0xf bank_mask:0xf
    v_mfma_f32_16x16x32_bf16 v[120:123], v[44:47], a[184:187], 0
    buffer_load_dwordx4 v10, s[20:23], s33 offen offset:3072 nt lds
    v_cvt_pk_bf16_f32 v129, v136, v140
    v_mul_f32_dpp v149, v34, v149 row_newbcast:1 row_mask:0xf bank_mask:0xf
    v_mul_f32_dpp v158, v34, v158 row_newbcast:2 row_mask:0xf bank_mask:0xf
    v_mul_f32_dpp v174, v36, v174 row_newbcast:2 row_mask:0xf bank_mask:0xf
    v_exp_f32 v50, v50
    v_mfma_f32_16x16x32_bf16 v[124:127], v[44:47], a[188:191], 0
    s_waitcnt vmcnt(36)
    v_cvt_pk_bf16_f32 v134, v131, v135
    v_cvt_pk_bf16_f32 v151, v155, v159
    v_mul_f32_dpp v183, v36, v183 row_newbcast:3 row_mask:0xf bank_mask:0xf
    v_mfma_f32_16x16x32_bf16 v[56:59], a[96:99], a[48:51], 0
    s_barrier
    v_mul_f32_dpp v145, v34, v145 row_newbcast:1 row_mask:0xf bank_mask:0xf
    v_mul_f32_dpp v164, v36, v164 row_newbcast:0 row_mask:0xf bank_mask:0xf
    v_mul_f32_dpp v182, v36, v182 row_newbcast:2 row_mask:0xf bank_mask:0xf
    v_exp_f32 v52, v52
    v_exp_f32 v54, v54
    v_mfma_f32_16x16x32_bf16 v[56:59], a[100:103], a[52:55], v[56:59]
    ds_read_b128 a[140:143], v3 offset:8640
    ds_read_b64_tr_b16 a[208:209], v4 offset:42304
    v_mul_f32_dpp v141, v34, v141 row_newbcast:1 row_mask:0xf bank_mask:0xf
    v_cvt_pk_bf16_f32 v131, v137, v141
    v_cvt_pk_bf16_f32 v160, v160, v164
    v_cvt_pk_bf16_f32 v164, v162, v166
    v_mul_f32_dpp v185, v36, v185 row_newbcast:1 row_mask:0xf bank_mask:0xf
    v_mul_f32_dpp v187, v36, v187 row_newbcast:3 row_mask:0xf bank_mask:0xf
    v_mfma_f32_16x16x32_bf16 v[56:59], a[104:107], a[56:59], v[56:59]
    ds_read_b128 a[132:135], v3 offset:8512
    ds_read_b128 a[148:151], v3 offset:9024
    v_mul_f32_dpp v176, v36, v176 row_newbcast:0 row_mask:0xf bank_mask:0xf
    v_exp_f32 v48, v48
    v_exp_f32 v51, v51
    v_exp_f32 v55, v55
    v_mfma_f32_16x16x32_bf16 v[56:59], a[108:111], a[60:63], v[56:59]
    ds_write_b128 v23, v[128:131] offset:8192
    ds_read_b128 a[156:159], v3 offset:9152
    v_cvt_pk_bf16_f32 v41, v50, v51
    v_mfma_f32_16x16x32_bf16 v[60:63], a[124:127], a[60:63], 0
    ds_read_b64_tr_b16 a[196:197], v4 offset:42256
    v_cvt_pk_bf16_f32 v135, v139, v143
    v_mul_f32_dpp v156, v34, v156 row_newbcast:0 row_mask:0xf bank_mask:0xf
    v_cvt_pk_bf16_f32 v146, v145, v149
    v_mul_f32_dpp v173, v36, v173 row_newbcast:1 row_mask:0xf bank_mask:0xf
    v_mul_f32_dpp v180, v36, v180 row_newbcast:0 row_mask:0xf bank_mask:0xf
    v_mul_f32_dpp v191, v36, v191 row_newbcast:3 row_mask:0xf bank_mask:0xf
    v_cvt_pk_bf16_f32 v42, v52, v53
    v_mfma_f32_16x16x32_bf16 v[60:63], a[120:123], a[56:59], v[60:63]
    ds_read_b128 a[128:131], v3 offset:8448
    ds_read_b128 a[136:139], v3 offset:8576
    v_cvt_pk_bf16_f32 v133, v138, v142
    v_mul_f32_dpp v178, v36, v178 row_newbcast:2 row_mask:0xf bank_mask:0xf
    v_mul_f32_dpp v184, v36, v184 row_newbcast:0 row_mask:0xf bank_mask:0xf
    v_mul_f32_dpp v186, v36, v186 row_newbcast:2 row_mask:0xf bank_mask:0xf
    v_cvt_pk_bf16_f32 v40, v48, v49
    v_cvt_pk_bf16_f32 v43, v54, v55
    v_mfma_f32_16x16x32_bf16 v[60:63], a[116:119], a[52:55], v[60:63]
    ds_read_b64_tr_b16 a[220:221], v4 offset:42352
    v_cvt_pk_bf16_f32 v145, v152, v156
    v_cvt_pk_bf16_f32 v166, v163, v167
    v_accvgpr_read_b32 v34, a232
    v_add_f32 v34, v34, v38
    v_mfma_f32_16x16x32_bf16 v[60:63], a[112:115], a[48:51], v[60:63]
    s_add_u32 s32, s32, 8192
    v_mul_f32_dpp v172, v36, v172 row_newbcast:0 row_mask:0xf bank_mask:0xf
    v_subrev_u32 v38, s38, v34
    v_rcp_f32 v34, v34
    v_mfma_f32_16x16x32_bf16 v[128:131], v[40:43], a[160:163], 0
    s_add_u32 s33, s32, 4096
    ds_write_b128 v23, v[132:135] offset:8704
    v_cvt_pk_bf16_f32 v149, v154, v158
    v_mfma_f32_16x16x32_bf16 v[132:135], v[40:43], a[164:167], 0
    ds_read_b128 a[152:155], v3 offset:9088
    v_mul_f32_dpp v181, v36, v181 row_newbcast:1 row_mask:0xf bank_mask:0xf
    v_cvt_pk_bf16_f32 v176, v176, v180
    v_mov_b32_dpp v34, v34 row_ror:12 row_mask:0xa bank_mask:0xf
    v_exp_f32 v61, v61
    v_mfma_f32_16x16x32_bf16 v[136:139], v[40:43], a[168:171], 0
    s_add_u32 m0, s30, 0
    v_exp_f32 v58, v58
    v_exp_f32 v60, v60
    v_mfma_f32_16x16x32_bf16 v[140:143], v[40:43], a[172:175], 0
    ds_write_b128 v24, v[144:147] offset:8192
    ds_write_b128 v24, v[148:151] offset:8704
    v_mul_f32_dpp v189, v36, v189 row_newbcast:1 row_mask:0xf bank_mask:0xf
    v_cvt_pk_bf16_f32 v180, v178, v182
    v_mfma_f32_16x16x32_bf16 v[144:147], v[40:43], a[176:179], 0
    ds_read_b64_tr_b16 a[202:203], v4 offset:42784
    v_mul_f32_dpp v165, v36, v165 row_newbcast:1 row_mask:0xf bank_mask:0xf
    v_mov_b32_dpp v34, v34 row_ror:8 row_mask:0xc bank_mask:0xf
    v_cvt_pk_bf16_f32 v46, v60, v61
    buffer_load_dwordx4 v10, s[16:19], s32 offen offset:0 nt lds
    v_mfma_f32_16x16x32_bf16 v[148:151], v[40:43], a[180:183], 0
    s_add_u32 m0, s30, 32
    v_mul_f32_dpp v169, v36, v169 row_newbcast:1 row_mask:0xf bank_mask:0xf
    v_mul_f32_dpp v195, v34, v195 row_newbcast:3 row_mask:0xf bank_mask:0xf
    v_exp_f32 v57, v57
    v_mfma_f32_16x16x32_bf16 v[152:155], v[40:43], a[184:187], 0
    ds_read_b64_tr_b16 a[192:193], v4 offset:42240
    v_mul_f32_dpp v199, v34, v199 row_newbcast:3 row_mask:0xf bank_mask:0xf
    v_exp_f32 v56, v56
    v_exp_f32 v59, v59
    buffer_load_dwordx4 v10, s[16:19], s32 offen offset:1024 nt lds
    v_mfma_f32_16x16x32_bf16 v[156:159], v[40:43], a[188:191], 0
    v_exp_f32 v62, v62
    v_exp_f32 v63, v63
    v_cvt_pk_bf16_f32 v44, v56, v57
    v_mfma_f32_16x16x32_bf16 v[224:227], a[96:99], a[64:67], 0
    s_waitcnt lgkmcnt(15)
    ds_read_b128 a[144:147], v3 offset:8960
    ds_read_b64_tr_b16 a[218:219], v4 offset:42848
    v_mul_f32_dpp v161, v36, v161 row_newbcast:1 row_mask:0xf bank_mask:0xf
    v_cvt_pk_bf16_f32 v162, v161, v165
    v_mul_f32_dpp v188, v36, v188 row_newbcast:0 row_mask:0xf bank_mask:0xf
    v_mul_f32_dpp v193, v34, v193 row_newbcast:1 row_mask:0xf bank_mask:0xf
    v_mfma_f32_16x16x32_bf16 v[224:227], a[100:103], a[68:71], v[224:227]
    ds_read_b64_tr_b16 a[194:195], v4 offset:42752
    ds_read_b64_tr_b16 a[200:201], v4 offset:42272
    v_mul_f32_dpp v203, v34, v203 row_newbcast:3 row_mask:0xf bank_mask:0xf
    v_mul_f32_dpp v205, v34, v205 row_newbcast:1 row_mask:0xf bank_mask:0xf
    v_mul_f32_dpp v207, v34, v207 row_newbcast:3 row_mask:0xf bank_mask:0xf
    v_cvt_pk_bf16_f32 v47, v62, v63
    v_mfma_f32_16x16x32_bf16 v[224:227], a[104:107], a[72:75], v[224:227]
    v_mul_f32_dpp v170, v36, v170 row_newbcast:2 row_mask:0xf bank_mask:0xf
    v_cvt_pk_bf16_f32 v182, v179, v183
    v_mfma_f32_16x16x32_bf16 v[224:227], a[108:111], a[76:79], v[224:227]
    v_cvt_pk_bf16_f32 v163, v169, v173
    v_cvt_pk_bf16_f32 v165, v170, v174
    v_cvt_pk_bf16_f32 v167, v171, v175
    v_cvt_pk_bf16_f32 v178, v177, v181
    v_cvt_pk_bf16_f32 v177, v184, v188
    v_mul_f32_dpp v202, v34, v202 row_newbcast:2 row_mask:0xf bank_mask:0xf
    v_cvt_pk_bf16_f32 v45, v58, v59
    v_mfma_f32_16x16x32_bf16 v[228:231], a[124:127], a[76:79], 0
    s_add_u32 m0, s30, 64
    ds_read_b64_tr_b16 a[214:215], v4 offset:42832
    v_mul_f32_dpp v168, v36, v168 row_newbcast:0 row_mask:0xf bank_mask:0xf
    v_mul_f32_dpp v211, v34, v211 row_newbcast:3 row_mask:0xf bank_mask:0xf
    v_mfma_f32_16x16x32_bf16 v[228:231], a[120:123], a[72:75], v[228:231]
    v_cvt_pk_bf16_f32 v161, v168, v172
    v_cvt_pk_bf16_f32 v183, v187, v191
    v_mul_f32_dpp v197, v34, v197 row_newbcast:1 row_mask:0xf bank_mask:0xf
    v_mfma_f32_16x16x32_bf16 v[228:231], a[116:119], a[68:71], v[228:231]
    v_mul_f32_dpp v190, v36, v190 row_newbcast:2 row_mask:0xf bank_mask:0xf
    v_mul_f32_dpp v213, v34, v213 row_newbcast:1 row_mask:0xf bank_mask:0xf
    buffer_load_dwordx4 v10, s[16:19], s32 offen offset:2048 nt lds
    v_mfma_f32_16x16x32_bf16 v[228:231], a[112:115], a[64:67], v[228:231]
    s_add_u32 m0, s30, 96
    ds_write_b128 v23, v[160:163] offset:12288
    v_cvt_pk_bf16_f32 v181, v186, v190
    v_mul_f32_dpp v194, v34, v194 row_newbcast:2 row_mask:0xf bank_mask:0xf
    v_mul_f32_dpp v209, v34, v209 row_newbcast:1 row_mask:0xf bank_mask:0xf
    v_smfmac_f32_16x16x64_bf16 a[240:243], a[248:251], v[40:47], v19
    ds_write_b128 v23, v[164:167] offset:12800
    v_mul_f32_dpp v208, v34, v208 row_newbcast:0 row_mask:0xf bank_mask:0xf
    v_mfma_f32_16x16x32_bf16 v[160:163], v[44:47], a[160:163], 0
    v_mul_f32_dpp v204, v34, v204 row_newbcast:0 row_mask:0xf bank_mask:0xf
    v_mul_f32_dpp v210, v34, v210 row_newbcast:2 row_mask:0xf bank_mask:0xf
    v_mfma_f32_16x16x32_bf16 v[164:167], v[44:47], a[164:167], 0
    v_cvt_pk_bf16_f32 v179, v185, v189
    v_mul_f32_dpp v196, v34, v196 row_newbcast:0 row_mask:0xf bank_mask:0xf
    v_mfma_f32_16x16x32_bf16 v[168:171], v[44:47], a[168:171], 0
    ds_write_b128 v24, v[180:183] offset:12800
    v_mul_f32_dpp v198, v34, v198 row_newbcast:2 row_mask:0xf bank_mask:0xf
    v_mul_f32_dpp v212, v34, v212 row_newbcast:0 row_mask:0xf bank_mask:0xf
    v_mul_f32_dpp v215, v34, v215 row_newbcast:3 row_mask:0xf bank_mask:0xf
    v_mfma_f32_16x16x32_bf16 v[172:175], v[44:47], a[172:175], 0
    ds_write_b128 v24, v[176:179] offset:12288
    v_mul_f32_dpp v192, v34, v192 row_newbcast:0 row_mask:0xf bank_mask:0xf
    v_exp_f32 v225, v225
    v_exp_f32 v226, v226
    v_exp_f32 v229, v229
    v_exp_f32 v230, v230
    v_exp_f32 v231, v231
    v_mfma_f32_16x16x32_bf16 v[176:179], v[44:47], a[176:179], 0
    ds_read_b64_tr_b16 a[204:205], v4 offset:42288
    v_cvt_pk_bf16_f32 v208, v208, v212
    buffer_load_dwordx4 v10, s[16:19], s32 offen offset:3072 nt lds
    v_exp_f32 v228, v228
    v_mfma_f32_16x16x32_bf16 v[180:183], v[44:47], a[180:183], 0
    s_add_u32 m0, s30, 4224
    ds_read_b64_tr_b16 a[206:207], v4 offset:42800
    v_exp_f32 v227, v227
    v_cvt_pk_bf16_f32 v235, v230, v231
    v_mfma_f32_16x16x32_bf16 v[184:187], v[44:47], a[184:187], 0
    v_cvt_pk_bf16_f32 v192, v192, v196
    v_cvt_pk_bf16_f32 v196, v194, v198
    v_mul_f32_dpp v214, v34, v214 row_newbcast:2 row_mask:0xf bank_mask:0xf
    v_mul_f32_dpp v218, v34, v218 row_newbcast:2 row_mask:0xf bank_mask:0xf
    v_mul_f32_dpp v219, v34, v219 row_newbcast:3 row_mask:0xf bank_mask:0xf
    v_mfma_f32_16x16x32_bf16 v[188:191], v[44:47], a[188:191], 0
    s_waitcnt lgkmcnt(15)
    ds_read_b64_tr_b16 a[216:217], v4 offset:42336
    v_cvt_pk_bf16_f32 v198, v195, v199
    v_mfma_f32_16x16x32_bf16 v[48:51], a[128:131], a[0:3], 0
    v_mul_f32_dpp v220, v34, v220 row_newbcast:0 row_mask:0xf bank_mask:0xf
    v_exp_f32 v224, v224
    v_mfma_f32_16x16x32_bf16 v[48:51], a[132:135], a[4:7], v[48:51]
    ds_read_b64_tr_b16 a[198:199], v4 offset:42768
    v_mul_f32_dpp v201, v34, v201 row_newbcast:1 row_mask:0xf bank_mask:0xf
    v_mfma_f32_16x16x32_bf16 v[48:51], a[136:139], a[8:11], v[48:51]
    v_mul_f32_dpp v217, v34, v217 row_newbcast:1 row_mask:0xf bank_mask:0xf
    v_mul_f32_dpp v222, v34, v222 row_newbcast:2 row_mask:0xf bank_mask:0xf
    v_cvt_pk_bf16_f32 v212, v210, v214
    v_mfma_f32_16x16x32_bf16 v[48:51], a[140:143], a[12:15], v[48:51]
    v_cvt_pk_bf16_f32 v194, v193, v197
    v_cvt_pk_bf16_f32 v195, v201, v205
    v_mul_f32_dpp v221, v34, v221 row_newbcast:1 row_mask:0xf bank_mask:0xf
    v_mul_f32_dpp v223, v34, v223 row_newbcast:3 row_mask:0xf bank_mask:0xf
    v_cvt_pk_bf16_f32 v210, v209, v213
    v_mfma_f32_16x16x32_bf16 v[52:55], a[156:159], a[12:15], 0
    v_cvt_pk_bf16_f32 v213, v218, v222
    v_cvt_pk_bf16_f32 v234, v228, v229
    v_mfma_f32_16x16x32_bf16 v[52:55], a[152:155], a[8:11], v[52:55]
    v_mul_f32_dpp v200, v34, v200 row_newbcast:0 row_mask:0xf bank_mask:0xf
    v_mul_f32_dpp v206, v34, v206 row_newbcast:2 row_mask:0xf bank_mask:0xf
    v_cvt_pk_bf16_f32 v193, v200, v204
    v_cvt_pk_bf16_f32 v197, v202, v206
    buffer_load_dwordx4 v10, s[16:19], s33 offen offset:0 nt lds
    v_cvt_pk_bf16_f32 v232, v224, v225
    v_cvt_pk_bf16_f32 v233, v226, v227
    v_mfma_f32_16x16x32_bf16 v[52:55], a[148:151], a[4:7], v[52:55]
    s_waitcnt lgkmcnt(12)
    ds_read_b64_tr_b16 a[210:211], v4 offset:42816
    v_cvt_pk_bf16_f32 v199, v203, v207
    v_mfma_f32_16x16x32_bf16 v[52:55], a[144:147], a[0:3], v[52:55]
    s_add_u32 m0, s30, 4256
    v_cvt_pk_bf16_f32 v214, v211, v215
    v_cvt_pk_bf16_f32 v215, v219, v223
    v_smfmac_f32_16x16x64_bf16 a[244:247], a[248:251], v[232:239], v19
    ds_write_b128 v23, v[192:195] offset:16384
    v_mul_f32_dpp v216, v34, v216 row_newbcast:0 row_mask:0xf bank_mask:0xf
    v_cvt_pk_bf16_f32 v211, v217, v221
    v_mfma_f32_16x16x32_bf16 v[192:195], v[232:235], a[160:163], 0
    ds_write_b128 v23, v[196:199] offset:16896
    buffer_load_dwordx4 v10, s[16:19], s33 offen offset:1024 nt lds
    v_mfma_f32_16x16x32_bf16 v[196:199], v[232:235], a[164:167], 0
    v_cvt_pk_bf16_f32 v209, v216, v220
    v_exp_f32 v50, v50
    v_mfma_f32_16x16x32_bf16 v[200:203], v[232:235], a[168:171], 0
    s_add_u32 m0, s30, 4288
    ds_write_b128 v24, v[212:215] offset:16896
    v_mfma_f32_16x16x32_bf16 v[204:207], v[232:235], a[172:175], 0
    ds_write_b128 v24, v[208:211] offset:16384
    v_exp_f32 v53, v53
    v_mfma_f32_16x16x32_bf16 v[208:211], v[232:235], a[176:179], 0
    v_exp_f32 v52, v52
    v_mfma_f32_16x16x32_bf16 v[212:215], v[232:235], a[180:183], 0
    v_exp_f32 v54, v54
    v_mfma_f32_16x16x32_bf16 v[216:219], v[232:235], a[184:187], 0
    v_exp_f32 v48, v48
    v_mfma_f32_16x16x32_bf16 v[220:223], v[232:235], a[188:191], 0
    buffer_load_dwordx4 v10, s[16:19], s33 offen offset:2048 nt lds
    v_mfma_f32_16x16x32_bf16 v[56:59], a[128:131], a[16:19], 0
    v_exp_f32 v51, v51
    v_mfma_f32_16x16x32_bf16 v[56:59], a[132:135], a[20:23], v[56:59]
    s_add_u32 m0, s30, 4320
    v_exp_f32 v49, v49
    v_mfma_f32_16x16x32_bf16 v[56:59], a[136:139], a[24:27], v[56:59]
    ds_read_b64_tr_b16 a[212:213], v4 offset:42320
    v_cvt_pk_bf16_f32 v41, v50, v51
    v_mfma_f32_16x16x32_bf16 v[56:59], a[140:143], a[28:31], v[56:59]
    v_cvt_pk_bf16_f32 v40, v48, v49
    v_cvt_pk_bf16_f32 v42, v52, v53
    v_mfma_f32_16x16x32_bf16 v[60:63], a[156:159], a[28:31], 0
    buffer_load_dwordx4 v10, s[16:19], s33 offen offset:3072 nt lds
    v_mfma_f32_16x16x32_bf16 v[60:63], a[152:155], a[24:27], v[60:63]
    v_exp_f32 v55, v55
    v_exp_f32 v58, v58
    v_exp_f32 v59, v59
    v_mfma_f32_16x16x32_bf16 v[60:63], a[148:151], a[20:23], v[60:63]
    s_add_u32 m0, s30, 33792
    ds_read_b64_tr_b16 a[222:223], v4 offset:42864
    v_cvt_pk_bf16_f32 v43, v54, v55
    v_mfma_f32_16x16x32_bf16 v[60:63], a[144:147], a[16:19], v[60:63]
    s_waitcnt lgkmcnt(15)
    v_exp_f32 v57, v57
    v_mfma_f32_16x16x32_bf16 v[64:67], v[40:43], a[192:195], v[64:67]
    s_waitcnt lgkmcnt(7)
    buffer_load_dwordx4 v10, s[20:23], s32 offen offset:0 nt lds
    v_mfma_f32_16x16x32_bf16 v[68:71], v[40:43], a[196:199], v[68:71]
    s_add_u32 m0, s30, 33808
    v_exp_f32 v63, v63
    v_mfma_f32_16x16x32_bf16 v[72:75], v[40:43], a[200:203], v[72:75]
    buffer_load_dwordx4 v10, s[20:23], s32 offen offset:1024 nt lds
    v_mfma_f32_16x16x32_bf16 v[76:79], v[40:43], a[204:207], v[76:79]
    s_waitcnt lgkmcnt(6)
    s_add_u32 m0, s30, 33824
    v_exp_f32 v62, v62
    v_mfma_f32_16x16x32_bf16 v[80:83], v[40:43], a[208:211], v[80:83]
    s_waitcnt lgkmcnt(1)
    buffer_load_dwordx4 v10, s[20:23], s32 offen offset:2048 nt lds
    v_mfma_f32_16x16x32_bf16 v[84:87], v[40:43], a[212:215], v[84:87]
    v_max_u32 v15, v15, v38
    v_cvt_pk_bf16_f32 v47, v62, v63
    v_mfma_f32_16x16x32_bf16 v[88:91], v[40:43], a[216:219], v[88:91]
    s_waitcnt lgkmcnt(0)
    s_add_u32 m0, s30, 33840
    v_max_u32 v15, v15, v39
    v_mfma_f32_16x16x32_bf16 v[92:95], v[40:43], a[220:223], v[92:95]
    buffer_load_dwordx4 v10, s[20:23], s32 offen offset:3072 nt lds
    v_mfma_f32_16x16x32_bf16 v[48:51], a[128:131], a[32:35], 0
    s_add_u32 m0, s30, 37952
    v_exp_f32 v61, v61
    v_mfma_f32_16x16x32_bf16 v[48:51], a[132:135], a[36:39], v[48:51]
    buffer_load_dwordx4 v10, s[20:23], s33 offen offset:0 nt lds
    v_mfma_f32_16x16x32_bf16 v[48:51], a[136:139], a[40:43], v[48:51]
    s_add_u32 m0, s30, 37968
    v_exp_f32 v56, v56
    v_mfma_f32_16x16x32_bf16 v[48:51], a[140:143], a[44:47], v[48:51]
    buffer_load_dwordx4 v10, s[20:23], s33 offen offset:1024 nt lds
    v_mfma_f32_16x16x32_bf16 v[52:55], a[156:159], a[44:47], 0
    s_add_u32 m0, s30, 37984
    v_exp_f32 v60, v60
    v_mfma_f32_16x16x32_bf16 v[52:55], a[152:155], a[40:43], v[52:55]
    buffer_load_dwordx4 v10, s[20:23], s33 offen offset:2048 nt lds
    v_cvt_pk_bf16_f32 v44, v56, v57
    v_mfma_f32_16x16x32_bf16 v[52:55], a[148:151], a[36:39], v[52:55]
    s_add_u32 m0, s30, 38000
    v_cvt_pk_bf16_f32 v45, v58, v59
    v_cvt_pk_bf16_f32 v46, v60, v61
    v_mfma_f32_16x16x32_bf16 v[52:55], a[144:147], a[32:35], v[52:55]
    buffer_load_dwordx4 v10, s[20:23], s33 offen offset:3072 nt lds
    s_mov_b32 s40, 0xfffff000
    v_add_u32 v5, 59392, v21
    v_xor_b32 v6, 64, v5
    s_waitcnt vmcnt(32)
.p2align 5
L_B2:
    v_smfmac_f32_16x16x64_bf16 a[236:239], a[248:251], v[40:47], v19
    s_mov_b32 s31, s30
    s_waitcnt vmcnt(40)
    v_add_u32 v5, 8192, v5
    v_mfma_f32_16x16x32_bf16 v[96:99], v[44:47], a[192:195], v[96:99]
    s_barrier
    v_mfma_f32_16x16x32_bf16 v[100:103], v[44:47], a[196:199], v[100:103]
    s_xor_b32 s30, s30, 16896
    ds_read_b64_tr_b16 v[248:249], v5 offset:2048
    v_add_u32 v3, s30, v1
    v_mfma_f32_16x16x32_bf16 v[104:107], v[44:47], a[200:203], v[104:107]
    ds_read_b128 a[96:99], v3 offset:0
    v_exp_f32 v51, v51
    v_mfma_f32_16x16x32_bf16 v[108:111], v[44:47], a[204:207], v[108:111]
    s_add_u32 s40, s40, 4096
    v_exp_f32 v50, v50
    v_mfma_f32_16x16x32_bf16 v[112:115], v[44:47], a[208:211], v[112:115]
    s_add_u32 s32, s32, 8192
    ds_read_b128 a[100:103], v3 offset:64
    v_exp_f32 v54, v54
    v_mfma_f32_16x16x32_bf16 v[116:119], v[44:47], a[212:215], v[116:119]
    s_add_u32 s33, s32, 4096
    ds_read_b64_tr_b16 v[240:241], v5 offset:0
    v_exp_f32 v49, v49
    v_mfma_f32_16x16x32_bf16 v[120:123], v[44:47], a[216:219], v[120:123]
    v_exp_f32 v53, v53
    v_mfma_f32_16x16x32_bf16 v[124:127], v[44:47], a[220:223], v[124:127]
    s_add_u32 m0, s31, 8448
    v_exp_f32 v52, v52
    v_mfma_f32_16x16x32_bf16 v[56:59], a[128:131], a[48:51], 0
    v_exp_f32 v55, v55
    v_mfma_f32_16x16x32_bf16 v[56:59], a[132:135], a[52:55], v[56:59]
    v_exp_f32 v48, v48
    v_mfma_f32_16x16x32_bf16 v[56:59], a[136:139], a[56:59], v[56:59]
    ds_read_b128 a[104:107], v3 offset:128
    v_add_u32 v6, 8192, v6
    v_mfma_f32_16x16x32_bf16 v[56:59], a[140:143], a[60:63], v[56:59]
    buffer_load_dwordx4 v10, s[16:19], s32 offen offset:0 nt lds
    v_mfma_f32_16x16x32_bf16 v[60:63], a[156:159], a[60:63], 0
    ds_read_b128 a[108:111], v3 offset:192
    v_cvt_pk_bf16_f32 v43, v54, v55
    v_mfma_f32_16x16x32_bf16 v[60:63], a[152:155], a[56:59], v[60:63]
    ds_read_b64_tr_b16 v[246:247], v6 offset:1024
    v_cvt_pk_bf16_f32 v40, v48, v49
    v_cvt_pk_bf16_f32 v42, v52, v53
    v_mfma_f32_16x16x32_bf16 v[60:63], a[148:151], a[52:55], v[60:63]
    s_add_u32 m0, s31, 8480
    ds_read_b128 a[124:127], v3 offset:704
    v_cvt_pk_bf16_f32 v41, v50, v51
    v_mfma_f32_16x16x32_bf16 v[60:63], a[144:147], a[48:51], v[60:63]
    buffer_load_dwordx4 v10, s[16:19], s32 offen offset:1024 nt lds
    v_mfma_f32_16x16x32_bf16 v[128:131], v[40:43], a[192:195], v[128:131]
    s_add_u32 m0, s31, 8512
    v_exp_f32 v56, v56
    v_mfma_f32_16x16x32_bf16 v[132:135], v[40:43], a[196:199], v[132:135]
    ds_read_b128 a[120:123], v3 offset:640
    buffer_load_dwordx4 v10, s[16:19], s32 offen offset:2048 nt lds
    v_mfma_f32_16x16x32_bf16 v[136:139], v[40:43], a[200:203], v[136:139]
    v_exp_f32 v62, v62
    v_mfma_f32_16x16x32_bf16 v[140:143], v[40:43], a[204:207], v[140:143]
    s_add_u32 m0, s31, 8544
    ds_read_b64_tr_b16 v[244:245], v5 offset:1024
    v_add_u32 v4, s30, v2
    v_mfma_f32_16x16x32_bf16 v[144:147], v[40:43], a[208:211], v[144:147]
    v_exp_f32 v57, v57
    v_mfma_f32_16x16x32_bf16 v[148:151], v[40:43], a[212:215], v[148:151]
    v_exp_f32 v60, v60
    v_mfma_f32_16x16x32_bf16 v[152:155], v[40:43], a[216:219], v[152:155]
    buffer_load_dwordx4 v10, s[16:19], s32 offen offset:3072 nt lds
    v_mfma_f32_16x16x32_bf16 v[156:159], v[40:43], a[220:223], v[156:159]
    s_cmp_lt_u32 s40, 94208
    s_cselect_b32 s41, s40, 188416
    v_cvt_pk_bf16_f32 v44, v56, v57
    v_mfma_f32_16x16x32_bf16 v[224:227], a[128:131], a[64:67], 0
    s_add_u32 m0, s31, 12672
    v_exp_f32 v63, v63
    v_mfma_f32_16x16x32_bf16 v[224:227], a[132:135], a[68:71], v[224:227]
    ds_read_b128 a[116:119], v3 offset:576
    v_cvt_pk_bf16_f32 v47, v62, v63
    v_mfma_f32_16x16x32_bf16 v[224:227], a[136:139], a[72:75], v[224:227]
    v_exp_f32 v58, v58
    v_mfma_f32_16x16x32_bf16 v[224:227], a[140:143], a[76:79], v[224:227]
    s_waitcnt lgkmcnt(1)
    ds_read_b128 a[112:115], v3 offset:512
    v_exp_f32 v59, v59
    v_mfma_f32_16x16x32_bf16 v[228:231], a[156:159], a[76:79], 0
    ds_read_b64_tr_b16 v[250:251], v6 offset:2048
    v_cvt_pk_bf16_f32 v45, v58, v59
    v_mfma_f32_16x16x32_bf16 v[228:231], a[152:155], a[72:75], v[228:231]
    v_exp_f32 v61, v61
    v_mfma_f32_16x16x32_bf16 v[228:231], a[148:151], a[68:71], v[228:231]
    ds_read_b64_tr_b16 a[160:161], v4 offset:33792
    v_cvt_pk_bf16_f32 v46, v60, v61
    v_mfma_f32_16x16x32_bf16 v[228:231], a[144:147], a[64:67], v[228:231]
    v_exp_f32 v225, v225
    v_smfmac_f32_16x16x64_bf16 a[240:243], a[248:251], v[40:47], v19
    ds_read_b64_tr_b16 a[162:163], v4 offset:34304
    v_exp_f32 v226, v226
    v_mfma_f32_16x16x32_bf16 v[160:163], v[44:47], a[192:195], v[160:163]
    buffer_load_dwordx4 v10, s[16:19], s33 offen offset:0 nt lds
    v_mfma_f32_16x16x32_bf16 v[164:167], v[44:47], a[196:199], v[164:167]
    s_add_u32 m0, s31, 12704
    ds_read_b64_tr_b16 a[164:165], v4 offset:33808
    v_exp_f32 v230, v230
    v_mfma_f32_16x16x32_bf16 v[168:171], v[44:47], a[200:203], v[168:171]
    buffer_load_dwordx4 v10, s[16:19], s33 offen offset:1024 nt lds
    v_mfma_f32_16x16x32_bf16 v[172:175], v[44:47], a[204:207], v[172:175]
    v_exp_f32 v229, v229
    v_mfma_f32_16x16x32_bf16 v[176:179], v[44:47], a[208:211], v[176:179]
    s_waitcnt lgkmcnt(3)
    ds_read_b64_tr_b16 a[166:167], v4 offset:34320
    v_mfma_f32_16x16x32_bf16 v[180:183], v[44:47], a[212:215], v[180:183]
    v_exp_f32 v227, v227
    v_mfma_f32_16x16x32_bf16 v[184:187], v[44:47], a[216:219], v[184:187]
    s_add_u32 m0, s31, 12736
    v_exp_f32 v231, v231
    v_mfma_f32_16x16x32_bf16 v[188:191], v[44:47], a[220:223], v[188:191]
    ds_read_b64_tr_b16 a[168:169], v4 offset:33824
    v_cvt_pk_bf16_f32 v233, v226, v227
    v_mfma_f32_16x16x32_bf16 v[48:51], a[96:99], a[0:3], 0
    buffer_load_dwordx4 v10, s[16:19], s33 offen offset:2048 nt lds
    v_mfma_f32_16x16x32_bf16 v[48:51], a[100:103], a[4:7], v[48:51]
    ds_read_b64_tr_b16 a[170:171], v4 offset:34336
    ds_read_b64_tr_b16 v[252:253], v5 offset:3072
    v_cvt_pk_bf16_f32 v235, v230, v231
    v_mfma_f32_16x16x32_bf16 v[48:51], a[104:107], a[8:11], v[48:51]
    ds_read_b64_tr_b16 v[242:243], v6 offset:0
    v_exp_f32 v224, v224
    v_mfma_f32_16x16x32_bf16 v[48:51], a[108:111], a[12:15], v[48:51]
    v_exp_f32 v228, v228
    v_mfma_f32_16x16x32_bf16 v[52:55], a[124:127], a[12:15], 0
    ds_read_b64_tr_b16 a[172:173], v4 offset:33840
    v_cvt_pk_bf16_f32 v232, v224, v225
    v_mfma_f32_16x16x32_bf16 v[52:55], a[120:123], a[8:11], v[52:55]
    v_exp_f32 v49, v49
    v_mfma_f32_16x16x32_bf16 v[52:55], a[116:119], a[4:7], v[52:55]
    ds_read_b64_tr_b16 a[174:175], v4 offset:34352
    v_cvt_pk_bf16_f32 v234, v228, v229
    v_mfma_f32_16x16x32_bf16 v[52:55], a[112:115], a[0:3], v[52:55]
    v_exp_f32 v51, v51
    v_smfmac_f32_16x16x64_bf16 a[244:247], a[248:251], v[232:239], v19
    s_add_u32 m0, s31, 12768
    ds_read_b64_tr_b16 a[176:177], v4 offset:33856
    v_exp_f32 v50, v50
    v_mfma_f32_16x16x32_bf16 v[192:195], v[232:235], a[192:195], v[192:195]
    buffer_load_dwordx4 v10, s[16:19], s33 offen offset:3072 nt lds
    v_mfma_f32_16x16x32_bf16 v[196:199], v[232:235], a[196:199], v[196:199]
    s_add_u32 m0, s31, 42240
    v_exp_f32 v55, v55
    v_mfma_f32_16x16x32_bf16 v[200:203], v[232:235], a[200:203], v[200:203]
    buffer_load_dwordx4 v10, s[20:23], s32 offen offset:0 nt lds
    v_mfma_f32_16x16x32_bf16 v[204:207], v[232:235], a[204:207], v[204:207]
    s_add_u32 m0, s31, 42256
    v_exp_f32 v48, v48
    v_mfma_f32_16x16x32_bf16 v[208:211], v[232:235], a[208:211], v[208:211]
    buffer_load_dwordx4 v10, s[20:23], s32 offen offset:1024 nt lds
    v_mfma_f32_16x16x32_bf16 v[212:215], v[232:235], a[212:215], v[212:215]
    ds_read_b64_tr_b16 a[178:179], v4 offset:34368
    v_cvt_pk_bf16_f32 v40, v48, v49
    v_mfma_f32_16x16x32_bf16 v[216:219], v[232:235], a[216:219], v[216:219]
    s_waitcnt lgkmcnt(4)
    v_exp_f32 v52, v52
    v_mfma_f32_16x16x32_bf16 v[220:223], v[232:235], a[220:223], v[220:223]
    s_add_u32 m0, s31, 42272
    v_exp_f32 v53, v53
    v_mfma_f32_16x16x32_bf16 v[56:59], a[96:99], a[16:19], 0
    ds_read_b64_tr_b16 a[180:181], v4 offset:33872
    buffer_store_dwordx4 v[240:243], v10, s[24:27], s41 offen offset:0 nt
    v_mfma_f32_16x16x32_bf16 v[56:59], a[100:103], a[20:23], v[56:59]
    buffer_load_dwordx4 v10, s[20:23], s32 offen offset:2048 nt lds
    v_mfma_f32_16x16x32_bf16 v[56:59], a[104:107], a[24:27], v[56:59]
    s_add_u32 m0, s31, 42288
    ds_read_b64_tr_b16 a[182:183], v4 offset:34384
    v_cvt_pk_bf16_f32 v41, v50, v51
    v_mfma_f32_16x16x32_bf16 v[56:59], a[108:111], a[28:31], v[56:59]
    v_exp_f32 v54, v54
    v_mfma_f32_16x16x32_bf16 v[60:63], a[124:127], a[28:31], 0
    ds_read_b64_tr_b16 a[184:185], v4 offset:33888
    v_cvt_pk_bf16_f32 v42, v52, v53
    v_mfma_f32_16x16x32_bf16 v[60:63], a[120:123], a[24:27], v[60:63]
    buffer_load_dwordx4 v10, s[20:23], s32 offen offset:3072 nt lds
    v_mfma_f32_16x16x32_bf16 v[60:63], a[116:119], a[20:23], v[60:63]
    s_add_u32 m0, s31, 46400
    ds_read_b64_tr_b16 a[186:187], v4 offset:34400
    v_cvt_pk_bf16_f32 v43, v54, v55
    v_mfma_f32_16x16x32_bf16 v[60:63], a[112:115], a[16:19], v[60:63]
    buffer_store_dwordx4 v[244:247], v10, s[24:27], s41 offen offset:1024 nt
    v_mfma_f32_16x16x32_bf16 v[64:67], v[40:43], a[160:163], v[64:67]
    ds_read_b64_tr_b16 a[188:189], v4 offset:33904
    v_exp_f32 v56, v56
    v_mfma_f32_16x16x32_bf16 v[68:71], v[40:43], a[164:167], v[68:71]
    v_exp_f32 v59, v59
    v_mfma_f32_16x16x32_bf16 v[72:75], v[40:43], a[168:171], v[72:75]
    s_waitcnt lgkmcnt(7)
    ds_read_b64_tr_b16 a[190:191], v4 offset:34416
    v_exp_f32 v63, v63
    v_mfma_f32_16x16x32_bf16 v[76:79], v[40:43], a[172:175], v[76:79]
    s_waitcnt lgkmcnt(6)
    v_exp_f32 v58, v58
    v_mfma_f32_16x16x32_bf16 v[80:83], v[40:43], a[176:179], v[80:83]
    s_waitcnt lgkmcnt(4)
    buffer_load_dwordx4 v10, s[20:23], s33 offen offset:0 nt lds
    v_mfma_f32_16x16x32_bf16 v[84:87], v[40:43], a[180:183], v[84:87]
    s_waitcnt lgkmcnt(2)
    v_exp_f32 v61, v61
    v_cvt_pk_bf16_f32 v45, v58, v59
    v_mfma_f32_16x16x32_bf16 v[88:91], v[40:43], a[184:187], v[88:91]
    s_waitcnt lgkmcnt(0)
    buffer_store_dwordx4 v[248:251], v10, s[24:27], s41 offen offset:2048 nt
    v_mfma_f32_16x16x32_bf16 v[92:95], v[40:43], a[188:191], v[92:95]
    v_exp_f32 v57, v57
    v_mfma_f32_16x16x32_bf16 v[48:51], a[96:99], a[32:35], 0
    s_add_u32 m0, s31, 46416
    ds_read_b64_tr_b16 v[254:255], v6 offset:3072
    v_cvt_pk_bf16_f32 v44, v56, v57
    v_mfma_f32_16x16x32_bf16 v[48:51], a[100:103], a[36:39], v[48:51]
    buffer_load_dwordx4 v10, s[20:23], s33 offen offset:1024 nt lds
    v_mfma_f32_16x16x32_bf16 v[48:51], a[104:107], a[40:43], v[48:51]
    s_add_u32 m0, s31, 46432
    v_exp_f32 v60, v60
    v_mfma_f32_16x16x32_bf16 v[48:51], a[108:111], a[44:47], v[48:51]
    v_exp_f32 v62, v62
    v_mfma_f32_16x16x32_bf16 v[52:55], a[124:127], a[44:47], 0
    buffer_load_dwordx4 v10, s[20:23], s33 offen offset:2048 nt lds
    v_mfma_f32_16x16x32_bf16 v[52:55], a[120:123], a[40:43], v[52:55]
    s_add_u32 m0, s31, 46448
    v_cvt_pk_bf16_f32 v46, v60, v61
    v_cvt_pk_bf16_f32 v47, v62, v63
    v_mfma_f32_16x16x32_bf16 v[52:55], a[116:119], a[36:39], v[52:55]
    buffer_load_dwordx4 v10, s[20:23], s33 offen offset:3072 nt lds
    v_mfma_f32_16x16x32_bf16 v[52:55], a[112:115], a[32:35], v[52:55]
    s_waitcnt lgkmcnt(0)
    buffer_store_dwordx4 v[252:255], v10, s[24:27], s41 offen offset:3072 nt
    v_smfmac_f32_16x16x64_bf16 a[236:239], a[248:251], v[40:47], v19
    s_add_u32 s32, s32, 8192
    s_waitcnt vmcnt(36)
    v_mfma_f32_16x16x32_bf16 v[96:99], v[44:47], a[160:163], v[96:99]
    s_barrier
    v_mfma_f32_16x16x32_bf16 v[100:103], v[44:47], a[164:167], v[100:103]
    s_add_u32 s33, s32, 4096
    ds_read_b128 a[128:131], v3 offset:8448
    v_exp_f32 v48, v48
    v_mfma_f32_16x16x32_bf16 v[104:107], v[44:47], a[168:171], v[104:107]
    v_exp_f32 v55, v55
    v_mfma_f32_16x16x32_bf16 v[108:111], v[44:47], a[172:175], v[108:111]
    s_add_u32 m0, s30, 0
    ds_read_b128 a[132:135], v3 offset:8512
    v_exp_f32 v52, v52
    v_mfma_f32_16x16x32_bf16 v[112:115], v[44:47], a[176:179], v[112:115]
    v_exp_f32 v49, v49
    v_mfma_f32_16x16x32_bf16 v[116:119], v[44:47], a[180:183], v[116:119]
    ds_read_b128 a[136:139], v3 offset:8576
    buffer_load_dwordx4 v10, s[16:19], s32 offen offset:0 nt lds
    v_mfma_f32_16x16x32_bf16 v[120:123], v[44:47], a[184:187], v[120:123]
    v_exp_f32 v50, v50
    v_mfma_f32_16x16x32_bf16 v[124:127], v[44:47], a[188:191], v[124:127]
    s_add_u32 m0, s30, 32
    ds_read_b128 a[140:143], v3 offset:8640
    v_exp_f32 v53, v53
    v_mfma_f32_16x16x32_bf16 v[56:59], a[96:99], a[48:51], 0
    v_exp_f32 v54, v54
    v_mfma_f32_16x16x32_bf16 v[56:59], a[100:103], a[52:55], v[56:59]
    ds_read_b64_tr_b16 v[242:243], v6 offset:4096
    v_cvt_pk_bf16_f32 v40, v48, v49
    v_mfma_f32_16x16x32_bf16 v[56:59], a[104:107], a[56:59], v[56:59]
    buffer_load_dwordx4 v10, s[16:19], s32 offen offset:1024 nt lds
    v_mfma_f32_16x16x32_bf16 v[56:59], a[108:111], a[60:63], v[56:59]
    ds_read_b64_tr_b16 v[240:241], v5 offset:4096
    v_cvt_pk_bf16_f32 v43, v54, v55
    v_mfma_f32_16x16x32_bf16 v[60:63], a[124:127], a[60:63], 0
    ds_read_b128 a[156:159], v3 offset:9152
    v_cvt_pk_bf16_f32 v42, v52, v53
    v_mfma_f32_16x16x32_bf16 v[60:63], a[120:123], a[56:59], v[60:63]
    v_exp_f32 v51, v51
    v_mfma_f32_16x16x32_bf16 v[60:63], a[116:119], a[52:55], v[60:63]
    s_add_u32 m0, s30, 64
    ds_read_b128 a[152:155], v3 offset:9088
    v_cvt_pk_bf16_f32 v41, v50, v51
    v_mfma_f32_16x16x32_bf16 v[60:63], a[112:115], a[48:51], v[60:63]
    buffer_load_dwordx4 v10, s[16:19], s32 offen offset:2048 nt lds
    v_mfma_f32_16x16x32_bf16 v[128:131], v[40:43], a[160:163], v[128:131]
    s_add_u32 m0, s30, 96
    v_exp_f32 v59, v59
    v_mfma_f32_16x16x32_bf16 v[132:135], v[40:43], a[164:167], v[132:135]
    s_add_u32 s40, s40, 4096
    v_exp_f32 v56, v56
    v_mfma_f32_16x16x32_bf16 v[136:139], v[40:43], a[168:171], v[136:139]
    ds_read_b128 a[148:151], v3 offset:9024
    v_exp_f32 v58, v58
    v_mfma_f32_16x16x32_bf16 v[140:143], v[40:43], a[172:175], v[140:143]
    v_exp_f32 v60, v60
    v_mfma_f32_16x16x32_bf16 v[144:147], v[40:43], a[176:179], v[144:147]
    v_exp_f32 v57, v57
    v_mfma_f32_16x16x32_bf16 v[148:151], v[40:43], a[180:183], v[148:151]
    s_cmp_lt_u32 s40, 94208
    s_cselect_b32 s41, s40, 188416
    buffer_load_dwordx4 v10, s[16:19], s32 offen offset:3072 nt lds
    v_mfma_f32_16x16x32_bf16 v[152:155], v[40:43], a[184:187], v[152:155]
    s_waitcnt lgkmcnt(3)
    ds_read_b64_tr_b16 v[250:251], v6 offset:6144
    v_cvt_pk_bf16_f32 v45, v58, v59
    v_mfma_f32_16x16x32_bf16 v[156:159], v[40:43], a[188:191], v[156:159]
    s_add_u32 m0, s30, 4224
    ds_read_b128 a[144:147], v3 offset:8960
    v_cvt_pk_bf16_f32 v44, v56, v57
    v_mfma_f32_16x16x32_bf16 v[224:227], a[96:99], a[64:67], 0
    buffer_load_dwordx4 v10, s[16:19], s33 offen offset:0 nt lds
    v_mfma_f32_16x16x32_bf16 v[224:227], a[100:103], a[68:71], v[224:227]
    s_add_u32 m0, s30, 4256
    v_exp_f32 v63, v63
    v_mfma_f32_16x16x32_bf16 v[224:227], a[104:107], a[72:75], v[224:227]
    ds_read_b64_tr_b16 a[192:193], v4 offset:42240
    v_exp_f32 v61, v61
    v_mfma_f32_16x16x32_bf16 v[224:227], a[108:111], a[76:79], v[224:227]
    buffer_load_dwordx4 v10, s[16:19], s33 offen offset:1024 nt lds
    v_mfma_f32_16x16x32_bf16 v[228:231], a[124:127], a[76:79], 0
    ds_read_b64_tr_b16 v[254:255], v6 offset:7168
    v_exp_f32 v62, v62
    v_mfma_f32_16x16x32_bf16 v[228:231], a[120:123], a[72:75], v[228:231]
    ds_read_b64_tr_b16 a[194:195], v4 offset:42752
    v_cvt_pk_bf16_f32 v46, v60, v61
    v_mfma_f32_16x16x32_bf16 v[228:231], a[116:119], a[68:71], v[228:231]
    ds_read_b64_tr_b16 v[252:253], v5 offset:7168
    v_cvt_pk_bf16_f32 v47, v62, v63
    v_mfma_f32_16x16x32_bf16 v[228:231], a[112:115], a[64:67], v[228:231]
    v_exp_f32 v226, v226
    v_smfmac_f32_16x16x64_bf16 a[240:243], a[248:251], v[40:47], v19
    ds_read_b64_tr_b16 a[196:197], v4 offset:42256
    v_exp_f32 v225, v225
    v_mfma_f32_16x16x32_bf16 v[160:163], v[44:47], a[160:163], v[160:163]
    s_add_u32 m0, s30, 4288
    v_exp_f32 v230, v230
    v_mfma_f32_16x16x32_bf16 v[164:167], v[44:47], a[164:167], v[164:167]
    ds_read_b64_tr_b16 a[198:199], v4 offset:42768
    buffer_load_dwordx4 v10, s[16:19], s33 offen offset:2048 nt lds
    v_mfma_f32_16x16x32_bf16 v[168:171], v[44:47], a[168:171], v[168:171]
    ds_read_b64_tr_b16 v[244:245], v5 offset:5120
    v_exp_f32 v224, v224
    v_mfma_f32_16x16x32_bf16 v[172:175], v[44:47], a[172:175], v[172:175]
    s_add_u32 m0, s30, 4320
    v_exp_f32 v228, v228
    v_mfma_f32_16x16x32_bf16 v[176:179], v[44:47], a[176:179], v[176:179]
    buffer_load_dwordx4 v10, s[16:19], s33 offen offset:3072 nt lds
    v_mfma_f32_16x16x32_bf16 v[180:183], v[44:47], a[180:183], v[180:183]
    s_add_u32 m0, s30, 33792
    ds_read_b64_tr_b16 a[200:201], v4 offset:42272
    v_cvt_pk_bf16_f32 v232, v224, v225
    v_mfma_f32_16x16x32_bf16 v[184:187], v[44:47], a[184:187], v[184:187]
    v_exp_f32 v231, v231
    v_mfma_f32_16x16x32_bf16 v[188:191], v[44:47], a[188:191], v[188:191]
    v_exp_f32 v229, v229
    v_mfma_f32_16x16x32_bf16 v[48:51], a[128:131], a[0:3], 0
    v_exp_f32 v227, v227
    v_mfma_f32_16x16x32_bf16 v[48:51], a[132:135], a[4:7], v[48:51]
    ds_read_b64_tr_b16 v[246:247], v6 offset:5120
    v_mfma_f32_16x16x32_bf16 v[48:51], a[136:139], a[8:11], v[48:51]
    ds_read_b64_tr_b16 a[202:203], v4 offset:42784
    v_cvt_pk_bf16_f32 v233, v226, v227
    v_mfma_f32_16x16x32_bf16 v[48:51], a[140:143], a[12:15], v[48:51]
    s_waitcnt lgkmcnt(14)
    buffer_store_dwordx4 v[240:243], v10, s[24:27], s41 offen offset:0 nt
    v_mfma_f32_16x16x32_bf16 v[52:55], a[156:159], a[12:15], 0
    s_waitcnt lgkmcnt(13)
    ds_read_b64_tr_b16 a[204:205], v4 offset:42288
    v_cvt_pk_bf16_f32 v234, v228, v229
    v_mfma_f32_16x16x32_bf16 v[52:55], a[152:155], a[8:11], v[52:55]
    s_waitcnt lgkmcnt(13)
    buffer_load_dwordx4 v10, s[20:23], s32 offen offset:0 nt lds
    v_mfma_f32_16x16x32_bf16 v[52:55], a[148:151], a[4:7], v[52:55]
    s_waitcnt lgkmcnt(11)
    ds_read_b64_tr_b16 a[206:207], v4 offset:42800
    v_cvt_pk_bf16_f32 v235, v230, v231
    v_mfma_f32_16x16x32_bf16 v[52:55], a[144:147], a[0:3], v[52:55]
    s_add_u32 m0, s30, 33808
    v_exp_f32 v50, v50
    v_smfmac_f32_16x16x64_bf16 a[244:247], a[248:251], v[232:239], v19
    ds_read_b64_tr_b16 a[208:209], v4 offset:42304
    buffer_load_dwordx4 v10, s[20:23], s32 offen offset:1024 nt lds
    v_mfma_f32_16x16x32_bf16 v[192:195], v[232:235], a[160:163], v[192:195]
    ds_read_b64_tr_b16 v[248:249], v5 offset:6144
    v_exp_f32 v53, v53
    v_mfma_f32_16x16x32_bf16 v[196:199], v[232:235], a[164:167], v[196:199]
    v_exp_f32 v52, v52
    v_mfma_f32_16x16x32_bf16 v[200:203], v[232:235], a[168:171], v[200:203]
    s_waitcnt lgkmcnt(5)
    v_exp_f32 v51, v51
    v_mfma_f32_16x16x32_bf16 v[204:207], v[232:235], a[172:175], v[204:207]
    buffer_store_dwordx4 v[244:247], v10, s[24:27], s41 offen offset:1024 nt
    v_mfma_f32_16x16x32_bf16 v[208:211], v[232:235], a[176:179], v[208:211]
    ds_read_b64_tr_b16 a[210:211], v4 offset:42816
    v_cvt_pk_bf16_f32 v41, v50, v51
    v_mfma_f32_16x16x32_bf16 v[212:215], v[232:235], a[180:183], v[212:215]
    s_add_u32 m0, s30, 33824
    v_exp_f32 v54, v54
    v_mfma_f32_16x16x32_bf16 v[216:219], v[232:235], a[184:187], v[216:219]
    buffer_load_dwordx4 v10, s[20:23], s32 offen offset:2048 nt lds
    v_mfma_f32_16x16x32_bf16 v[220:223], v[232:235], a[188:191], v[220:223]
    s_add_u32 m0, s30, 33840
    ds_read_b64_tr_b16 a[212:213], v4 offset:42320
    v_exp_f32 v49, v49
    v_mfma_f32_16x16x32_bf16 v[56:59], a[128:131], a[16:19], 0
    buffer_load_dwordx4 v10, s[20:23], s32 offen offset:3072 nt lds
    v_mfma_f32_16x16x32_bf16 v[56:59], a[132:135], a[20:23], v[56:59]
    ds_read_b64_tr_b16 a[214:215], v4 offset:42832
    v_cvt_pk_bf16_f32 v42, v52, v53
    v_mfma_f32_16x16x32_bf16 v[56:59], a[136:139], a[24:27], v[56:59]
    s_waitcnt lgkmcnt(3)
    v_exp_f32 v48, v48
    v_mfma_f32_16x16x32_bf16 v[56:59], a[140:143], a[28:31], v[56:59]
    ds_read_b64_tr_b16 a[216:217], v4 offset:42336
    v_cvt_pk_bf16_f32 v40, v48, v49
    v_mfma_f32_16x16x32_bf16 v[60:63], a[156:159], a[28:31], 0
    s_add_u32 s29, s29, 2
    v_exp_f32 v55, v55
    v_mfma_f32_16x16x32_bf16 v[60:63], a[152:155], a[24:27], v[60:63]
    ds_read_b64_tr_b16 a[218:219], v4 offset:42848
    v_cvt_pk_bf16_f32 v43, v54, v55
    v_mfma_f32_16x16x32_bf16 v[60:63], a[148:151], a[20:23], v[60:63]
    s_add_u32 m0, s30, 37952
    v_exp_f32 v56, v56
    v_mfma_f32_16x16x32_bf16 v[60:63], a[144:147], a[16:19], v[60:63]
    ds_read_b64_tr_b16 a[220:221], v4 offset:42352
    v_mfma_f32_16x16x32_bf16 v[64:67], v[40:43], a[192:195], v[64:67]
    v_exp_f32 v57, v57
    v_mfma_f32_16x16x32_bf16 v[68:71], v[40:43], a[196:199], v[68:71]
    ds_read_b64_tr_b16 a[222:223], v4 offset:42864
    v_exp_f32 v58, v58
    v_mfma_f32_16x16x32_bf16 v[72:75], v[40:43], a[200:203], v[72:75]
    buffer_load_dwordx4 v10, s[20:23], s33 offen offset:0 nt lds
    v_mfma_f32_16x16x32_bf16 v[76:79], v[40:43], a[204:207], v[76:79]
    s_waitcnt lgkmcnt(6)
    v_exp_f32 v59, v59
    v_mfma_f32_16x16x32_bf16 v[80:83], v[40:43], a[208:211], v[80:83]
    s_waitcnt lgkmcnt(4)
    v_exp_f32 v61, v61
    v_mfma_f32_16x16x32_bf16 v[84:87], v[40:43], a[212:215], v[84:87]
    s_waitcnt lgkmcnt(2)
    buffer_store_dwordx4 v[248:251], v10, s[24:27], s41 offen offset:2048 nt
    v_mfma_f32_16x16x32_bf16 v[88:91], v[40:43], a[216:219], v[88:91]
    s_waitcnt lgkmcnt(0)
    v_exp_f32 v62, v62
    v_mfma_f32_16x16x32_bf16 v[92:95], v[40:43], a[220:223], v[92:95]
    s_add_u32 m0, s30, 37968
    v_exp_f32 v63, v63
    v_mfma_f32_16x16x32_bf16 v[48:51], a[128:131], a[32:35], 0
    buffer_load_dwordx4 v10, s[20:23], s33 offen offset:1024 nt lds
    v_mfma_f32_16x16x32_bf16 v[48:51], a[132:135], a[36:39], v[48:51]
    s_add_u32 m0, s30, 37984
    v_exp_f32 v60, v60
    v_mfma_f32_16x16x32_bf16 v[48:51], a[136:139], a[40:43], v[48:51]
    buffer_load_dwordx4 v10, s[20:23], s33 offen offset:2048 nt lds
    v_mfma_f32_16x16x32_bf16 v[48:51], a[140:143], a[44:47], v[48:51]
    v_cvt_pk_bf16_f32 v46, v60, v61
    v_cvt_pk_bf16_f32 v47, v62, v63
    v_mfma_f32_16x16x32_bf16 v[52:55], a[156:159], a[44:47], 0
    s_add_u32 m0, s30, 38000
    v_cvt_pk_bf16_f32 v44, v56, v57
    v_cvt_pk_bf16_f32 v45, v58, v59
    v_mfma_f32_16x16x32_bf16 v[52:55], a[152:155], a[40:43], v[52:55]
    s_cmp_lg_u32 s29, 61
    buffer_store_dwordx4 v[252:255], v10, s[24:27], s41 offen offset:3072 nt
    v_mfma_f32_16x16x32_bf16 v[52:55], a[148:151], a[36:39], v[52:55]
    buffer_load_dwordx4 v10, s[20:23], s33 offen offset:3072 nt lds
    v_mfma_f32_16x16x32_bf16 v[52:55], a[144:147], a[32:35], v[52:55]
    s_cbranch_scc1 L_B2
    v_smfmac_f32_16x16x64_bf16 a[236:239], a[248:251], v[40:47], v19
    s_add_u32 s46, s43, 26624
    s_add_u32 s47, s43, 30720
    v_xor_b32 v24, 0x140, v23
    v_exp_f32 v48, v48
    v_exp_f32 v49, v49
    v_exp_f32 v50, v50
    v_mfma_f32_16x16x32_bf16 v[96:99], v[44:47], a[192:195], v[96:99]
    v_exp_f32 v51, v51
    v_exp_f32 v52, v52
    v_exp_f32 v53, v53
    v_exp_f32 v54, v54
    v_mfma_f32_16x16x32_bf16 v[100:103], v[44:47], a[196:199], v[100:103]
    v_add_u32 v5, s43, v21
    v_xor_b32 v6, 64, v5
    v_exp_f32 v55, v55
    v_cvt_pk_bf16_f32 v40, v48, v49
    v_cvt_pk_bf16_f32 v41, v50, v51
    v_cvt_pk_bf16_f32 v42, v52, v53
    v_mfma_f32_16x16x32_bf16 v[104:107], v[44:47], a[200:203], v[104:107]
    v_accvgpr_read_b32 v34, a236
    v_accvgpr_read_b32 v38, a237
    v_add_f32 v34, v34, v38
    v_subrev_u32 v38, s38, v34
    v_max_u32 v16, v16, v38
    v_rcp_f32 v34, v34
    v_cvt_pk_bf16_f32 v43, v54, v55
    v_mfma_f32_16x16x32_bf16 v[108:111], v[44:47], a[204:207], v[108:111]
    v_mov_b32_dpp v34, v34 row_ror:12 row_mask:0xa bank_mask:0xf
    v_accvgpr_read_b32 v36, a238
    v_accvgpr_read_b32 v39, a239
    v_add_f32 v36, v36, v39
    v_subrev_u32 v39, s38, v36
    v_max_u32 v16, v16, v39
    v_rcp_f32 v36, v36
    v_mfma_f32_16x16x32_bf16 v[112:115], v[44:47], a[208:211], v[112:115]
    v_mov_b32_dpp v34, v34 row_ror:8 row_mask:0xc bank_mask:0xf
    v_mov_b32_dpp v36, v36 row_ror:12 row_mask:0xa bank_mask:0xf
    v_mfma_f32_16x16x32_bf16 v[116:119], v[44:47], a[212:215], v[116:119]
    v_mul_f32_dpp v64, v34, v64 row_newbcast:0 row_mask:0xf bank_mask:0xf
    v_mul_f32_dpp v65, v34, v65 row_newbcast:1 row_mask:0xf bank_mask:0xf
    v_mul_f32_dpp v66, v34, v66 row_newbcast:2 row_mask:0xf bank_mask:0xf
    v_mul_f32_dpp v67, v34, v67 row_newbcast:3 row_mask:0xf bank_mask:0xf
    v_mul_f32_dpp v68, v34, v68 row_newbcast:0 row_mask:0xf bank_mask:0xf
    v_mul_f32_dpp v69, v34, v69 row_newbcast:1 row_mask:0xf bank_mask:0xf
    v_mul_f32_dpp v70, v34, v70 row_newbcast:2 row_mask:0xf bank_mask:0xf
    v_mul_f32_dpp v71, v34, v71 row_newbcast:3 row_mask:0xf bank_mask:0xf
    v_mfma_f32_16x16x32_bf16 v[120:123], v[44:47], a[216:219], v[120:123]
    v_mul_f32_dpp v72, v34, v72 row_newbcast:0 row_mask:0xf bank_mask:0xf
    v_mul_f32_dpp v73, v34, v73 row_newbcast:1 row_mask:0xf bank_mask:0xf
    v_mul_f32_dpp v74, v34, v74 row_newbcast:2 row_mask:0xf bank_mask:0xf
    v_mul_f32_dpp v75, v34, v75 row_newbcast:3 row_mask:0xf bank_mask:0xf
    v_mul_f32_dpp v76, v34, v76 row_newbcast:0 row_mask:0xf bank_mask:0xf
    v_mul_f32_dpp v77, v34, v77 row_newbcast:1 row_mask:0xf bank_mask:0xf
    v_mul_f32_dpp v78, v34, v78 row_newbcast:2 row_mask:0xf bank_mask:0xf
    v_mul_f32_dpp v79, v34, v79 row_newbcast:3 row_mask:0xf bank_mask:0xf
    v_mfma_f32_16x16x32_bf16 v[124:127], v[44:47], a[220:223], v[124:127]
    v_cvt_pk_bf16_f32 v64, v64, v68
    v_cvt_pk_bf16_f32 v68, v66, v70
    v_cvt_pk_bf16_f32 v66, v65, v69
    v_cvt_pk_bf16_f32 v70, v67, v71
    v_cvt_pk_bf16_f32 v65, v72, v76
    v_cvt_pk_bf16_f32 v67, v73, v77
    v_cvt_pk_bf16_f32 v69, v74, v78
    v_cvt_pk_bf16_f32 v71, v75, v79
    v_mfma_f32_16x16x32_bf16 v[56:59], a[128:131], a[48:51], 0
    ds_write_b128 v23, v[64:67] offset:0
    v_mul_f32_dpp v80, v34, v80 row_newbcast:0 row_mask:0xf bank_mask:0xf
    v_mul_f32_dpp v81, v34, v81 row_newbcast:1 row_mask:0xf bank_mask:0xf
    v_mul_f32_dpp v82, v34, v82 row_newbcast:2 row_mask:0xf bank_mask:0xf
    v_mfma_f32_16x16x32_bf16 v[56:59], a[132:135], a[52:55], v[56:59]
    ds_write_b128 v23, v[68:71] offset:512
    v_mul_f32_dpp v83, v34, v83 row_newbcast:3 row_mask:0xf bank_mask:0xf
    v_mul_f32_dpp v84, v34, v84 row_newbcast:0 row_mask:0xf bank_mask:0xf
    v_mul_f32_dpp v85, v34, v85 row_newbcast:1 row_mask:0xf bank_mask:0xf
    v_mfma_f32_16x16x32_bf16 v[56:59], a[136:139], a[56:59], v[56:59]
    v_mul_f32_dpp v86, v34, v86 row_newbcast:2 row_mask:0xf bank_mask:0xf
    v_mul_f32_dpp v87, v34, v87 row_newbcast:3 row_mask:0xf bank_mask:0xf
    v_mul_f32_dpp v88, v34, v88 row_newbcast:0 row_mask:0xf bank_mask:0xf
    v_mul_f32_dpp v89, v34, v89 row_newbcast:1 row_mask:0xf bank_mask:0xf
    v_mul_f32_dpp v90, v34, v90 row_newbcast:2 row_mask:0xf bank_mask:0xf
    v_mul_f32_dpp v91, v34, v91 row_newbcast:3 row_mask:0xf bank_mask:0xf
    v_mul_f32_dpp v92, v34, v92 row_newbcast:0 row_mask:0xf bank_mask:0xf
    v_mul_f32_dpp v93, v34, v93 row_newbcast:1 row_mask:0xf bank_mask:0xf
    v_mfma_f32_16x16x32_bf16 v[56:59], a[140:143], a[60:63], v[56:59]
    v_mul_f32_dpp v94, v34, v94 row_newbcast:2 row_mask:0xf bank_mask:0xf
    v_mul_f32_dpp v95, v34, v95 row_newbcast:3 row_mask:0xf bank_mask:0xf
    v_cvt_pk_bf16_f32 v80, v80, v84
    v_cvt_pk_bf16_f32 v84, v82, v86
    v_cvt_pk_bf16_f32 v82, v81, v85
    v_cvt_pk_bf16_f32 v86, v83, v87
    v_cvt_pk_bf16_f32 v81, v88, v92
    v_cvt_pk_bf16_f32 v83, v89, v93
    v_mfma_f32_16x16x32_bf16 v[60:63], a[156:159], a[60:63], 0
    ds_write_b128 v24, v[80:83] offset:0
    v_cvt_pk_bf16_f32 v85, v90, v94
    v_cvt_pk_bf16_f32 v87, v91, v95
    v_mov_b32_dpp v36, v36 row_ror:8 row_mask:0xc bank_mask:0xf
    v_mfma_f32_16x16x32_bf16 v[60:63], a[152:155], a[56:59], v[60:63]
    v_exp_f32 v56, v56
    v_exp_f32 v57, v57
    v_exp_f32 v58, v58
    v_exp_f32 v59, v59
    v_mfma_f32_16x16x32_bf16 v[60:63], a[148:151], a[52:55], v[60:63]
    ds_write_b128 v24, v[84:87] offset:512
    v_mul_f32_dpp v96, v36, v96 row_newbcast:0 row_mask:0xf bank_mask:0xf
    v_mul_f32_dpp v97, v36, v97 row_newbcast:1 row_mask:0xf bank_mask:0xf
    v_mul_f32_dpp v98, v36, v98 row_newbcast:2 row_mask:0xf bank_mask:0xf
    v_mfma_f32_16x16x32_bf16 v[60:63], a[144:147], a[48:51], v[60:63]
    ds_read_b64_tr_b16 v[64:65], v5 offset:0
    ds_read_b64_tr_b16 v[66:67], v6 offset:0
    ds_read_b64_tr_b16 v[68:69], v5 offset:1024
    ds_read_b64_tr_b16 v[70:71], v6 offset:1024
    v_mul_f32_dpp v99, v36, v99 row_newbcast:3 row_mask:0xf bank_mask:0xf
    v_mul_f32_dpp v100, v36, v100 row_newbcast:0 row_mask:0xf bank_mask:0xf
    v_mfma_f32_16x16x32_bf16 v[128:131], v[40:43], a[192:195], v[128:131]
    ds_read_b64_tr_b16 v[72:73], v5 offset:2048
    ds_read_b64_tr_b16 v[74:75], v6 offset:2048
    ds_read_b64_tr_b16 v[76:77], v5 offset:3072
    ds_read_b64_tr_b16 v[78:79], v6 offset:3072
    v_cvt_pk_bf16_f32 v44, v56, v57
    v_cvt_pk_bf16_f32 v45, v58, v59
    v_mfma_f32_16x16x32_bf16 v[132:135], v[40:43], a[196:199], v[132:135]
    v_exp_f32 v60, v60
    v_exp_f32 v61, v61
    v_exp_f32 v62, v62
    v_exp_f32 v63, v63
    v_mfma_f32_16x16x32_bf16 v[136:139], v[40:43], a[200:203], v[136:139]
    s_waitcnt lgkmcnt(6)
    s_waitcnt lgkmcnt(4)
    v_mul_f32_dpp v101, v36, v101 row_newbcast:1 row_mask:0xf bank_mask:0xf
    v_mul_f32_dpp v102, v36, v102 row_newbcast:2 row_mask:0xf bank_mask:0xf
    v_mul_f32_dpp v103, v36, v103 row_newbcast:3 row_mask:0xf bank_mask:0xf
    v_mul_f32_dpp v104, v36, v104 row_newbcast:0 row_mask:0xf bank_mask:0xf
    v_mul_f32_dpp v105, v36, v105 row_newbcast:1 row_mask:0xf bank_mask:0xf
    v_cvt_pk_bf16_f32 v46, v60, v61
    v_cvt_pk_bf16_f32 v47, v62, v63
    v_mfma_f32_16x16x32_bf16 v[140:143], v[40:43], a[204:207], v[140:143]
    s_waitcnt lgkmcnt(2)
    s_waitcnt lgkmcnt(0)
    buffer_store_dwordx4 v[64:67], v10, s[24:27], s46 offen offset:0 sc1
    v_mfma_f32_16x16x32_bf16 v[144:147], v[40:43], a[208:211], v[144:147]
    buffer_store_dwordx4 v[68:71], v10, s[24:27], s46 offen offset:1024 sc1
    v_mul_f32_dpp v106, v36, v106 row_newbcast:2 row_mask:0xf bank_mask:0xf
    v_mfma_f32_16x16x32_bf16 v[148:151], v[40:43], a[212:215], v[148:151]
    buffer_store_dwordx4 v[72:75], v10, s[24:27], s46 offen offset:2048 sc1
    v_mul_f32_dpp v107, v36, v107 row_newbcast:3 row_mask:0xf bank_mask:0xf
    v_mfma_f32_16x16x32_bf16 v[152:155], v[40:43], a[216:219], v[152:155]
    buffer_store_dwordx4 v[76:79], v10, s[24:27], s46 offen offset:3072 sc1
    v_mul_f32_dpp v108, v36, v108 row_newbcast:0 row_mask:0xf bank_mask:0xf
    v_mfma_f32_16x16x32_bf16 v[156:159], v[40:43], a[220:223], v[156:159]
    s_add_u32 s46, s43, 34816
    v_mul_f32_dpp v109, v36, v109 row_newbcast:1 row_mask:0xf bank_mask:0xf
    v_mul_f32_dpp v110, v36, v110 row_newbcast:2 row_mask:0xf bank_mask:0xf
    v_mul_f32_dpp v111, v36, v111 row_newbcast:3 row_mask:0xf bank_mask:0xf
    v_cvt_pk_bf16_f32 v96, v96, v100
    v_cvt_pk_bf16_f32 v100, v98, v102
    v_cvt_pk_bf16_f32 v98, v97, v101
    v_cvt_pk_bf16_f32 v102, v99, v103
    v_cvt_pk_bf16_f32 v97, v104, v108
    v_mfma_f32_16x16x32_bf16 v[224:227], a[128:131], a[64:67], 0
    v_cvt_pk_bf16_f32 v99, v105, v109
    v_cvt_pk_bf16_f32 v101, v106, v110
    v_cvt_pk_bf16_f32 v103, v107, v111
    v_mul_f32_dpp v112, v36, v112 row_newbcast:0 row_mask:0xf bank_mask:0xf
    v_mul_f32_dpp v113, v36, v113 row_newbcast:1 row_mask:0xf bank_mask:0xf
    v_mul_f32_dpp v114, v36, v114 row_newbcast:2 row_mask:0xf bank_mask:0xf
    v_mul_f32_dpp v115, v36, v115 row_newbcast:3 row_mask:0xf bank_mask:0xf
    v_mul_f32_dpp v116, v36, v116 row_newbcast:0 row_mask:0xf bank_mask:0xf
    v_mfma_f32_16x16x32_bf16 v[224:227], a[132:135], a[68:71], v[224:227]
    ds_write_b128 v23, v[96:99] offset:4096
    v_mul_f32_dpp v117, v36, v117 row_newbcast:1 row_mask:0xf bank_mask:0xf
    v_mul_f32_dpp v118, v36, v118 row_newbcast:2 row_mask:0xf bank_mask:0xf
    v_mul_f32_dpp v119, v36, v119 row_newbcast:3 row_mask:0xf bank_mask:0xf
    v_mfma_f32_16x16x32_bf16 v[224:227], a[136:139], a[72:75], v[224:227]
    ds_write_b128 v23, v[100:103] offset:4608
    v_mul_f32_dpp v120, v36, v120 row_newbcast:0 row_mask:0xf bank_mask:0xf
    v_mul_f32_dpp v121, v36, v121 row_newbcast:1 row_mask:0xf bank_mask:0xf
    v_mul_f32_dpp v122, v36, v122 row_newbcast:2 row_mask:0xf bank_mask:0xf
    v_mfma_f32_16x16x32_bf16 v[224:227], a[140:143], a[76:79], v[224:227]
    v_mul_f32_dpp v123, v36, v123 row_newbcast:3 row_mask:0xf bank_mask:0xf
    v_mul_f32_dpp v124, v36, v124 row_newbcast:0 row_mask:0xf bank_mask:0xf
    v_mul_f32_dpp v125, v36, v125 row_newbcast:1 row_mask:0xf bank_mask:0xf
    v_mul_f32_dpp v126, v36, v126 row_newbcast:2 row_mask:0xf bank_mask:0xf
    v_mul_f32_dpp v127, v36, v127 row_newbcast:3 row_mask:0xf bank_mask:0xf
    v_cvt_pk_bf16_f32 v112, v112, v116
    v_cvt_pk_bf16_f32 v116, v114, v118
    v_cvt_pk_bf16_f32 v114, v113, v117
    v_mfma_f32_16x16x32_bf16 v[228:231], a[156:159], a[76:79], 0
    v_cvt_pk_bf16_f32 v118, v115, v119
    v_cvt_pk_bf16_f32 v113, v120, v124
    v_cvt_pk_bf16_f32 v115, v121, v125
    v_cvt_pk_bf16_f32 v117, v122, v126
    v_cvt_pk_bf16_f32 v119, v123, v127
    v_mfma_f32_16x16x32_bf16 v[228:231], a[152:155], a[72:75], v[228:231]
    v_exp_f32 v224, v224
    v_exp_f32 v225, v225
    v_exp_f32 v226, v226
    v_exp_f32 v227, v227
    v_mfma_f32_16x16x32_bf16 v[228:231], a[148:151], a[68:71], v[228:231]
    ds_write_b128 v24, v[112:115] offset:4096
    v_mfma_f32_16x16x32_bf16 v[228:231], a[144:147], a[64:67], v[228:231]
    ds_write_b128 v24, v[116:119] offset:4608
    v_smfmac_f32_16x16x64_bf16 a[240:243], a[248:251], v[40:47], v19
    ds_read_b64_tr_b16 v[96:97], v5 offset:4096
    ds_read_b64_tr_b16 v[98:99], v6 offset:4096
    ds_read_b64_tr_b16 v[100:101], v5 offset:5120
    ds_read_b64_tr_b16 v[102:103], v6 offset:5120
    v_mfma_f32_16x16x32_bf16 v[160:163], v[44:47], a[192:195], v[160:163]
    v_exp_f32 v228, v228
    v_exp_f32 v229, v229
    v_exp_f32 v230, v230
    v_exp_f32 v231, v231
    v_mfma_f32_16x16x32_bf16 v[164:167], v[44:47], a[196:199], v[164:167]
    ds_read_b64_tr_b16 v[104:105], v5 offset:6144
    ds_read_b64_tr_b16 v[106:107], v6 offset:6144
    ds_read_b64_tr_b16 v[108:109], v5 offset:7168
    v_cvt_pk_bf16_f32 v232, v224, v225
    v_cvt_pk_bf16_f32 v233, v226, v227
    v_cvt_pk_bf16_f32 v234, v228, v229
    v_cvt_pk_bf16_f32 v235, v230, v231
    v_mfma_f32_16x16x32_bf16 v[168:171], v[44:47], a[200:203], v[168:171]
    s_waitcnt lgkmcnt(5)
    s_waitcnt lgkmcnt(3)
    buffer_store_dwordx4 v[96:99], v10, s[24:27], s47 offen offset:0 sc1
    v_mfma_f32_16x16x32_bf16 v[172:175], v[44:47], a[204:207], v[172:175]
    ds_read_b64_tr_b16 v[110:111], v6 offset:7168
    buffer_store_dwordx4 v[100:103], v10, s[24:27], s47 offen offset:1024 sc1
    v_mfma_f32_16x16x32_bf16 v[176:179], v[44:47], a[208:211], v[176:179]
    s_waitcnt lgkmcnt(2)
    buffer_store_dwordx4 v[104:107], v10, s[24:27], s47 offen offset:2048 sc1
    v_accvgpr_read_b32 v34, a240
    v_mfma_f32_16x16x32_bf16 v[180:183], v[44:47], a[212:215], v[180:183]
    v_accvgpr_read_b32 v38, a241
    v_add_f32 v34, v34, v38
    v_subrev_u32 v38, s38, v34
    v_max_u32 v16, v16, v38
    v_rcp_f32 v34, v34
    v_accvgpr_read_b32 v36, a242
    v_accvgpr_read_b32 v39, a243
    v_mfma_f32_16x16x32_bf16 v[184:187], v[44:47], a[216:219], v[184:187]
    s_waitcnt lgkmcnt(0)
    buffer_store_dwordx4 v[108:111], v10, s[24:27], s47 offen offset:3072 sc1
    v_mov_b32_dpp v34, v34 row_ror:12 row_mask:0xa bank_mask:0xf
    v_mfma_f32_16x16x32_bf16 v[188:191], v[44:47], a[220:223], v[188:191]
    s_add_u32 s47, s43, 38912
    v_mov_b32_dpp v34, v34 row_ror:8 row_mask:0xc bank_mask:0xf
    v_add_f32 v36, v36, v39
    v_subrev_u32 v39, s38, v36
    v_max_u32 v16, v16, v39
    v_rcp_f32 v36, v36
    v_smfmac_f32_16x16x64_bf16 a[244:247], a[248:251], v[232:239], v19
    v_mul_f32_dpp v128, v34, v128 row_newbcast:0 row_mask:0xf bank_mask:0xf
    v_mul_f32_dpp v129, v34, v129 row_newbcast:1 row_mask:0xf bank_mask:0xf
    v_mul_f32_dpp v130, v34, v130 row_newbcast:2 row_mask:0xf bank_mask:0xf
    v_mul_f32_dpp v131, v34, v131 row_newbcast:3 row_mask:0xf bank_mask:0xf
    v_mul_f32_dpp v132, v34, v132 row_newbcast:0 row_mask:0xf bank_mask:0xf
    v_mul_f32_dpp v133, v34, v133 row_newbcast:1 row_mask:0xf bank_mask:0xf
    v_mul_f32_dpp v134, v34, v134 row_newbcast:2 row_mask:0xf bank_mask:0xf
    v_mfma_f32_16x16x32_bf16 v[192:195], v[232:235], a[192:195], v[192:195]
    v_mul_f32_dpp v135, v34, v135 row_newbcast:3 row_mask:0xf bank_mask:0xf
    v_mul_f32_dpp v136, v34, v136 row_newbcast:0 row_mask:0xf bank_mask:0xf
    v_mul_f32_dpp v137, v34, v137 row_newbcast:1 row_mask:0xf bank_mask:0xf
    v_mul_f32_dpp v138, v34, v138 row_newbcast:2 row_mask:0xf bank_mask:0xf
    v_mul_f32_dpp v139, v34, v139 row_newbcast:3 row_mask:0xf bank_mask:0xf
    v_mul_f32_dpp v140, v34, v140 row_newbcast:0 row_mask:0xf bank_mask:0xf
    v_mul_f32_dpp v141, v34, v141 row_newbcast:1 row_mask:0xf bank_mask:0xf
    v_mul_f32_dpp v142, v34, v142 row_newbcast:2 row_mask:0xf bank_mask:0xf
    v_mfma_f32_16x16x32_bf16 v[196:199], v[232:235], a[196:199], v[196:199]
    v_mul_f32_dpp v143, v34, v143 row_newbcast:3 row_mask:0xf bank_mask:0xf
    v_cvt_pk_bf16_f32 v128, v128, v132
    v_cvt_pk_bf16_f32 v132, v130, v134
    v_cvt_pk_bf16_f32 v130, v129, v133
    v_cvt_pk_bf16_f32 v134, v131, v135
    v_cvt_pk_bf16_f32 v129, v136, v140
    v_cvt_pk_bf16_f32 v131, v137, v141
    v_cvt_pk_bf16_f32 v133, v138, v142
    v_mfma_f32_16x16x32_bf16 v[200:203], v[232:235], a[200:203], v[200:203]
    ds_write_b128 v23, v[128:131] offset:8192
    v_cvt_pk_bf16_f32 v135, v139, v143
    v_mul_f32_dpp v144, v34, v144 row_newbcast:0 row_mask:0xf bank_mask:0xf
    v_mul_f32_dpp v145, v34, v145 row_newbcast:1 row_mask:0xf bank_mask:0xf
    v_mfma_f32_16x16x32_bf16 v[204:207], v[232:235], a[204:207], v[204:207]
    ds_write_b128 v23, v[132:135] offset:8704
    v_mul_f32_dpp v146, v34, v146 row_newbcast:2 row_mask:0xf bank_mask:0xf
    v_mul_f32_dpp v147, v34, v147 row_newbcast:3 row_mask:0xf bank_mask:0xf
    v_mul_f32_dpp v148, v34, v148 row_newbcast:0 row_mask:0xf bank_mask:0xf
    v_mfma_f32_16x16x32_bf16 v[208:211], v[232:235], a[208:211], v[208:211]
    v_mul_f32_dpp v149, v34, v149 row_newbcast:1 row_mask:0xf bank_mask:0xf
    v_mul_f32_dpp v150, v34, v150 row_newbcast:2 row_mask:0xf bank_mask:0xf
    v_mul_f32_dpp v151, v34, v151 row_newbcast:3 row_mask:0xf bank_mask:0xf
    v_mul_f32_dpp v152, v34, v152 row_newbcast:0 row_mask:0xf bank_mask:0xf
    v_mul_f32_dpp v153, v34, v153 row_newbcast:1 row_mask:0xf bank_mask:0xf
    v_mul_f32_dpp v154, v34, v154 row_newbcast:2 row_mask:0xf bank_mask:0xf
    v_mul_f32_dpp v155, v34, v155 row_newbcast:3 row_mask:0xf bank_mask:0xf
    v_mul_f32_dpp v156, v34, v156 row_newbcast:0 row_mask:0xf bank_mask:0xf
    v_mfma_f32_16x16x32_bf16 v[212:215], v[232:235], a[212:215], v[212:215]
    v_mul_f32_dpp v157, v34, v157 row_newbcast:1 row_mask:0xf bank_mask:0xf
    v_mul_f32_dpp v158, v34, v158 row_newbcast:2 row_mask:0xf bank_mask:0xf
    v_mul_f32_dpp v159, v34, v159 row_newbcast:3 row_mask:0xf bank_mask:0xf
    v_cvt_pk_bf16_f32 v144, v144, v148
    v_cvt_pk_bf16_f32 v148, v146, v150
    v_cvt_pk_bf16_f32 v146, v145, v149
    v_cvt_pk_bf16_f32 v150, v147, v151
    v_cvt_pk_bf16_f32 v145, v152, v156
    v_mfma_f32_16x16x32_bf16 v[216:219], v[232:235], a[216:219], v[216:219]
    v_cvt_pk_bf16_f32 v147, v153, v157
    v_cvt_pk_bf16_f32 v149, v154, v158
    v_cvt_pk_bf16_f32 v151, v155, v159
    v_mov_b32_dpp v36, v36 row_ror:12 row_mask:0xa bank_mask:0xf
    v_accvgpr_read_b32 v34, a244
    v_accvgpr_read_b32 v38, a245
    v_add_f32 v34, v34, v38
    v_subrev_u32 v38, s38, v34
    v_mfma_f32_16x16x32_bf16 v[220:223], v[232:235], a[220:223], v[220:223]
    ds_write_b128 v24, v[144:147] offset:8192
    v_mov_b32_dpp v36, v36 row_ror:8 row_mask:0xc bank_mask:0xf
    v_max_u32 v16, v16, v38
    ds_write_b128 v24, v[148:151] offset:8704
    v_mul_f32_dpp v160, v36, v160 row_newbcast:0 row_mask:0xf bank_mask:0xf
    v_mul_f32_dpp v161, v36, v161 row_newbcast:1 row_mask:0xf bank_mask:0xf
    v_mul_f32_dpp v162, v36, v162 row_newbcast:2 row_mask:0xf bank_mask:0xf
    v_mul_f32_dpp v163, v36, v163 row_newbcast:3 row_mask:0xf bank_mask:0xf
    v_mul_f32_dpp v164, v36, v164 row_newbcast:0 row_mask:0xf bank_mask:0xf
    ds_read_b64_tr_b16 v[128:129], v5 offset:8192
    ds_read_b64_tr_b16 v[130:131], v6 offset:8192
    ds_read_b64_tr_b16 v[132:133], v5 offset:9216
    ds_read_b64_tr_b16 v[134:135], v6 offset:9216
    ds_read_b64_tr_b16 v[136:137], v5 offset:10240
    ds_read_b64_tr_b16 v[138:139], v6 offset:10240
    ds_read_b64_tr_b16 v[140:141], v5 offset:11264
    ds_read_b64_tr_b16 v[142:143], v6 offset:11264
    v_mul_f32_dpp v165, v36, v165 row_newbcast:1 row_mask:0xf bank_mask:0xf
    v_mul_f32_dpp v166, v36, v166 row_newbcast:2 row_mask:0xf bank_mask:0xf
    v_mul_f32_dpp v167, v36, v167 row_newbcast:3 row_mask:0xf bank_mask:0xf
    v_mul_f32_dpp v168, v36, v168 row_newbcast:0 row_mask:0xf bank_mask:0xf
    v_mul_f32_dpp v169, v36, v169 row_newbcast:1 row_mask:0xf bank_mask:0xf
    v_mul_f32_dpp v170, v36, v170 row_newbcast:2 row_mask:0xf bank_mask:0xf
    v_mul_f32_dpp v171, v36, v171 row_newbcast:3 row_mask:0xf bank_mask:0xf
    v_mul_f32_dpp v172, v36, v172 row_newbcast:0 row_mask:0xf bank_mask:0xf
    v_mul_f32_dpp v173, v36, v173 row_newbcast:1 row_mask:0xf bank_mask:0xf
    v_mul_f32_dpp v174, v36, v174 row_newbcast:2 row_mask:0xf bank_mask:0xf
    v_mul_f32_dpp v175, v36, v175 row_newbcast:3 row_mask:0xf bank_mask:0xf
    v_cvt_pk_bf16_f32 v160, v160, v164
    v_cvt_pk_bf16_f32 v164, v162, v166
    v_cvt_pk_bf16_f32 v162, v161, v165
    v_cvt_pk_bf16_f32 v166, v163, v167
    v_cvt_pk_bf16_f32 v161, v168, v172
    v_cvt_pk_bf16_f32 v163, v169, v173
    v_cvt_pk_bf16_f32 v165, v170, v174
    v_cvt_pk_bf16_f32 v167, v171, v175
    v_mul_f32_dpp v176, v36, v176 row_newbcast:0 row_mask:0xf bank_mask:0xf
    v_mul_f32_dpp v177, v36, v177 row_newbcast:1 row_mask:0xf bank_mask:0xf
    v_mul_f32_dpp v178, v36, v178 row_newbcast:2 row_mask:0xf bank_mask:0xf
    s_waitcnt lgkmcnt(6)
    s_waitcnt lgkmcnt(4)
    s_waitcnt lgkmcnt(2)
    buffer_store_dwordx4 v[128:131], v10, s[24:27], s46 offen offset:0 sc1
    s_waitcnt lgkmcnt(0)
    buffer_store_dwordx4 v[132:135], v10, s[24:27], s46 offen offset:1024 sc1
    v_mul_f32_dpp v179, v36, v179 row_newbcast:3 row_mask:0xf bank_mask:0xf
    v_mul_f32_dpp v180, v36, v180 row_newbcast:0 row_mask:0xf bank_mask:0xf
    buffer_store_dwordx4 v[136:139], v10, s[24:27], s46 offen offset:2048 sc1
    v_mul_f32_dpp v181, v36, v181 row_newbcast:1 row_mask:0xf bank_mask:0xf
    v_mul_f32_dpp v182, v36, v182 row_newbcast:2 row_mask:0xf bank_mask:0xf
    v_mul_f32_dpp v183, v36, v183 row_newbcast:3 row_mask:0xf bank_mask:0xf
    buffer_store_dwordx4 v[140:143], v10, s[24:27], s46 offen offset:3072 sc1
    v_mul_f32_dpp v184, v36, v184 row_newbcast:0 row_mask:0xf bank_mask:0xf
    v_mul_f32_dpp v185, v36, v185 row_newbcast:1 row_mask:0xf bank_mask:0xf
    v_mul_f32_dpp v186, v36, v186 row_newbcast:2 row_mask:0xf bank_mask:0xf
    ds_write_b128 v23, v[160:163] offset:12288
    ds_write_b128 v23, v[164:167] offset:12800
    v_mul_f32_dpp v187, v36, v187 row_newbcast:3 row_mask:0xf bank_mask:0xf
    v_mul_f32_dpp v188, v36, v188 row_newbcast:0 row_mask:0xf bank_mask:0xf
    v_mul_f32_dpp v189, v36, v189 row_newbcast:1 row_mask:0xf bank_mask:0xf
    v_mul_f32_dpp v190, v36, v190 row_newbcast:2 row_mask:0xf bank_mask:0xf
    v_mul_f32_dpp v191, v36, v191 row_newbcast:3 row_mask:0xf bank_mask:0xf
    v_cvt_pk_bf16_f32 v176, v176, v180
    v_cvt_pk_bf16_f32 v180, v178, v182
    v_cvt_pk_bf16_f32 v178, v177, v181
    v_cvt_pk_bf16_f32 v182, v179, v183
    v_cvt_pk_bf16_f32 v177, v184, v188
    s_add_u32 s46, s43, 43008
    v_cvt_pk_bf16_f32 v179, v185, v189
    v_cvt_pk_bf16_f32 v181, v186, v190
    v_cvt_pk_bf16_f32 v183, v187, v191
    v_rcp_f32 v34, v34
    ds_write_b128 v24, v[176:179] offset:12288
    ds_write_b128 v24, v[180:183] offset:12800
    ds_read_b64_tr_b16 v[160:161], v5 offset:12288
    ds_read_b64_tr_b16 v[162:163], v6 offset:12288
    ds_read_b64_tr_b16 v[164:165], v5 offset:13312
    ds_read_b64_tr_b16 v[166:167], v6 offset:13312
    ds_read_b64_tr_b16 v[168:169], v5 offset:14336
    ds_read_b64_tr_b16 v[170:171], v6 offset:14336
    ds_read_b64_tr_b16 v[172:173], v5 offset:15360
    ds_read_b64_tr_b16 v[174:175], v6 offset:15360
    v_mov_b32_dpp v34, v34 row_ror:12 row_mask:0xa bank_mask:0xf
    s_nop 1
    v_mov_b32_dpp v34, v34 row_ror:8 row_mask:0xc bank_mask:0xf
    s_nop 1
    v_mul_f32_dpp v192, v34, v192 row_newbcast:0 row_mask:0xf bank_mask:0xf
    v_mul_f32_dpp v193, v34, v193 row_newbcast:1 row_mask:0xf bank_mask:0xf
    v_mul_f32_dpp v194, v34, v194 row_newbcast:2 row_mask:0xf bank_mask:0xf
    v_mul_f32_dpp v195, v34, v195 row_newbcast:3 row_mask:0xf bank_mask:0xf
    v_mul_f32_dpp v196, v34, v196 row_newbcast:0 row_mask:0xf bank_mask:0xf
    v_mul_f32_dpp v197, v34, v197 row_newbcast:1 row_mask:0xf bank_mask:0xf
    v_mul_f32_dpp v198, v34, v198 row_newbcast:2 row_mask:0xf bank_mask:0xf
    v_mul_f32_dpp v199, v34, v199 row_newbcast:3 row_mask:0xf bank_mask:0xf
    v_mul_f32_dpp v200, v34, v200 row_newbcast:0 row_mask:0xf bank_mask:0xf
    v_mul_f32_dpp v201, v34, v201 row_newbcast:1 row_mask:0xf bank_mask:0xf
    s_waitcnt lgkmcnt(6)
    s_waitcnt lgkmcnt(4)
    s_waitcnt lgkmcnt(2)
    buffer_store_dwordx4 v[160:163], v10, s[24:27], s47 offen offset:0 sc1
    s_waitcnt lgkmcnt(0)
    buffer_store_dwordx4 v[164:167], v10, s[24:27], s47 offen offset:1024 sc1
    v_mul_f32_dpp v202, v34, v202 row_newbcast:2 row_mask:0xf bank_mask:0xf
    v_mul_f32_dpp v203, v34, v203 row_newbcast:3 row_mask:0xf bank_mask:0xf
    buffer_store_dwordx4 v[168:171], v10, s[24:27], s47 offen offset:2048 sc1
    v_mul_f32_dpp v204, v34, v204 row_newbcast:0 row_mask:0xf bank_mask:0xf
    v_mul_f32_dpp v205, v34, v205 row_newbcast:1 row_mask:0xf bank_mask:0xf
    v_mul_f32_dpp v206, v34, v206 row_newbcast:2 row_mask:0xf bank_mask:0xf
    buffer_store_dwordx4 v[172:175], v10, s[24:27], s47 offen offset:3072 sc1
    v_mul_f32_dpp v207, v34, v207 row_newbcast:3 row_mask:0xf bank_mask:0xf
    v_cvt_pk_bf16_f32 v192, v192, v196
    v_cvt_pk_bf16_f32 v196, v194, v198
    v_cvt_pk_bf16_f32 v194, v193, v197
    v_cvt_pk_bf16_f32 v198, v195, v199
    v_cvt_pk_bf16_f32 v193, v200, v204
    v_cvt_pk_bf16_f32 v195, v201, v205
    v_cvt_pk_bf16_f32 v197, v202, v206
    v_cvt_pk_bf16_f32 v199, v203, v207
    v_mul_f32_dpp v208, v34, v208 row_newbcast:0 row_mask:0xf bank_mask:0xf
    v_mul_f32_dpp v209, v34, v209 row_newbcast:1 row_mask:0xf bank_mask:0xf
    v_mul_f32_dpp v210, v34, v210 row_newbcast:2 row_mask:0xf bank_mask:0xf
    v_mul_f32_dpp v211, v34, v211 row_newbcast:3 row_mask:0xf bank_mask:0xf
    ds_write_b128 v23, v[192:195] offset:16384
    ds_write_b128 v23, v[196:199] offset:16896
    v_mul_f32_dpp v212, v34, v212 row_newbcast:0 row_mask:0xf bank_mask:0xf
    v_mul_f32_dpp v213, v34, v213 row_newbcast:1 row_mask:0xf bank_mask:0xf
    v_mul_f32_dpp v214, v34, v214 row_newbcast:2 row_mask:0xf bank_mask:0xf
    v_mul_f32_dpp v215, v34, v215 row_newbcast:3 row_mask:0xf bank_mask:0xf
    v_mul_f32_dpp v216, v34, v216 row_newbcast:0 row_mask:0xf bank_mask:0xf
    v_mul_f32_dpp v217, v34, v217 row_newbcast:1 row_mask:0xf bank_mask:0xf
    v_mul_f32_dpp v218, v34, v218 row_newbcast:2 row_mask:0xf bank_mask:0xf
    v_mul_f32_dpp v219, v34, v219 row_newbcast:3 row_mask:0xf bank_mask:0xf
    v_mul_f32_dpp v220, v34, v220 row_newbcast:0 row_mask:0xf bank_mask:0xf
    v_mul_f32_dpp v221, v34, v221 row_newbcast:1 row_mask:0xf bank_mask:0xf
    v_mul_f32_dpp v222, v34, v222 row_newbcast:2 row_mask:0xf bank_mask:0xf
    v_mul_f32_dpp v223, v34, v223 row_newbcast:3 row_mask:0xf bank_mask:0xf
    v_cvt_pk_bf16_f32 v208, v208, v212
    v_cvt_pk_bf16_f32 v212, v210, v214
    v_cvt_pk_bf16_f32 v210, v209, v213
    v_cvt_pk_bf16_f32 v214, v211, v215
    v_cvt_pk_bf16_f32 v209, v216, v220
    v_cvt_pk_bf16_f32 v211, v217, v221
    v_cvt_pk_bf16_f32 v213, v218, v222
    v_cvt_pk_bf16_f32 v215, v219, v223
    ds_write_b128 v24, v[208:211] offset:16384
    ds_write_b128 v24, v[212:215] offset:16896
    ds_read_b64_tr_b16 v[192:193], v5 offset:16384
    ds_read_b64_tr_b16 v[194:195], v6 offset:16384
    ds_read_b64_tr_b16 v[196:197], v5 offset:17408
    ds_read_b64_tr_b16 v[198:199], v6 offset:17408
    ds_read_b64_tr_b16 v[200:201], v5 offset:18432
    ds_read_b64_tr_b16 v[202:203], v6 offset:18432
    ds_read_b64_tr_b16 v[204:205], v5 offset:19456
    ds_read_b64_tr_b16 v[206:207], v6 offset:19456
    s_waitcnt lgkmcnt(6)
    s_waitcnt lgkmcnt(4)
    s_waitcnt lgkmcnt(2)
    buffer_store_dwordx4 v[192:195], v10, s[24:27], s46 offen offset:0 sc1
    s_waitcnt lgkmcnt(0)
    buffer_store_dwordx4 v[196:199], v10, s[24:27], s46 offen offset:1024 sc1
    buffer_store_dwordx4 v[200:203], v10, s[24:27], s46 offen offset:2048 sc1
    buffer_store_dwordx4 v[204:207], v10, s[24:27], s46 offen offset:3072 sc1
    s_waitcnt vmcnt(0)
    s_mov_b32 s3, 0x20000000
    v_cmp_lt_u32 s[4:5], s3, v15
    v_cmp_lt_u32 s[6:7], s3, v16
    s_or_b64 s[8:9], s[4:5], s[6:7]
    s_cbranch_scc1 L_FIX
    s_endpgm
L_FIX:
    v_lshrrev_b32 v0, 4, v10
    v_and_b32 v1, 15, v0
    v_lshrrev_b32 v2, 4, v0
    v_lshlrev_b32 v3, 8, v1
    v_lshl_add_u32 v4, v2, 4, v3
    v_add_u32 v5, 4096, v4
    v_lshl_add_u32 v7, v2, 6, v3
    v_lshlrev_b32 v1, 4, v1
    v_lshl_add_u32 v8, v2, 10, v1
    v_add_u32 v9, 4096, v8
    s_mov_b32 s8, 0
    s_sub_u32 s9, s43, 67584
    s_mov_b32 s29, 0x05040100
    s_mov_b32 s30, 0x07060302
L_FIX_HEAD:
    s_add_u32 s28, s8, 0x40000
    s_cmp_eq_u64 s[4:5], 0
    s_cbranch_scc1 L_FIX_NEXT
    s_mov_b32 s10, 0
L_FIX_TILE:
    s_add_u32 s31, s9, s10
    s_mov_b32 s11, s8
    v_mov_b32 v12, 0xff800000
    buffer_load_dwordx4 v[16:19], v4, s[12:15], s31 offen offset:0
    buffer_load_dwordx4 v[20:23], v4, s[12:15], s31 offen offset:64
    buffer_load_dwordx4 v[24:27], v4, s[12:15], s31 offen offset:128
    buffer_load_dwordx4 v[28:31], v4, s[12:15], s31 offen offset:192
L_FIX_P1:
    buffer_load_dwordx4 v[32:35], v4, s[16:19], s11 offen offset:0
    buffer_load_dwordx4 v[36:39], v4, s[16:19], s11 offen offset:64
    buffer_load_dwordx4 v[40:43], v4, s[16:19], s11 offen offset:128
    buffer_load_dwordx4 v[44:47], v4, s[16:19], s11 offen offset:192
    buffer_load_dwordx4 v[48:51], v5, s[16:19], s11 offen offset:0
    buffer_load_dwordx4 v[52:55], v5, s[16:19], s11 offen offset:64
    buffer_load_dwordx4 v[56:59], v5, s[16:19], s11 offen offset:128
    buffer_load_dwordx4 v[60:63], v5, s[16:19], s11 offen offset:192
    s_waitcnt vmcnt(0)
    v_mfma_f32_16x16x32_bf16 v[64:67], v[32:35], v[16:19], 0
    v_mfma_f32_16x16x32_bf16 v[64:67], v[36:39], v[20:23], v[64:67]
    v_mfma_f32_16x16x32_bf16 v[64:67], v[40:43], v[24:27], v[64:67]
    v_mfma_f32_16x16x32_bf16 v[64:67], v[44:47], v[28:31], v[64:67]
    v_mfma_f32_16x16x32_bf16 v[68:71], v[48:51], v[16:19], 0
    v_mfma_f32_16x16x32_bf16 v[68:71], v[52:55], v[20:23], v[68:71]
    v_mfma_f32_16x16x32_bf16 v[68:71], v[56:59], v[24:27], v[68:71]
    v_mfma_f32_16x16x32_bf16 v[68:71], v[60:63], v[28:31], v[68:71]
    v_max3_f32 v12, v12, v64, v65
    v_max3_f32 v12, v12, v66, v67
    s_nop 5
    v_max3_f32 v12, v12, v68, v69
    v_max3_f32 v12, v12, v70, v71
    s_add_u32 s11, s11, 8192
    s_cmp_lt_u32 s11, s28
    s_cbranch_scc1 L_FIX_P1
    v_mov_b32 v14, v12
    s_nop 1
    v_permlane32_swap_b32 v12, v14
    v_max_f32 v12, v12, v14
    v_mov_b32 v14, v12
    s_nop 1
    v_permlane16_swap_b32 v12, v14
    v_max_f32 v12, v12, v14
    s_mov_b32 s11, s8
    v_mov_b32 v13, 0
    v_mov_b32 v128, 0
    v_mov_b32 v129, 0
    v_mov_b32 v130, 0
    v_mov_b32 v131, 0
    v_mov_b32 v132, 0
    v_mov_b32 v133, 0
    v_mov_b32 v134, 0
    v_mov_b32 v135, 0
    v_mov_b32 v136, 0
    v_mov_b32 v137, 0
    v_mov_b32 v138, 0
    v_mov_b32 v139, 0
    v_mov_b32 v140, 0
    v_mov_b32 v141, 0
    v_mov_b32 v142, 0
    v_mov_b32 v143, 0
    v_mov_b32 v144, 0
    v_mov_b32 v145, 0
    v_mov_b32 v146, 0
    v_mov_b32 v147, 0
    v_mov_b32 v148, 0
    v_mov_b32 v149, 0
    v_mov_b32 v150, 0
    v_mov_b32 v151, 0
    v_mov_b32 v152, 0
    v_mov_b32 v153, 0
    v_mov_b32 v154, 0
    v_mov_b32 v155, 0
    v_mov_b32 v156, 0
    v_mov_b32 v157, 0
    v_mov_b32 v158, 0
    v_mov_b32 v159, 0
L_FIX_P2:
    buffer_load_dwordx4 v[32:35], v4, s[16:19], s11 offen offset:0
    buffer_load_dwordx4 v[36:39], v4, s[16:19], s11 offen offset:64
    buffer_load_dwordx4 v[40:43], v4, s[16:19], s11 offen offset:128
    buffer_load_dwordx4 v[44:47], v4, s[16:19], s11 offen offset:192
    buffer_load_dwordx4 v[48:51], v5, s[16:19], s11 offen offset:0
    buffer_load_dwordx4 v[52:55], v5, s[16:19], s11 offen offset:64
    buffer_load_dwordx4 v[56:59], v5, s[16:19], s11 offen offset:128
    buffer_load_dwordx4 v[60:63], v5, s[16:19], s11 offen offset:192
    buffer_load_dwordx4 v[96:99], v8, s[20:23], s11 offen offset:0
    buffer_load_dwordx4 v[100:103], v8, s[20:23], s11 offen offset:256
    buffer_load_dwordx4 v[104:107], v8, s[20:23], s11 offen offset:512
    buffer_load_dwordx4 v[108:111], v8, s[20:23], s11 offen offset:768
    buffer_load_dwordx4 v[112:115], v9, s[20:23], s11 offen offset:0
    buffer_load_dwordx4 v[116:119], v9, s[20:23], s11 offen offset:256
    buffer_load_dwordx4 v[120:123], v9, s[20:23], s11 offen offset:512
    buffer_load_dwordx4 v[124:127], v9, s[20:23], s11 offen offset:768
    s_waitcnt vmcnt(8)
    v_mfma_f32_16x16x32_bf16 v[64:67], v[32:35], v[16:19], 0
    v_mfma_f32_16x16x32_bf16 v[64:67], v[36:39], v[20:23], v[64:67]
    v_mfma_f32_16x16x32_bf16 v[64:67], v[40:43], v[24:27], v[64:67]
    v_mfma_f32_16x16x32_bf16 v[64:67], v[44:47], v[28:31], v[64:67]
    v_mfma_f32_16x16x32_bf16 v[68:71], v[48:51], v[16:19], 0
    v_mfma_f32_16x16x32_bf16 v[68:71], v[52:55], v[20:23], v[68:71]
    v_mfma_f32_16x16x32_bf16 v[68:71], v[56:59], v[24:27], v[68:71]
    v_mfma_f32_16x16x32_bf16 v[68:71], v[60:63], v[28:31], v[68:71]
    v_sub_f32 v64, v64, v12
    v_sub_f32 v65, v65, v12
    v_sub_f32 v66, v66, v12
    v_sub_f32 v67, v67, v12
    s_nop 3
    v_sub_f32 v68, v68, v12
    v_sub_f32 v69, v69, v12
    v_sub_f32 v70, v70, v12
    v_sub_f32 v71, v71, v12
    v_mul_f32 v64, s35, v64
    v_mul_f32 v65, s35, v65
    v_mul_f32 v66, s35, v66
    v_mul_f32 v67, s35, v67
    v_mul_f32 v68, s35, v68
    v_mul_f32 v69, s35, v69
    v_mul_f32 v70, s35, v70
    v_mul_f32 v71, s35, v71
    v_exp_f32 v64, v64
    v_exp_f32 v65, v65
    v_exp_f32 v66, v66
    v_exp_f32 v67, v67
    v_exp_f32 v68, v68
    v_exp_f32 v69, v69
    v_exp_f32 v70, v70
    v_exp_f32 v71, v71
    v_add_f32 v13, v13, v64
    v_add_f32 v13, v13, v65
    v_add_f32 v13, v13, v66
    v_add_f32 v13, v13, v67
    v_add_f32 v13, v13, v68
    v_add_f32 v13, v13, v69
    v_add_f32 v13, v13, v70
    v_add_f32 v13, v13, v71
    v_cvt_pk_bf16_f32 v72, v64, v65
    v_cvt_pk_bf16_f32 v73, v66, v67
    v_cvt_pk_bf16_f32 v74, v68, v69
    v_cvt_pk_bf16_f32 v75, v70, v71
    s_waitcnt vmcnt(0)
    v_perm_b32 v160, v100, v96, s29
    v_perm_b32 v161, v108, v104, s29
    v_perm_b32 v162, v116, v112, s29
    v_perm_b32 v163, v124, v120, s29
    v_perm_b32 v164, v100, v96, s30
    v_perm_b32 v165, v108, v104, s30
    v_perm_b32 v166, v116, v112, s30
    v_perm_b32 v167, v124, v120, s30
    v_perm_b32 v168, v101, v97, s29
    v_perm_b32 v169, v109, v105, s29
    v_perm_b32 v170, v117, v113, s29
    v_perm_b32 v171, v125, v121, s29
    v_perm_b32 v172, v101, v97, s30
    v_perm_b32 v173, v109, v105, s30
    v_perm_b32 v174, v117, v113, s30
    v_perm_b32 v175, v125, v121, s30
    v_perm_b32 v176, v102, v98, s29
    v_perm_b32 v177, v110, v106, s29
    v_perm_b32 v178, v118, v114, s29
    v_perm_b32 v179, v126, v122, s29
    v_perm_b32 v180, v102, v98, s30
    v_perm_b32 v181, v110, v106, s30
    v_perm_b32 v182, v118, v114, s30
    v_perm_b32 v183, v126, v122, s30
    v_perm_b32 v184, v103, v99, s29
    v_perm_b32 v185, v111, v107, s29
    v_perm_b32 v186, v119, v115, s29
    v_perm_b32 v187, v127, v123, s29
    v_perm_b32 v188, v103, v99, s30
    v_perm_b32 v189, v111, v107, s30
    v_perm_b32 v190, v119, v115, s30
    v_perm_b32 v191, v127, v123, s30
    v_mfma_f32_16x16x32_bf16 v[128:131], v[160:163], v[72:75], v[128:131]
    v_mfma_f32_16x16x32_bf16 v[132:135], v[164:167], v[72:75], v[132:135]
    v_mfma_f32_16x16x32_bf16 v[136:139], v[168:171], v[72:75], v[136:139]
    v_mfma_f32_16x16x32_bf16 v[140:143], v[172:175], v[72:75], v[140:143]
    v_mfma_f32_16x16x32_bf16 v[144:147], v[176:179], v[72:75], v[144:147]
    v_mfma_f32_16x16x32_bf16 v[148:151], v[180:183], v[72:75], v[148:151]
    v_mfma_f32_16x16x32_bf16 v[152:155], v[184:187], v[72:75], v[152:155]
    v_mfma_f32_16x16x32_bf16 v[156:159], v[188:191], v[72:75], v[156:159]
    s_add_u32 s11, s11, 8192
    s_cmp_lt_u32 s11, s28
    s_cbranch_scc1 L_FIX_P2
    v_mov_b32 v14, v13
    s_nop 1
    v_permlane32_swap_b32 v13, v14
    v_add_f32 v13, v13, v14
    v_mov_b32 v14, v13
    s_nop 1
    v_permlane16_swap_b32 v13, v14
    v_add_f32 v13, v13, v14
    v_rcp_f32 v13, v13
    s_nop 0
    v_mul_f32 v128, v128, v13
    v_mul_f32 v129, v129, v13
    v_mul_f32 v130, v130, v13
    v_mul_f32 v131, v131, v13
    v_mul_f32 v132, v132, v13
    v_mul_f32 v133, v133, v13
    v_mul_f32 v134, v134, v13
    v_mul_f32 v135, v135, v13
    v_mul_f32 v136, v136, v13
    v_mul_f32 v137, v137, v13
    v_mul_f32 v138, v138, v13
    v_mul_f32 v139, v139, v13
    v_mul_f32 v140, v140, v13
    v_mul_f32 v141, v141, v13
    v_mul_f32 v142, v142, v13
    v_mul_f32 v143, v143, v13
    v_mul_f32 v144, v144, v13
    v_mul_f32 v145, v145, v13
    v_mul_f32 v146, v146, v13
    v_mul_f32 v147, v147, v13
    v_mul_f32 v148, v148, v13
    v_mul_f32 v149, v149, v13
    v_mul_f32 v150, v150, v13
    v_mul_f32 v151, v151, v13
    v_mul_f32 v152, v152, v13
    v_mul_f32 v153, v153, v13
    v_mul_f32 v154, v154, v13
    v_mul_f32 v155, v155, v13
    v_mul_f32 v156, v156, v13
    v_mul_f32 v157, v157, v13
    v_mul_f32 v158, v158, v13
    v_mul_f32 v159, v159, v13
    v_cvt_pk_bf16_f32 v160, v128, v132
    v_cvt_pk_bf16_f32 v161, v136, v140
    v_cvt_pk_bf16_f32 v162, v144, v148
    v_cvt_pk_bf16_f32 v163, v152, v156
    buffer_store_dwordx4 v[160:163], v7, s[24:27], s31 offen offset:0
    v_cvt_pk_bf16_f32 v164, v129, v133
    v_cvt_pk_bf16_f32 v165, v137, v141
    v_cvt_pk_bf16_f32 v166, v145, v149
    v_cvt_pk_bf16_f32 v167, v153, v157
    buffer_store_dwordx4 v[164:167], v7, s[24:27], s31 offen offset:16
    v_cvt_pk_bf16_f32 v168, v130, v134
    v_cvt_pk_bf16_f32 v169, v138, v142
    v_cvt_pk_bf16_f32 v170, v146, v150
    v_cvt_pk_bf16_f32 v171, v154, v158
    buffer_store_dwordx4 v[168:171], v7, s[24:27], s31 offen offset:32
    v_cvt_pk_bf16_f32 v172, v131, v135
    v_cvt_pk_bf16_f32 v173, v139, v143
    v_cvt_pk_bf16_f32 v174, v147, v151
    v_cvt_pk_bf16_f32 v175, v155, v159
    buffer_store_dwordx4 v[172:175], v7, s[24:27], s31 offen offset:48
    s_waitcnt vmcnt(0)
    s_add_u32 s10, s10, 4096
    s_cmp_lt_u32 s10, s44
    s_cbranch_scc1 L_FIX_TILE
L_FIX_NEXT:
    s_mov_b64 s[4:5], s[6:7]
    s_mov_b32 s8, s28
    s_add_u32 s9, s9, 94208
    s_cmp_lt_u32 s8, 0x80000
    s_cbranch_scc1 L_FIX_HEAD
L_END:
    s_endpgm
.section .rodata,"a"
.p2align 6
.amdhsa_kernel standalone__mha_softmax__near_ridge_kernel
  .amdhsa_next_free_vgpr 512
  .amdhsa_next_free_sgpr 102
  .amdhsa_accum_offset 256
  .amdhsa_group_segment_fixed_size 0
  .amdhsa_kernarg_size 48
  .amdhsa_user_sgpr_count 2
  .amdhsa_user_sgpr_kernarg_segment_ptr 1
  .amdhsa_system_sgpr_workgroup_id_x 1
.end_amdhsa_kernel
```
